```python
import torch

def _softmax(x, axis=-1):
    return torch.softmax(x, dim=axis)
def _gelu(x):
    return torch.nn.functional.gelu(x, approximate="tanh")
def _silu(x):
    return torch.nn.functional.silu(x)
def _sigmoid(x):
    return torch.sigmoid(x)
def _layernorm(x, axis=-1, eps=1e-5):
    m = x.mean(dim=axis, keepdim=True)
    v = x.var(dim=axis, keepdim=True, unbiased=False)
    return (x - m) / torch.sqrt(v + eps)
def _scatter_add(tgt, idx, src, axis=0):
    return tgt.clone().index_add_(axis, idx, src)
def _segment_sum(src, seg, n):
    out = torch.zeros((n,) + src.shape[1:], dtype=src.dtype)
    return out.index_add_(0, seg, src)
def _pad(x, pw):
    flat = tuple(v for pair in reversed(pw) for v in pair)
    return torch.nn.functional.pad(x, flat)

kernel_name = 'recurrent_scan__sliding_block_cached__mixer_s_mlp__prompt'

def setup_inputs():

    _w = (lambda a: (lambda t: t.to(torch.bfloat16) if t.is_floating_point() else t)(torch.as_tensor(a)))
    def _A_setup():
        B, Sq, D = 1, 2048, 512
        Hq, Hkv, Sk, Dh = 32, 8, 2048, 128
        assert Hq % Hkv == 0, (Hq, Hkv)
        return {
            "x": _w((lambda *s: torch.randn(*s, dtype=torch.bfloat16) * 0.05)(B, Sq, D)),
            "k_cache": _w((lambda *s: torch.randn(*s, dtype=torch.bfloat16) * 0.8)(B, Hkv, Sk, Dh)),
            "v_cache": _w((lambda *s: torch.randn(*s, dtype=torch.bfloat16) * 0.8)(B, Hkv, Sk, Dh)),
            "wq": _w((lambda *s: torch.randn(*s, dtype=torch.bfloat16) * 0.8)(D, Hq * Dh) * (D ** -0.5)),
            "wo": _w((lambda *s: torch.randn(*s, dtype=torch.bfloat16) * 0.8)(Hq * Dh, D) * ((Hq * Dh) ** -0.5)),
        }
    _A_in = _A_setup()

    def _B_setup():
        B, S, D, F = 1, 2048, 512, 1792
        return {
            "x":  _w((lambda *s: torch.randn(*s, dtype=torch.bfloat16) * 0.05)(B, S, D)),
            "w1": _w((lambda *s: torch.randn(*s, dtype=torch.bfloat16) * 3.2)(D, D) * (D ** -0.5)),
            "w2": _w((lambda *s: torch.randn(*s, dtype=torch.bfloat16) * 3.2)(D, D) * (D ** -0.5)),
            "w3": _w((lambda *s: torch.randn(*s, dtype=torch.bfloat16) * 3.2)(D, F) * (D ** -0.5)),
            "w4": _w((lambda *s: torch.randn(*s, dtype=torch.bfloat16) * 3.2)(F, D) * (F ** -0.5)),
        }
    _B_in = _B_setup()

    return {
        "A_x": _A_in["x"],
        "A_k_cache": _A_in["k_cache"],
        "A_v_cache": _A_in["v_cache"],
        "A_wq": _A_in["wq"],
        "A_wo": _A_in["wo"],
        "B_x": _B_in["x"],
        "B_w1": _B_in["w1"],
        "B_w2": _B_in["w2"],
        "B_w3": _B_in["w3"],
        "B_w4": _B_in["w4"],
    }

def reference(A_x, A_k_cache, A_v_cache, A_wq, A_wo, B_x, B_w1, B_w2, B_w3, B_w4):
    def _A_ref(x, k_cache, v_cache, wq, wo):
        B, Sq, D = x.shape
        Hq, Dh = 32, 128
        Hkv, Sk = k_cache.shape[1], k_cache.shape[2]
        W = min(4096, max(256, Sk // 4))
        rep = Hq // Hkv
        q = (lambda x, *d: x.permute(*d))((x @ wq).reshape(B, Sq, Hq, Dh), 0, 2, 1, 3)
        k = (lambda x, n, axis: torch.repeat_interleave(x, n, dim=axis))(k_cache[:, :, Sk - W:, :], rep, axis=1)
        v = (lambda x, n, axis: torch.repeat_interleave(x, n, dim=axis))(v_cache[:, :, Sk - W:, :], rep, axis=1)
        scores = torch.einsum("bhqd,bhkd->bhqk", q, k) * (Dh ** -0.5)
        p = _softmax(scores, axis=-1)
        o = torch.einsum("bhqk,bhkd->bhqd", p, v)
        return (lambda x, *d: x.permute(*d))(o, 0, 2, 1, 3).reshape(B, Sq, Hq * Dh) @ wo

    def _B_ref(x, w1, w2, w3, w4):
        B, S, D = x.shape
        h = _gelu(_layernorm(x, axis=-1) @ w1)
        c = D // 4
        g0 = _pad(h[:, :, 0*c:1*c], ((0, 0), (1, 0), (0, 0)))[:, :S, :]
        g1 = _pad(h[:, :, 1*c:2*c], ((0, 0), (0, 1), (0, 0)))[:, 1:, :]
        g2 = _pad(h[:, :, 2*c:3*c], ((0, 0), (2, 0), (0, 0)))[:, :S, :]
        g3 = _pad(h[:, :, 3*c:   ], ((0, 0), (0, 2), (0, 0)))[:, 2:, :]
        hs = torch.concatenate([g0, g1, g2, g3], axis=-1) @ w2
        x1 = x + hs
        h2 = _gelu(_layernorm(x1, axis=-1) @ w3) @ w4
        return x1 + h2

    x = A_x
    xn = _layernorm(x, axis=-1)
    s = _A_ref(xn, A_k_cache, A_v_cache, A_wq, A_wo)
    g = _silu(_B_ref(xn, B_w1, B_w2, B_w3, B_w4))
    return x + s * g
```

```asm
; @launch grid=(256,1,1) block=(256,1,1) lds=163840
.amdgcn_target "amdgcn-amd-amdhsa--gfx950"
.text
.globl recurrent_scan__sliding_block_cached__mixer_s_mlp__prompt_kernel
.p2align 8
.type recurrent_scan__sliding_block_cached__mixer_s_mlp__prompt_kernel,@function
recurrent_scan__sliding_block_cached__mixer_s_mlp__prompt_kernel:
  s_cmp_ge_u32 s2, 256
  s_cbranch_scc1 L_end
  s_load_dwordx16 s[64:79], s[0:1], 0
  s_load_dwordx8 s[80:87], s[0:1], 64
  s_load_dwordx2 s[88:89], s[0:1], 96
  v_and_b32 v1, 63, v0
  v_lshrrev_b32 v30, 6, v0
  s_nop 0
  v_readfirstlane_b32 s3, v30
  s_nop 0
  s_cmp_lt_u32 s3, 3
  s_cbranch_scc1 L_cpf_1
  s_getpc_b64 s[58:59]
L_pcbase:
  s_lshr_b32 s98, s2, 3
  s_mul_i32 s98, s98, 16
  v_add_u32 v30, s98, v1
  v_lshlrev_b32 v30, 7, v30
  v_min_u32 v30, L_end-L_pcbase, v30
  v_mov_b32 v31, s59
  v_add_co_u32 v30, vcc, s58, v30
  s_nop 1
  v_addc_co_u32 v31, vcc, 0, v31, vcc
  s_mov_b64 exec, (1<<16)-1
  global_load_dword a255, v[30:31], off
  s_mov_b64 exec, -1
L_cpf_1:
  s_and_b32 s56, s2, 7
  s_lshr_b32 s57, s2, 3
  s_and_b32 s5, s56, 3
  s_lshl_b32 s5, s5, 1
  s_and_b32 s58, s57, 1
  s_add_u32 s5, s5, s58
  s_andn2_b32 s4, s57, 1
  s_lshr_b32 s58, s56, 2
  s_add_u32 s4, s4, s58
  s_lshl_b32 s60, s4, 16
  v_lshlrev_b32 v0, 4, v1
  s_lshl_b32 s98, s3, 14
  s_add_u32 s99, s60, s98
  v_xor_b32 v128, 0, v0
  v_xor_b32 v129, 16, v0
  v_xor_b32 v130, 32, v0
  v_xor_b32 v131, 48, v0
  v_xor_b32 v132, 64, v0
  v_xor_b32 v133, 80, v0
  v_xor_b32 v134, 96, v0
  v_xor_b32 v135, 112, v0
  v_xor_b32 v136, 128, v0
  v_xor_b32 v137, 144, v0
  v_xor_b32 v138, 160, v0
  v_xor_b32 v139, 176, v0
  v_xor_b32 v140, 192, v0
  v_xor_b32 v141, 208, v0
  v_xor_b32 v142, 224, v0
  v_xor_b32 v143, 240, v0
  s_waitcnt lgkmcnt(0)
  s_mov_b32 s8, s64
  s_mov_b32 s9, s65
  s_mov_b32 s10, 2097152
  s_mov_b32 s11, 0x20000
  s_add_u32 m0, s98, 0
  s_add_u32 s99, s99, 0
  buffer_load_dwordx4 v128, s[8:11], s99 offen offset:0 lds
  buffer_load_dwordx4 v129, s[8:11], s99 offen offset:1024 lds
  buffer_load_dwordx4 v130, s[8:11], s99 offen offset:2048 lds
  buffer_load_dwordx4 v131, s[8:11], s99 offen offset:3072 lds
  s_add_u32 m0, s98, 4096
  s_add_u32 s99, s99, 4096
  buffer_load_dwordx4 v132, s[8:11], s99 offen offset:0 lds
  buffer_load_dwordx4 v133, s[8:11], s99 offen offset:1024 lds
  buffer_load_dwordx4 v134, s[8:11], s99 offen offset:2048 lds
  buffer_load_dwordx4 v135, s[8:11], s99 offen offset:3072 lds
  s_add_u32 m0, s98, 8192
  s_add_u32 s99, s99, 4096
  buffer_load_dwordx4 v136, s[8:11], s99 offen offset:0 lds
  buffer_load_dwordx4 v137, s[8:11], s99 offen offset:1024 lds
  buffer_load_dwordx4 v138, s[8:11], s99 offen offset:2048 lds
  buffer_load_dwordx4 v139, s[8:11], s99 offen offset:3072 lds
  s_add_u32 m0, s98, 12288
  s_add_u32 s99, s99, 4096
  buffer_load_dwordx4 v140, s[8:11], s99 offen offset:0 lds
  buffer_load_dwordx4 v141, s[8:11], s99 offen offset:1024 lds
  buffer_load_dwordx4 v142, s[8:11], s99 offen offset:2048 lds
  buffer_load_dwordx4 v143, s[8:11], s99 offen offset:3072 lds
  s_and_b32 s95, s56, 1
  s_lshl_b32 s95, s95, 2
  s_and_b32 s58, s57, 3
  s_add_u32 s95, s95, s58
  s_andn2_b32 s94, s57, 3
  s_lshr_b32 s58, s56, 1
  s_add_u32 s94, s94, s58
  s_lshr_b32 s97, s57, 2
  s_lshr_b32 s96, s57, 1
  s_and_b32 s6, s3, 1
  s_lshr_b32 s7, s3, 1
  v_lshlrev_b32 v0, 4, v1
  s_lshl_b32 s59, s5, 10
  s_lshl_b32 s56, s3, 8
  s_add_u32 s59, s59, s56
  s_add_u32 s20, s70, s59
  s_addc_u32 s21, s71, 0
  s_sub_u32 s22, 4194304, s59
  s_mov_b32 s23, 0x20000
  s_lshl_b32 s59, s5, 7
  s_add_u32 s28, s76, s59
  s_addc_u32 s29, s77, 0
  s_sub_u32 s30, 524288, s59
  s_mov_b32 s31, 0x20000
  s_add_u32 s32, s78, s59
  s_addc_u32 s33, s79, 0
  s_sub_u32 s34, 524288, s59
  s_mov_b32 s35, 0x20000
  s_lshl_b32 s59, s5, 19
  s_add_u32 s59, s59, 393216
  s_add_u32 s12, s66, s59
  s_addc_u32 s13, s67, 0
  s_sub_u32 s14, 4194304, s59
  s_mov_b32 s15, 0x20000
  s_sub_u32 s59, s59, 10240
  s_add_u32 s16, s68, s59
  s_addc_u32 s17, s69, 0
  s_sub_u32 s18, 4194304, s59
  s_mov_b32 s19, 0x20000
  s_lshl_b32 s59, s5, 19
  s_lshl_b32 s56, s3, 8
  s_add_u32 s59, s59, s56
  s_add_u32 s24, s72, s59
  s_addc_u32 s25, s73, 0
  s_sub_u32 s26, 4194304, s59
  s_mov_b32 s27, 0x20000
  s_and_b32 s58, s95, 1
  s_lshl_b32 s59, s3, 1
  s_add_u32 s59, s59, s58
  s_cmp_eq_u32 s59, 7
  s_cselect_b32 s59, 0, s59
  s_mul_i32 s58, s95, 7
  s_add_u32 s101, s59, s58
  s_lshl_b32 s59, s101, 6
  s_add_u32 s36, s80, s59
  s_addc_u32 s37, s81, 0
  s_sub_u32 s38, 1835008, s59
  s_mov_b32 s39, 0x20000
  s_and_b32 s56, s2, 7
  s_and_b32 s71, s56, 1
  s_lshl_b32 s71, s71, 2
  s_and_b32 s58, s57, 3
  s_add_u32 s71, s71, s58
  s_andn2_b32 s70, s57, 3
  s_lshr_b32 s58, s56, 1
  s_add_u32 s70, s70, s58
  s_lshl_b32 s59, s71, 7
  s_add_u32 s40, s82, s59
  s_addc_u32 s41, s83, 0
  s_sub_u32 s42, 1835008, s59
  s_mov_b32 s43, 0x20000
  s_mov_b32 s44, s84
  s_mov_b32 s45, s85
  s_mov_b32 s46, 2097152
  s_mov_b32 s47, 0x20000
  s_mov_b32 s48, s86
  s_mov_b32 s49, s87
  s_mov_b32 s50, 256
  s_mov_b32 s51, 0x20000
  s_mov_b32 s52, s88
  s_mov_b32 s53, s89
  s_mov_b32 s54, 268435456
  s_mov_b32 s55, 0x20000
  s_getpc_b64 s[72:73]
L_pc2:
  s_mov_b32 s64, 0x3f803f80
  s_mov_b32 s65, 0x00003f80
  s_mov_b32 s66, 0x3f800000
  s_mov_b32 s67, 989855744
  s_mov_b32 s68, 3216550459
  s_mov_b32 s69, 3216550459
  s_lshl_b32 s63, s3, 12
  s_mov_b32 s62, 0
  s_mov_b32 s100, 0
  s_lshl_b32 s61, s3, 13
  s_add_u32 s61, s61, 65536
  v_lshrrev_b32 v30, 3, v1
  v_lshrrev_b32 v31, 2, v30
  v_and_b32 v30, 3, v30
  v_lshl_add_u32 v30, v31, 3, v30
  v_mul_u32_u24 v30, 1024, v30
  v_lshrrev_b32 v31, 4, v1
  v_lshlrev_b32 v31, 5, v31
  v_and_b32 v40, 0x70, v0
  v_xor_b32 v31, v31, v40
  v_add_u32 v24, v30, v31
  v_add_u32 v25, 15360, v24
  v_add_u32 v26, 2048, v24
  v_add_u32 v27, 17408, v24
  v_lshrrev_b32 v30, 4, v1
  v_lshlrev_b32 v31, 5, v30
  v_and_b32 v40, 0xf0, v0
  v_xor_b32 v31, v31, v40
  v_mul_u32_u24 v30, 8192, v30
  v_add_u32 v20, v30, v31
  v_xor_b32 v31, 0x80, v31
  v_add_u32 v30, v30, v31
  v_add_u32 v21, 64512, v30
  v_add_u32 v22, 129024, v20
  v_add_u32 v23, 193536, v30
  s_mul_i32 s76, s5, 264192
  s_mul_i32 s56, s7, 132096
  s_add_u32 s76, s76, s56
  s_lshl_b32 s56, s4, 10
  s_add_u32 s76, s76, s56
  s_lshl_b32 s56, s6, 9
  s_add_u32 s76, s76, s56
  s_add_u32 s76, s76, 128
  s_lshl_b32 s77, s4, 10
  s_lshl_b32 s56, s3, 8
  s_add_u32 s77, s77, s56
  s_lshl_b32 s78, s4, 16
  s_lshl_b32 s56, s6, 15
  s_add_u32 s78, s78, s56
  s_lshl_b32 s56, s5, 11
  s_add_u32 s78, s78, s56
  s_lshl_b32 s56, s7, 10
  s_add_u32 s78, s78, s56
  s_add_u32 s78, s78, 4194304
  s_lshl_b32 s79, s94, 16
  s_lshl_b32 s56, s3, 14
  s_add_u32 s79, s79, s56
  s_add_u32 s79, s79, 4194304
  s_lshl_b32 s80, s70, 16
  s_lshl_b32 s56, s6, 15
  s_add_u32 s80, s80, s56
  s_lshl_b32 s56, s71, 11
  s_add_u32 s80, s80, s56
  s_lshl_b32 s56, s7, 10
  s_add_u32 s80, s80, s56
  s_add_u32 s80, s80, 4194304
  s_mul_i32 s81, s94, 229376
  s_lshl_b32 s56, s101, 12
  s_add_u32 s81, s81, s56
  s_add_u32 s81, s81, 8388608
  s_mul_i32 s82, s70, 229376
  s_add_u32 s82, s82, 8388608
  s_lshl_b32 s83, s4, 19
  s_lshl_b32 s56, s3, 17
  s_add_u32 s83, s83, s56
  s_lshl_b32 s56, s5, 10
  s_add_u32 s83, s83, s56
  s_add_u32 s83, s83, 16777216
  s_and_b32 s84, s4, 15
  s_lshl_b32 s84, s84, 13
  s_lshl_b32 s85, s70, 19
  s_lshl_b32 s56, s71, 16
  s_add_u32 s85, s85, s56
  s_lshl_b32 s56, s7, 15
  s_add_u32 s85, s85, s56
  s_lshl_b32 s56, s6, 14
  s_add_u32 s85, s85, s56
  s_add_u32 s85, s85, 16777216
  s_and_b32 s86, s85, 0x1e000
  s_andn2_b32 s85, s85, 0x1e000
  s_and_b32 s56, s70, 15
  s_lshl_b32 s56, s56, 13
  s_xor_b32 s86, s86, s56
  s_lshl_b32 s87, s70, 16
  s_lshl_b32 s56, s6, 15
  s_add_u32 s87, s87, s56
  s_lshl_b32 s56, s71, 7
  s_add_u32 s87, s87, s56
  s_lshl_b32 s56, s7, 6
  s_add_u32 s87, s87, s56
  s_lshl_b32 s88, s4, 8
  s_lshl_b32 s56, s5, 2
  s_add_u32 s88, s88, s56
  s_add_u32 s88, s88, 3145728
  s_lshl_b32 s89, s94, 8
  s_lshl_b32 s56, s95, 2
  s_add_u32 s89, s89, s56
  s_add_u32 s89, s89, 3145728
  s_lshl_b32 s74, s70, 8
  s_add_u32 s74, s74, 3145728
  v_lshrrev_b32 v30, 4, v1
  v_lshlrev_b32 v31, 5, v30
  v_xor_b32 v2, v31, v0
  v_mul_u32_u24 v30, 33024, v30
  v_and_b32 v31, 0xf0, v2
  v_add_u32 v41, v30, v31
  v_and_b32 v31, 0xf0, v0
  v_add_u32 v116, v30, v31
  s_lshl_b32 s56, s6, 15
  v_add_u32 v3, s56, v2
  s_lshl_b32 s75, s3, 14
  v_add_u32 v117, s75, v2
  v_lshrrev_b32 v30, 4, v1
  v_bfe_u32 v31, v1, 2, 2
  v_and_b32 v40, 1, v30
  v_lshl_add_u32 v40, v40, 2, v31
  v_lshl_add_u32 v30, v30, 2, v31
  v_lshlrev_b32 v4, 8, v30
  v_and_b32 v31, 3, v1
  v_lshl_add_u32 v4, v31, 3, v4
  v_lshl_add_u32 v4, v40, 5, v4
  v_add_u32 v4, s61, v4
  v_xor_b32 v5, 32, v4
  v_xor_b32 v6, 64, v4
  v_xor_b32 v7, 96, v4
  v_xor_b32 v8, 128, v4
  v_xor_b32 v9, 160, v4
  v_xor_b32 v10, 192, v4
  v_xor_b32 v11, 224, v4
  v_add_u32 v12, 0x10000, v4
  v_add_u32 v13, 0x10000, v5
  v_add_u32 v14, 0x10000, v6
  v_add_u32 v15, 0x10000, v7
  v_add_u32 v16, 0x10000, v8
  v_add_u32 v17, 0x10000, v9
  v_add_u32 v18, 0x10000, v10
  v_add_u32 v19, 0x10000, v11
  v_lshrrev_b32 v30, 4, v1
  v_bfe_u32 v31, v1, 2, 2
  v_lshl_add_u32 v40, v30, 2, v31
  v_lshlrev_b32 v28, 7, v40
  v_bfe_u32 v40, v40, 1, 2
  v_lshl_add_u32 v28, v40, 5, v28
  v_and_b32 v31, 3, v1
  v_lshl_add_u32 v28, v31, 3, v28
  v_add_u32 v28, 98304, v28
  s_lshl_b32 s56, s7, 6
  v_xor_b32 v28, s56, v28
  v_xor_b32 v29, 32, v28
  v_and_b32 v30, 15, v1
  v_lshlrev_b32 v30, 3, v30
  v_add_u32 v118, 97280, v30
  s_lshl_b32 s56, s6, 8
  v_add_u32 v119, s56, v118
  s_lshl_b32 s57, s5, 11
  s_lshl_b32 s56, s7, 10
  s_add_u32 s57, s57, s56
  s_lshl_b32 s56, s6, 15
  s_add_u32 s57, s57, s56
  v_lshrrev_b32 v30, 5, v1
  v_mul_u32_u24 v30, 0x120, v30
  v_and_b32 v31, 0xf0, v0
  v_xor_b32 v30, v30, v31
  v_bfe_u32 v31, v1, 4, 1
  v_lshl_add_u32 v30, v31, 3, v30
  v_add_u32 v120, s57, v30
  v_xor_b32 v121, 0x240, v120
  v_lshrrev_b32 v30, 2, v1
  v_lshlrev_b32 v30, 18, v30
  v_bfe_u32 v31, v1, 1, 1
  s_lshl_b32 s56, s96, 1
  v_add_u32 v31, s56, v31
  v_lshl_add_u32 v30, v31, 13, v30
  v_and_b32 v31, 1, v1
  v_lshl_add_u32 v122, v31, 7, v30
  v_accvgpr_write_b32 a208, s64
  v_accvgpr_write_b32 a209, s64
  v_accvgpr_write_b32 a210, s64
  v_accvgpr_write_b32 a211, s64
  v_accvgpr_write_b32 a212, 0
  v_accvgpr_write_b32 a213, 0
  v_accvgpr_write_b32 a216, 0
  v_accvgpr_write_b32 a217, 0
  v_and_b32 v30, 16, v0
  v_lshlrev_b32 v40, v30, s65
  v_lshrrev_b32 v30, 4, v1
  v_bfe_u32 v31, v1, 2, 2
  v_cmp_eq_u32 vcc, v30, v31
  v_and_b32 v30, 2, v1
  s_nop 0
  v_cndmask_b32 v40, 0, v40, vcc
  v_cmp_eq_u32 vcc, 0, v30
  s_nop 1
  v_cndmask_b32 v31, 0, v40, vcc
  v_sub_u32 v30, v40, v31
  v_accvgpr_write_b32 a214, v31
  v_accvgpr_write_b32 a215, v30
  s_lshl_b32 s98, s3, 16
  s_add_u32 s98, s98, 0
  s_add_u32 m0, s61, 32768
  s_nop 0
  buffer_load_dwordx4 v24, s[28:31], s98 offen offset:0  lds
  buffer_load_dwordx4 v25, s[28:31], s98 offen offset:1024  lds
  buffer_load_dwordx4 v26, s[28:31], s98 offen offset:2048  lds
  buffer_load_dwordx4 v27, s[28:31], s98 offen offset:3072  lds
  s_lshl_b32 s98, s3, 16
  s_add_u32 s98, s98, 32768
  s_add_u32 m0, s61, 36864
  s_nop 0
  buffer_load_dwordx4 v24, s[28:31], s98 offen offset:0  lds
  buffer_load_dwordx4 v25, s[28:31], s98 offen offset:1024  lds
  buffer_load_dwordx4 v26, s[28:31], s98 offen offset:2048  lds
  buffer_load_dwordx4 v27, s[28:31], s98 offen offset:3072  lds
  s_lshl_b32 s98, s3, 16
  s_add_u32 s98, s98, 262144
  s_add_u32 m0, s61, 65536
  s_nop 0
  buffer_load_dwordx4 v24, s[28:31], s98 offen offset:0  lds
  buffer_load_dwordx4 v25, s[28:31], s98 offen offset:1024  lds
  buffer_load_dwordx4 v26, s[28:31], s98 offen offset:2048  lds
  buffer_load_dwordx4 v27, s[28:31], s98 offen offset:3072  lds
  v_and_b32 v30, 15, v1
  v_lshrrev_b32 v31, 4, v1
  v_xor_b32 v31, v31, v30
  v_lshlrev_b32 v30, 10, v30
  v_lshl_add_u32 v30, v31, 4, v30
  v_add_u32 v32, s75, v30
  v_xor_b32 v33, 64, v32
  v_xor_b32 v34, 128, v32
  v_xor_b32 v35, 192, v32
  s_waitcnt vmcnt(12)
  ds_read_b128 v[192:195], v32 offset:0
  s_lshl_b32 s98, s3, 16
  s_add_u32 s98, s98, 294912
  s_add_u32 m0, s61, 69632
  s_nop 0
  buffer_load_dwordx4 v24, s[28:31], s98 offen offset:0  lds
  ds_read_b128 v[196:199], v33 offset:0
  ds_read_b128 v[200:203], v34 offset:0
  ds_read_b128 v[204:207], v35 offset:0
  ds_read_b128 v[208:211], v32 offset:256
  ds_read_b128 v[212:215], v33 offset:256
  ds_read_b128 v[216:219], v34 offset:256
  ds_read_b128 v[220:223], v35 offset:256
  ds_read_b128 v[224:227], v32 offset:512
  ds_read_b128 v[228:231], v33 offset:512
  ds_read_b128 v[232:235], v34 offset:512
  ds_read_b128 v[236:239], v35 offset:512
  ds_read_b128 v[240:243], v32 offset:768
  ds_read_b128 v[244:247], v33 offset:768
  ds_read_b128 v[248:251], v34 offset:768
  ds_read_b128 v[252:255], v35 offset:768
  buffer_load_dwordx4 v25, s[28:31], s98 offen offset:1024  lds
  s_waitcnt lgkmcnt(12)
  v_mfma_f32_16x16x32_bf16 v[48:51], a[208:211], v[192:195], 0
  v_mfma_f32_16x16x32_bf16 v[52:55], v[192:195], v[192:195], 0
  v_mfma_f32_16x16x32_bf16 v[48:51], a[208:211], v[196:199], v[48:51]
  v_mfma_f32_16x16x32_bf16 v[52:55], v[196:199], v[196:199], v[52:55]
  v_mfma_f32_16x16x32_bf16 v[48:51], a[208:211], v[200:203], v[48:51]
  v_mfma_f32_16x16x32_bf16 v[52:55], v[200:203], v[200:203], v[52:55]
  v_mfma_f32_16x16x32_bf16 v[48:51], a[208:211], v[204:207], v[48:51]
  v_mfma_f32_16x16x32_bf16 v[52:55], v[204:207], v[204:207], v[52:55]
  s_waitcnt lgkmcnt(8)
  v_mfma_f32_16x16x32_bf16 v[48:51], a[208:211], v[208:211], v[48:51]
  v_mfma_f32_16x16x32_bf16 v[52:55], v[208:211], v[208:211], v[52:55]
  v_mfma_f32_16x16x32_bf16 v[48:51], a[208:211], v[212:215], v[48:51]
  v_mfma_f32_16x16x32_bf16 v[52:55], v[212:215], v[212:215], v[52:55]
  v_mfma_f32_16x16x32_bf16 v[48:51], a[208:211], v[216:219], v[48:51]
  v_mfma_f32_16x16x32_bf16 v[52:55], v[216:219], v[216:219], v[52:55]
  buffer_load_dwordx4 v26, s[28:31], s98 offen offset:2048  lds
  v_mfma_f32_16x16x32_bf16 v[48:51], a[208:211], v[220:223], v[48:51]
  v_mfma_f32_16x16x32_bf16 v[52:55], v[220:223], v[220:223], v[52:55]
  s_waitcnt lgkmcnt(4)
  v_mfma_f32_16x16x32_bf16 v[48:51], a[208:211], v[224:227], v[48:51]
  v_mfma_f32_16x16x32_bf16 v[52:55], v[224:227], v[224:227], v[52:55]
  v_mfma_f32_16x16x32_bf16 v[48:51], a[208:211], v[228:231], v[48:51]
  v_mfma_f32_16x16x32_bf16 v[52:55], v[228:231], v[228:231], v[52:55]
  v_mfma_f32_16x16x32_bf16 v[48:51], a[208:211], v[232:235], v[48:51]
  v_mfma_f32_16x16x32_bf16 v[52:55], v[232:235], v[232:235], v[52:55]
  v_mfma_f32_16x16x32_bf16 v[48:51], a[208:211], v[236:239], v[48:51]
  v_mfma_f32_16x16x32_bf16 v[52:55], v[236:239], v[236:239], v[52:55]
  s_waitcnt lgkmcnt(0)
  v_mfma_f32_16x16x32_bf16 v[48:51], a[208:211], v[240:243], v[48:51]
  v_mfma_f32_16x16x32_bf16 v[52:55], v[240:243], v[240:243], v[52:55]
  v_mfma_f32_16x16x32_bf16 v[48:51], a[208:211], v[244:247], v[48:51]
  v_mfma_f32_16x16x32_bf16 v[52:55], v[244:247], v[244:247], v[52:55]
  buffer_load_dwordx4 v27, s[28:31], s98 offen offset:3072  lds
  v_mfma_f32_16x16x32_bf16 v[48:51], a[208:211], v[248:251], v[48:51]
  v_mfma_f32_16x16x32_bf16 v[52:55], v[248:251], v[248:251], v[52:55]
  v_mfma_f32_16x16x32_bf16 v[48:51], a[208:211], v[252:255], v[48:51]
  v_mfma_f32_16x16x32_bf16 v[52:55], v[252:255], v[252:255], v[52:55]
  v_and_b32 v30, 3, v1
  v_cmp_eq_u32 s[56:57], 1, v30
  v_cmp_eq_u32 s[58:59], 2, v30
  v_cmp_eq_u32 vcc, 3, v30
  v_lshrrev_b32 v30, 4, v1
  v_bfe_u32 v31, v1, 2, 2
  s_nop 0
  v_mul_f32 v56, 3137339392, v48
  v_mul_f32 v57, 3137339392, v49
  v_mul_f32 v58, 3137339392, v50
  v_mul_f32 v59, 3137339392, v51
  s_nop 1
  v_mfma_f32_16x16x32_bf16 v[128:131], a[214:217], v[192:195], v[56:59]
  v_cndmask_b32 v52, v52, v53, s[56:57]
  s_mov_b32 s60, 0
  s_add_u32 m0, s61, 0
  s_nop 0
  buffer_load_dwordx4 v20, s[20:23], s60 offen offset:0  lds
  v_mfma_f32_16x16x32_bf16 v[132:135], a[212:215], v[192:195], v[56:59]
  v_cndmask_b32 v52, v52, v54, s[58:59]
  v_mfma_f32_16x16x32_bf16 v[136:139], a[214:217], v[196:199], v[56:59]
  v_cndmask_b32 v52, v52, v55, vcc
  v_mfma_f32_16x16x32_bf16 v[140:143], a[212:215], v[196:199], v[56:59]
  v_cmp_eq_u32 vcc, v30, v31
  v_mfma_f32_16x16x32_bf16 v[144:147], a[214:217], v[200:203], v[56:59]
  v_cvt_pk_bf16_f32 v160, v128, v129
  v_cvt_pk_bf16_f32 v161, v130, v131
  v_mul_f32 v49, v56, v56
  v_mfma_f32_16x16x32_bf16 v[148:151], a[212:215], v[200:203], v[56:59]
  v_cvt_pk_bf16_f32 v162, v132, v133
  v_cvt_pk_bf16_f32 v163, v134, v135
  ds_write_b128 v117, v[160:163] offset:0
  v_and_b32 v30, 15, v1
  v_mfma_f32_16x16x32_bf16 v[152:155], a[214:217], v[204:207], v[56:59]
  buffer_load_dwordx4 v21, s[20:23], s60 offen offset:1024  lds
  v_cvt_pk_bf16_f32 v164, v136, v137
  v_cvt_pk_bf16_f32 v165, v138, v139
  v_cndmask_b32 v52, 0, v52, vcc
  v_mfma_f32_16x16x32_bf16 v[156:159], a[212:215], v[204:207], v[56:59]
  v_cvt_pk_bf16_f32 v166, v140, v141
  v_cvt_pk_bf16_f32 v167, v142, v143
  ds_write_b128 v117, v[164:167] offset:1024
  v_mov_b32 v53, v52
  v_mfma_f32_16x16x32_bf16 v[128:131], a[214:217], v[208:211], v[56:59]
  v_cvt_pk_bf16_f32 v168, v144, v145
  v_cvt_pk_bf16_f32 v169, v146, v147
  v_permlane32_swap_b32 v52, v53
  v_mfma_f32_16x16x32_bf16 v[132:135], a[212:215], v[208:211], v[56:59]
  v_cvt_pk_bf16_f32 v170, v148, v149
  v_cvt_pk_bf16_f32 v171, v150, v151
  ds_write_b128 v117, v[168:171] offset:2048
  buffer_load_dwordx4 v22, s[20:23], s60 offen offset:2048  lds
  v_add_f32 v52, v52, v53
  v_mfma_f32_16x16x32_bf16 v[136:139], a[214:217], v[212:215], v[56:59]
  v_cvt_pk_bf16_f32 v172, v152, v153
  v_cvt_pk_bf16_f32 v173, v154, v155
  v_mov_b32 v53, v52
  v_mfma_f32_16x16x32_bf16 v[140:143], a[212:215], v[212:215], v[56:59]
  v_cvt_pk_bf16_f32 v174, v156, v157
  v_cvt_pk_bf16_f32 v175, v158, v159
  ds_write_b128 v117, v[172:175] offset:3072
  v_permlane16_swap_b32 v52, v53
  v_mfma_f32_16x16x32_bf16 v[144:147], a[214:217], v[216:219], v[56:59]
  v_cvt_pk_bf16_f32 v160, v128, v129
  v_cvt_pk_bf16_f32 v161, v130, v131
  v_add_f32 v52, v52, v53
  v_mfma_f32_16x16x32_bf16 v[148:151], a[212:215], v[216:219], v[56:59]
  buffer_load_dwordx4 v23, s[20:23], s60 offen offset:3072  lds
  v_cvt_pk_bf16_f32 v162, v132, v133
  v_cvt_pk_bf16_f32 v163, v134, v135
  ds_write_b128 v117, v[160:163] offset:4096
  v_fma_f32 v52, v52, s67, -v49
  v_mfma_f32_16x16x32_bf16 v[152:155], a[214:217], v[220:223], v[56:59]
  v_cvt_pk_bf16_f32 v164, v136, v137
  v_cvt_pk_bf16_f32 v165, v138, v139
  v_max_f32 v52, 0, v52
  v_mfma_f32_16x16x32_bf16 v[156:159], a[212:215], v[220:223], v[56:59]
  v_cvt_pk_bf16_f32 v166, v140, v141
  v_cvt_pk_bf16_f32 v167, v142, v143
  ds_write_b128 v117, v[164:167] offset:5120
  v_add_f32 v53, 925353388, v52
  v_mfma_f32_16x16x32_bf16 v[128:131], a[214:217], v[224:227], v[56:59]
  v_cvt_pk_bf16_f32 v168, v144, v145
  v_cvt_pk_bf16_f32 v169, v146, v147
  s_mov_b32 s60, 32768
  s_add_u32 m0, s61, 4096
  s_nop 0
  buffer_load_dwordx4 v20, s[20:23], s60 offen offset:0  lds
  v_rsq_f32 v48, v53
  v_mfma_f32_16x16x32_bf16 v[132:135], a[212:215], v[224:227], v[56:59]
  v_cvt_pk_bf16_f32 v170, v148, v149
  v_cvt_pk_bf16_f32 v171, v150, v151
  ds_write_b128 v117, v[168:171] offset:6144
  s_lshl_b32 s56, s3, 7
  v_mfma_f32_16x16x32_bf16 v[136:139], a[214:217], v[228:231], v[56:59]
  v_cvt_pk_bf16_f32 v172, v152, v153
  v_cvt_pk_bf16_f32 v173, v154, v155
  s_add_u32 s56, s56, 97280
  v_mfma_f32_16x16x32_bf16 v[140:143], a[212:215], v[228:231], v[56:59]
  v_cvt_pk_bf16_f32 v174, v156, v157
  v_cvt_pk_bf16_f32 v175, v158, v159
  ds_write_b128 v117, v[172:175] offset:7168
  v_lshl_add_u32 v30, v30, 3, s56
  v_mfma_f32_16x16x32_bf16 v[144:147], a[214:217], v[232:235], v[56:59]
  buffer_load_dwordx4 v21, s[20:23], s60 offen offset:1024  lds
  v_cvt_pk_bf16_f32 v160, v128, v129
  v_cvt_pk_bf16_f32 v161, v130, v131
  v_mul_f32 v52, v52, v48
  v_mfma_f32_16x16x32_bf16 v[148:151], a[212:215], v[232:235], v[56:59]
  v_cvt_pk_bf16_f32 v162, v132, v133
  v_cvt_pk_bf16_f32 v163, v134, v135
  ds_write_b128 v117, v[160:163] offset:8192
  v_mul_f32 v52, v52, v48
  v_mfma_f32_16x16x32_bf16 v[152:155], a[214:217], v[236:239], v[56:59]
  v_cvt_pk_bf16_f32 v164, v136, v137
  v_cvt_pk_bf16_f32 v165, v138, v139
  v_add_f32 v52, 925353388, v52
  v_mfma_f32_16x16x32_bf16 v[156:159], a[212:215], v[236:239], v[56:59]
  v_cvt_pk_bf16_f32 v166, v140, v141
  v_cvt_pk_bf16_f32 v167, v142, v143
  ds_write_b128 v117, v[164:167] offset:9216
  buffer_load_dwordx4 v22, s[20:23], s60 offen offset:2048  lds
  v_rsq_f32 v52, v52
  v_mfma_f32_16x16x32_bf16 v[128:131], a[214:217], v[240:243], v[56:59]
  v_cvt_pk_bf16_f32 v168, v144, v145
  v_cvt_pk_bf16_f32 v169, v146, v147
  s_nop 0
  v_mfma_f32_16x16x32_bf16 v[132:135], a[212:215], v[240:243], v[56:59]
  v_cvt_pk_bf16_f32 v170, v148, v149
  v_cvt_pk_bf16_f32 v171, v150, v151
  ds_write_b128 v117, v[168:171] offset:10240
  v_mul_f32 v49, v52, v48
  v_mfma_f32_16x16x32_bf16 v[136:139], a[214:217], v[244:247], v[56:59]
  v_cvt_pk_bf16_f32 v172, v152, v153
  v_cvt_pk_bf16_f32 v173, v154, v155
  ds_write_b64 v30, v[48:49]
  v_mfma_f32_16x16x32_bf16 v[140:143], a[212:215], v[244:247], v[56:59]
  v_cvt_pk_bf16_f32 v174, v156, v157
  s_mov_b32 s99, 262144
  buffer_load_dword a255, v122, s[20:23], s99 offen
  v_cvt_pk_bf16_f32 v175, v158, v159
  ds_write_b128 v117, v[172:175] offset:11264
  v_mfma_f32_16x16x32_bf16 v[144:147], a[214:217], v[248:251], v[56:59]
  v_cvt_pk_bf16_f32 v160, v128, v129
  v_cvt_pk_bf16_f32 v161, v130, v131
  v_mfma_f32_16x16x32_bf16 v[148:151], a[212:215], v[248:251], v[56:59]
  v_cvt_pk_bf16_f32 v162, v132, v133
  v_cvt_pk_bf16_f32 v163, v134, v135
  ds_write_b128 v117, v[160:163] offset:12288
  v_mfma_f32_16x16x32_bf16 v[152:155], a[214:217], v[252:255], v[56:59]
  v_cvt_pk_bf16_f32 v164, v136, v137
  v_cvt_pk_bf16_f32 v165, v138, v139
  v_mfma_f32_16x16x32_bf16 v[156:159], a[212:215], v[252:255], v[56:59]
  v_cvt_pk_bf16_f32 v166, v140, v141
  v_cvt_pk_bf16_f32 v167, v142, v143
  ds_write_b128 v117, v[164:167] offset:13312
  v_cvt_pk_bf16_f32 v168, v144, v145
  v_cvt_pk_bf16_f32 v169, v146, v147
  v_cvt_pk_bf16_f32 v170, v148, v149
  v_cvt_pk_bf16_f32 v171, v150, v151
  ds_write_b128 v117, v[168:171] offset:14336
  v_cvt_pk_bf16_f32 v172, v152, v153
  v_cvt_pk_bf16_f32 v173, v154, v155
  v_cvt_pk_bf16_f32 v174, v156, v157
  v_cvt_pk_bf16_f32 v175, v158, v159
  ds_write_b128 v117, v[172:175] offset:15360
  s_waitcnt vmcnt(8) lgkmcnt(0)
  s_barrier
  ds_read_b64 v[96:97], v118 offset:0
  ds_read_b64 v[98:99], v118 offset:128
  ds_read_b64 v[100:101], v118 offset:256
  ds_read_b64 v[102:103], v118 offset:384
  ds_read_b64 v[104:105], v119 offset:0
  ds_read_b64 v[106:107], v119 offset:128
  ds_read_b128 a[72:75], v3 offset:0
  ds_read_b128 a[76:79], v3 offset:16384
  ds_read_b64_tr_b16 a[64:65], v28 offset:0
  ds_read_b64_tr_b16 a[66:67], v28 offset:2048
  ds_read_b64_tr_b16 a[68:69], v29 offset:0
  ds_read_b64_tr_b16 a[70:71], v29 offset:2048
  ds_read_b128 a[88:91], v3 offset:1024
  ds_read_b128 a[92:95], v3 offset:17408
  ds_read_b64_tr_b16 a[80:81], v28 offset:4096
  ds_read_b64_tr_b16 a[82:83], v28 offset:6144
  ds_read_b64_tr_b16 a[84:85], v29 offset:4096
  ds_read_b64_tr_b16 a[86:87], v29 offset:6144
  ds_read_b128 a[104:107], v3 offset:2048
  ds_read_b128 a[108:111], v3 offset:18432
  ds_read_b64_tr_b16 a[96:97], v28 offset:8192
  ds_read_b64_tr_b16 a[98:99], v28 offset:10240
  ds_read_b64_tr_b16 a[100:101], v29 offset:8192
  ds_read_b64_tr_b16 a[102:103], v29 offset:10240
  ds_read_b64 v[32:33], v120 offset:0
  ds_read_b64 v[36:37], v120 offset:16384
  ds_read_b64 v[34:35], v121 offset:0
  ds_read_b64 v[38:39], v121 offset:16384
  s_waitcnt lgkmcnt(15)
  v_mfma_f32_16x16x32_bf16 v[48:51], a[64:67], a[72:75], 0
  ds_read_b128 a[120:123], v3 offset:3072
  ds_read_b128 a[124:127], v3 offset:19456
  v_mfma_f32_16x16x32_bf16 v[52:55], a[64:67], a[76:79], 0
  ds_read_b64_tr_b16 a[112:113], v28 offset:12288
  ds_read_b64_tr_b16 a[114:115], v28 offset:14336
  v_mfma_f32_16x16x32_bf16 v[56:59], a[68:71], a[72:75], 0
  ds_read_b64_tr_b16 a[116:117], v29 offset:12288
  ds_read_b64_tr_b16 a[118:119], v29 offset:14336
  v_mfma_f32_16x16x32_bf16 v[60:63], a[68:71], a[76:79], 0
  s_waitcnt lgkmcnt(15)
  v_mfma_f32_16x16x32_bf16 v[48:51], a[80:83], a[88:91], v[48:51]
  ds_read_b128 a[72:75], v3 offset:4096
  ds_read_b128 a[76:79], v3 offset:20480
  v_mfma_f32_16x16x32_bf16 v[52:55], a[80:83], a[92:95], v[52:55]
  ds_read_b64_tr_b16 a[64:65], v28 offset:16384
  ds_read_b64_tr_b16 a[66:67], v28 offset:18432
  v_mfma_f32_16x16x32_bf16 v[56:59], a[84:87], a[88:91], v[56:59]
  ds_read_b64_tr_b16 a[68:69], v29 offset:16384
  ds_read_b64_tr_b16 a[70:71], v29 offset:18432
  v_mfma_f32_16x16x32_bf16 v[60:63], a[84:87], a[92:95], v[60:63]
  s_waitcnt lgkmcnt(15)
  s_barrier
  s_add_u32 m0, s61, 4096
  s_mov_b32 s98, 32768
  buffer_load_dwordx4 v23, s[20:23], s98 offen offset:3072 lds
  s_mov_b32 s60, 262144
  v_mfma_f32_16x16x32_bf16 v[48:51], a[96:99], a[104:107], v[48:51]
  ds_read_b128 a[88:91], v3 offset:5120
  ds_read_b128 a[92:95], v3 offset:21504
  v_mfma_f32_16x16x32_bf16 v[52:55], a[96:99], a[108:111], v[52:55]
  ds_read_b64_tr_b16 a[80:81], v28 offset:20480
  ds_read_b64_tr_b16 a[82:83], v28 offset:22528
  v_mfma_f32_16x16x32_bf16 v[56:59], a[100:103], a[104:107], v[56:59]
  ds_read_b64_tr_b16 a[84:85], v29 offset:20480
  ds_read_b64_tr_b16 a[86:87], v29 offset:22528
  v_mfma_f32_16x16x32_bf16 v[60:63], a[100:103], a[108:111], v[60:63]
  s_waitcnt lgkmcnt(12)
  v_mfma_f32_16x16x32_bf16 v[48:51], a[112:115], a[120:123], v[48:51]
  ds_read_b128 a[104:107], v3 offset:6144
  ds_read_b128 a[108:111], v3 offset:22528
  v_mfma_f32_16x16x32_bf16 v[52:55], a[112:115], a[124:127], v[52:55]
  ds_read_b64_tr_b16 a[96:97], v28 offset:24576
  ds_read_b64_tr_b16 a[98:99], v28 offset:26624
  v_mfma_f32_16x16x32_bf16 v[56:59], a[116:119], a[120:123], v[56:59]
  ds_read_b64_tr_b16 a[100:101], v29 offset:24576
  ds_read_b64_tr_b16 a[102:103], v29 offset:26624
  v_mfma_f32_16x16x32_bf16 v[60:63], a[116:119], a[124:127], v[60:63]
  s_waitcnt lgkmcnt(12)
  v_mfma_f32_16x16x32_bf16 v[48:51], a[64:67], a[72:75], v[48:51]
  ds_read_b128 a[120:123], v3 offset:7168
  ds_read_b128 a[124:127], v3 offset:23552
  v_mfma_f32_16x16x32_bf16 v[52:55], a[64:67], a[76:79], v[52:55]
  ds_read_b64_tr_b16 a[112:113], v28 offset:28672
  ds_read_b64_tr_b16 a[114:115], v28 offset:30720
  v_mfma_f32_16x16x32_bf16 v[56:59], a[68:71], a[72:75], v[56:59]
  ds_read_b64_tr_b16 a[116:117], v29 offset:28672
  ds_read_b64_tr_b16 a[118:119], v29 offset:30720
  v_mfma_f32_16x16x32_bf16 v[60:63], a[68:71], a[76:79], v[60:63]
  s_waitcnt lgkmcnt(12)
  v_mfma_f32_16x16x32_bf16 v[48:51], a[80:83], a[88:91], v[48:51]
  ds_read_b128 a[72:75], v3 offset:8192
  ds_read_b128 a[76:79], v3 offset:24576
  v_mfma_f32_16x16x32_bf16 v[52:55], a[80:83], a[92:95], v[52:55]
  ds_read_b64_tr_b16 a[64:65], v28 offset:32768
  ds_read_b64_tr_b16 a[66:67], v28 offset:34816
  v_mfma_f32_16x16x32_bf16 v[56:59], a[84:87], a[88:91], v[56:59]
  ds_read_b64_tr_b16 a[68:69], v29 offset:32768
  ds_read_b64_tr_b16 a[70:71], v29 offset:34816
  v_mfma_f32_16x16x32_bf16 v[60:63], a[84:87], a[92:95], v[60:63]
  s_waitcnt lgkmcnt(12)
  v_mfma_f32_16x16x32_bf16 v[48:51], a[96:99], a[104:107], v[48:51]
  ds_read_b128 a[88:91], v3 offset:9216
  ds_read_b128 a[92:95], v3 offset:25600
  v_mfma_f32_16x16x32_bf16 v[52:55], a[96:99], a[108:111], v[52:55]
  ds_read_b64_tr_b16 a[80:81], v28 offset:36864
  ds_read_b64_tr_b16 a[82:83], v28 offset:38912
  v_mfma_f32_16x16x32_bf16 v[56:59], a[100:103], a[104:107], v[56:59]
  ds_read_b64_tr_b16 a[84:85], v29 offset:36864
  ds_read_b64_tr_b16 a[86:87], v29 offset:38912
  v_mfma_f32_16x16x32_bf16 v[60:63], a[100:103], a[108:111], v[60:63]
  s_waitcnt lgkmcnt(12)
  v_mfma_f32_16x16x32_bf16 v[48:51], a[112:115], a[120:123], v[48:51]
  ds_read_b128 a[104:107], v3 offset:10240
  ds_read_b128 a[108:111], v3 offset:26624
  v_mfma_f32_16x16x32_bf16 v[52:55], a[112:115], a[124:127], v[52:55]
  ds_read_b64_tr_b16 a[96:97], v28 offset:40960
  ds_read_b64_tr_b16 a[98:99], v28 offset:43008
  v_mfma_f32_16x16x32_bf16 v[56:59], a[116:119], a[120:123], v[56:59]
  ds_read_b64_tr_b16 a[100:101], v29 offset:40960
  ds_read_b64_tr_b16 a[102:103], v29 offset:43008
  v_mfma_f32_16x16x32_bf16 v[60:63], a[116:119], a[124:127], v[60:63]
  s_waitcnt lgkmcnt(12)
  v_mfma_f32_16x16x32_bf16 v[48:51], a[64:67], a[72:75], v[48:51]
  ds_read_b128 a[120:123], v3 offset:11264
  ds_read_b128 a[124:127], v3 offset:27648
  v_mfma_f32_16x16x32_bf16 v[52:55], a[64:67], a[76:79], v[52:55]
  ds_read_b64_tr_b16 a[112:113], v28 offset:45056
  ds_read_b64_tr_b16 a[114:115], v28 offset:47104
  v_mfma_f32_16x16x32_bf16 v[56:59], a[68:71], a[72:75], v[56:59]
  ds_read_b64_tr_b16 a[116:117], v29 offset:45056
  ds_read_b64_tr_b16 a[118:119], v29 offset:47104
  v_mfma_f32_16x16x32_bf16 v[60:63], a[68:71], a[76:79], v[60:63]
  s_waitcnt lgkmcnt(12)
  v_mfma_f32_16x16x32_bf16 v[48:51], a[80:83], a[88:91], v[48:51]
  ds_read_b128 a[72:75], v3 offset:12288
  ds_read_b128 a[76:79], v3 offset:28672
  v_mfma_f32_16x16x32_bf16 v[52:55], a[80:83], a[92:95], v[52:55]
  ds_read_b64_tr_b16 a[64:65], v28 offset:49152
  ds_read_b64_tr_b16 a[66:67], v28 offset:51200
  v_mfma_f32_16x16x32_bf16 v[56:59], a[84:87], a[88:91], v[56:59]
  ds_read_b64_tr_b16 a[68:69], v29 offset:49152
  ds_read_b64_tr_b16 a[70:71], v29 offset:51200
  v_mfma_f32_16x16x32_bf16 v[60:63], a[84:87], a[92:95], v[60:63]
  s_waitcnt lgkmcnt(12)
  v_mfma_f32_16x16x32_bf16 v[48:51], a[96:99], a[104:107], v[48:51]
  ds_read_b128 a[88:91], v3 offset:13312
  ds_read_b128 a[92:95], v3 offset:29696
  v_mfma_f32_16x16x32_bf16 v[52:55], a[96:99], a[108:111], v[52:55]
  ds_read_b64_tr_b16 a[80:81], v28 offset:53248
  ds_read_b64_tr_b16 a[82:83], v28 offset:55296
  v_mfma_f32_16x16x32_bf16 v[56:59], a[100:103], a[104:107], v[56:59]
  ds_read_b64_tr_b16 a[84:85], v29 offset:53248
  ds_read_b64_tr_b16 a[86:87], v29 offset:55296
  v_mfma_f32_16x16x32_bf16 v[60:63], a[100:103], a[108:111], v[60:63]
  s_waitcnt lgkmcnt(12)
  v_mfma_f32_16x16x32_bf16 v[48:51], a[112:115], a[120:123], v[48:51]
  ds_read_b128 a[104:107], v3 offset:14336
  ds_read_b128 a[108:111], v3 offset:30720
  v_mfma_f32_16x16x32_bf16 v[52:55], a[112:115], a[124:127], v[52:55]
  ds_read_b64_tr_b16 a[96:97], v28 offset:57344
  ds_read_b64_tr_b16 a[98:99], v28 offset:59392
  v_mfma_f32_16x16x32_bf16 v[56:59], a[116:119], a[120:123], v[56:59]
  ds_read_b64_tr_b16 a[100:101], v29 offset:57344
  ds_read_b64_tr_b16 a[102:103], v29 offset:59392
  v_mfma_f32_16x16x32_bf16 v[60:63], a[116:119], a[124:127], v[60:63]
  s_waitcnt lgkmcnt(12)
  v_mfma_f32_16x16x32_bf16 v[48:51], a[64:67], a[72:75], v[48:51]
  ds_read_b128 a[120:123], v3 offset:15360
  ds_read_b128 a[124:127], v3 offset:31744
  v_mfma_f32_16x16x32_bf16 v[52:55], a[64:67], a[76:79], v[52:55]
  ds_read_b64_tr_b16 a[112:113], v28 offset:61440
  ds_read_b64_tr_b16 a[114:115], v28 offset:63488
  v_mfma_f32_16x16x32_bf16 v[56:59], a[68:71], a[72:75], v[56:59]
  ds_read_b64_tr_b16 a[116:117], v29 offset:61440
  ds_read_b64_tr_b16 a[118:119], v29 offset:63488
  v_mfma_f32_16x16x32_bf16 v[60:63], a[68:71], a[76:79], v[60:63]
  s_waitcnt lgkmcnt(12)
  v_mfma_f32_16x16x32_bf16 v[48:51], a[80:83], a[88:91], v[48:51]
  v_mfma_f32_16x16x32_bf16 v[52:55], a[80:83], a[92:95], v[52:55]
  v_mfma_f32_16x16x32_bf16 v[56:59], a[84:87], a[88:91], v[56:59]
  v_mfma_f32_16x16x32_bf16 v[60:63], a[84:87], a[92:95], v[60:63]
  s_waitcnt lgkmcnt(6)
  v_mfma_f32_16x16x32_bf16 v[48:51], a[96:99], a[104:107], v[48:51]
  v_mfma_f32_16x16x32_bf16 v[52:55], a[96:99], a[108:111], v[52:55]
  v_mfma_f32_16x16x32_bf16 v[56:59], a[100:103], a[104:107], v[56:59]
  v_mfma_f32_16x16x32_bf16 v[60:63], a[100:103], a[108:111], v[60:63]
  s_waitcnt lgkmcnt(0)
  v_mfma_f32_16x16x32_bf16 v[48:51], a[112:115], a[120:123], v[48:51]
  v_mfma_f32_16x16x32_bf16 v[52:55], a[112:115], a[124:127], v[52:55]
  v_mfma_f32_16x16x32_bf16 v[56:59], a[116:119], a[120:123], v[56:59]
  v_mfma_f32_16x16x32_bf16 v[60:63], a[116:119], a[124:127], v[60:63]
  s_waitcnt lgkmcnt(0)
  s_barrier
  v_mul_f32 v108, v105, v105
  s_add_u32 m0, s61, 32768
  s_nop 0
  buffer_load_dwordx4 v20, s[20:23], s60 offen offset:0  lds
  v_mul_f32 v109, 3222493025, v105
  v_rcp_f32 v110, v105
  v_mul_f32 v108, v108, v109
  v_mul_f32 v108, 1027024659, v108
  v_mul_f32 v112, v107, v107
  buffer_load_dwordx4 v21, s[20:23], s60 offen offset:1024  lds
  v_mul_f32 v113, 3222493025, v107
  v_rcp_f32 v114, v107
  v_mul_f32 v112, v112, v113
  v_mul_f32 v112, 1027024659, v112
  v_pk_mul_f32 v[64:65], v[48:49], v[48:49]
  v_pk_mul_f32 v[66:67], v[50:51], v[50:51]
  buffer_load_dwordx4 v22, s[20:23], s60 offen offset:2048  lds
  v_pk_mul_f32 v[68:69], v[52:53], v[52:53]
  v_pk_mul_f32 v[70:71], v[54:55], v[54:55]
  v_pk_fma_f32 v[64:65], v[64:65], v[108:109], v[108:109] op_sel:[0,0,1] op_sel_hi:[1,0,1]
  v_pk_fma_f32 v[66:67], v[66:67], v[108:109], v[108:109] op_sel:[0,0,1] op_sel_hi:[1,0,1]
  v_pk_fma_f32 v[68:69], v[68:69], v[112:113], v[112:113] op_sel:[0,0,1] op_sel_hi:[1,0,1]
  v_pk_fma_f32 v[70:71], v[70:71], v[112:113], v[112:113] op_sel:[0,0,1] op_sel_hi:[1,0,1]
  buffer_load_dwordx4 v23, s[20:23], s60 offen offset:3072  lds
  v_pk_mul_f32 v[64:65], v[64:65], v[48:49]
  v_pk_mul_f32 v[66:67], v[66:67], v[50:51]
  v_pk_mul_f32 v[68:69], v[68:69], v[52:53]
  v_pk_mul_f32 v[70:71], v[70:71], v[54:55]
  v_exp_f32 v64, v64
  s_add_u32 s60, s60, 32768
  s_add_u32 m0, s61, 36864
  s_nop 0
  buffer_load_dwordx4 v20, s[20:23], s60 offen offset:0  lds
  v_exp_f32 v65, v65
  v_exp_f32 v66, v66
  v_exp_f32 v67, v67
  v_exp_f32 v68, v68
  v_exp_f32 v69, v69
  v_exp_f32 v70, v70
  buffer_load_dwordx4 v21, s[20:23], s60 offen offset:1024  lds
  v_exp_f32 v71, v71
  v_pk_fma_f32 v[64:65], v[64:65], v[110:111], v[110:111] op_sel_hi:[1,0,0]
  v_pk_fma_f32 v[66:67], v[66:67], v[110:111], v[110:111] op_sel_hi:[1,0,0]
  v_pk_fma_f32 v[68:69], v[68:69], v[114:115], v[114:115] op_sel_hi:[1,0,0]
  v_pk_fma_f32 v[70:71], v[70:71], v[114:115], v[114:115] op_sel_hi:[1,0,0]
  v_rcp_f32 v64, v64
  buffer_load_dwordx4 v22, s[20:23], s60 offen offset:2048  lds
  v_rcp_f32 v65, v65
  v_rcp_f32 v66, v66
  v_rcp_f32 v67, v67
  v_rcp_f32 v68, v68
  v_rcp_f32 v69, v69
  buffer_load_dwordx4 v23, s[20:23], s60 offen offset:3072  lds
  v_rcp_f32 v70, v70
  v_rcp_f32 v71, v71
  v_pk_mul_f32 v[48:49], v[64:65], v[48:49]
  v_pk_mul_f32 v[50:51], v[66:67], v[50:51]
  v_pk_mul_f32 v[52:53], v[68:69], v[52:53]
  v_pk_mul_f32 v[54:55], v[70:71], v[54:55]
  s_add_u32 s60, s60, 229376
  s_add_u32 m0, s61, 65536
  s_nop 0
  buffer_load_dwordx4 v20, s[20:23], s60 offen offset:0  lds
  v_pk_mul_f32 v[64:65], v[56:57], v[56:57]
  v_pk_mul_f32 v[66:67], v[58:59], v[58:59]
  v_pk_mul_f32 v[68:69], v[60:61], v[60:61]
  v_pk_mul_f32 v[70:71], v[62:63], v[62:63]
  v_pk_fma_f32 v[64:65], v[64:65], v[108:109], v[108:109] op_sel:[0,0,1] op_sel_hi:[1,0,1]
  v_pk_fma_f32 v[66:67], v[66:67], v[108:109], v[108:109] op_sel:[0,0,1] op_sel_hi:[1,0,1]
  buffer_load_dwordx4 v21, s[20:23], s60 offen offset:1024  lds
  v_pk_fma_f32 v[68:69], v[68:69], v[112:113], v[112:113] op_sel:[0,0,1] op_sel_hi:[1,0,1]
  v_pk_fma_f32 v[70:71], v[70:71], v[112:113], v[112:113] op_sel:[0,0,1] op_sel_hi:[1,0,1]
  v_pk_mul_f32 v[64:65], v[64:65], v[56:57]
  v_pk_mul_f32 v[66:67], v[66:67], v[58:59]
  v_pk_mul_f32 v[68:69], v[68:69], v[60:61]
  buffer_load_dwordx4 v22, s[20:23], s60 offen offset:2048  lds
  v_pk_mul_f32 v[70:71], v[70:71], v[62:63]
  v_exp_f32 v64, v64
  v_exp_f32 v65, v65
  v_exp_f32 v66, v66
  v_exp_f32 v67, v67
  v_exp_f32 v68, v68
  buffer_load_dwordx4 v23, s[20:23], s60 offen offset:3072  lds
  v_exp_f32 v69, v69
  v_exp_f32 v70, v70
  v_exp_f32 v71, v71
  v_pk_fma_f32 v[64:65], v[64:65], v[110:111], v[110:111] op_sel_hi:[1,0,0]
  v_pk_fma_f32 v[66:67], v[66:67], v[110:111], v[110:111] op_sel_hi:[1,0,0]
  v_pk_fma_f32 v[68:69], v[68:69], v[114:115], v[114:115] op_sel_hi:[1,0,0]
  s_add_u32 s60, s60, 32768
  s_add_u32 m0, s61, 69632
  ds_read_b128 a[64:67], v2 offset:0
  ds_read_b128 a[68:71], v2 offset:16384
  v_pk_fma_f32 v[70:71], v[70:71], v[114:115], v[114:115] op_sel_hi:[1,0,0]
  v_rcp_f32 v64, v64
  v_rcp_f32 v65, v65
  v_rcp_f32 v66, v66
  v_rcp_f32 v67, v67
  ds_read_b128 a[72:75], v2 offset:32768
  ds_read_b128 a[76:79], v2 offset:49152
  v_rcp_f32 v68, v68
  v_rcp_f32 v69, v69
  v_rcp_f32 v70, v70
  v_rcp_f32 v71, v71
  v_pk_mul_f32 v[56:57], v[64:65], v[56:57]
  v_pk_mul_f32 v[58:59], v[66:67], v[58:59]
  s_waitcnt vmcnt(12)
  ds_read_b64_tr_b16 a[0:1], v4 offset:0
  ds_read_b64_tr_b16 a[2:3], v4 offset:4096
  v_pk_mul_f32 v[60:61], v[68:69], v[60:61]
  v_pk_mul_f32 v[62:63], v[70:71], v[62:63]
  v_cvt_pk_bf16_f32 v80, v48, v49
  v_cvt_pk_bf16_f32 v81, v50, v51
  v_cvt_pk_bf16_f32 v82, v56, v57
  v_cvt_pk_bf16_f32 v83, v58, v59
  ds_read_b64_tr_b16 a[4:5], v5 offset:0
  ds_read_b64_tr_b16 a[6:7], v5 offset:4096
  buffer_store_dwordx4 v[80:83], v116, s[52:55], s76 offen offset:0 sc1
  v_cvt_pk_bf16_f32 v84, v52, v53
  v_cvt_pk_bf16_f32 v85, v54, v55
  v_cvt_pk_bf16_f32 v86, v60, v61
  v_cvt_pk_bf16_f32 v87, v62, v63
  ds_read_b64_tr_b16 a[8:9], v6 offset:0
  ds_read_b64_tr_b16 a[10:11], v6 offset:4096
  buffer_store_dwordx4 v[84:87], v116, s[52:55], s76 offen offset:256 sc1
  v_mul_f32 v48, 1040356334, v96
  v_mul_f32 v50, 1040356334, v98
  v_mul_f32 v52, 1040356334, v100
  v_mul_f32 v54, 1040356334, v102
  v_lshlrev_b32 v64, 16, v32
  ds_read_b64_tr_b16 a[12:13], v7 offset:0
  ds_read_b64_tr_b16 a[14:15], v7 offset:4096
  v_and_b32 v65, 0xffff0000, v32
  v_lshlrev_b32 v66, 16, v33
  v_and_b32 v67, 0xffff0000, v33
  v_lshlrev_b32 v68, 16, v34
  v_and_b32 v69, 0xffff0000, v34
  v_lshlrev_b32 v70, 16, v35
  ds_read_b64_tr_b16 a[16:17], v8 offset:0
  ds_read_b64_tr_b16 a[18:19], v8 offset:4096
  v_and_b32 v71, 0xffff0000, v35
  v_lshlrev_b32 v72, 16, v36
  v_and_b32 v73, 0xffff0000, v36
  v_lshlrev_b32 v74, 16, v37
  v_and_b32 v75, 0xffff0000, v37
  ds_read_b64_tr_b16 a[20:21], v9 offset:0
  ds_read_b64_tr_b16 a[22:23], v9 offset:4096
  v_lshlrev_b32 v76, 16, v38
  v_and_b32 v77, 0xffff0000, v38
  v_lshlrev_b32 v78, 16, v39
  v_and_b32 v79, 0xffff0000, v39
  v_pk_mul_f32 v[64:65], v[64:65], v[104:105] op_sel_hi:[1,0]
  v_pk_mul_f32 v[66:67], v[66:67], v[104:105] op_sel_hi:[1,0]
  ds_read_b64_tr_b16 a[24:25], v10 offset:0
  ds_read_b64_tr_b16 a[26:27], v10 offset:4096
  v_pk_mul_f32 v[68:69], v[68:69], v[104:105] op_sel_hi:[1,0]
  v_pk_mul_f32 v[70:71], v[70:71], v[104:105] op_sel_hi:[1,0]
  v_pk_mul_f32 v[72:73], v[72:73], v[106:107] op_sel_hi:[1,0]
  v_pk_mul_f32 v[74:75], v[74:75], v[106:107] op_sel_hi:[1,0]
  v_pk_mul_f32 v[76:77], v[76:77], v[106:107] op_sel_hi:[1,0]
  v_pk_mul_f32 v[78:79], v[78:79], v[106:107] op_sel_hi:[1,0]
  ds_read_b64_tr_b16 a[28:29], v11 offset:0
  ds_read_b64_tr_b16 a[30:31], v11 offset:4096
  v_cvt_pk_bf16_f32 v32, v64, v65
  v_cvt_pk_bf16_f32 v33, v66, v67
  v_cvt_pk_bf16_f32 v34, v68, v69
  v_cvt_pk_bf16_f32 v35, v70, v71
  v_cvt_pk_bf16_f32 v36, v72, v73
  v_cvt_pk_bf16_f32 v37, v74, v75
  v_cvt_pk_bf16_f32 v38, v76, v77
  v_cvt_pk_bf16_f32 v39, v78, v79
  buffer_load_dwordx4 v20, s[20:23], s60 offen offset:0  lds
  buffer_load_dwordx4 v21, s[20:23], s60 offen offset:1024  lds
  buffer_load_dwordx4 v22, s[20:23], s60 offen offset:2048  lds
  buffer_load_dwordx4 v23, s[20:23], s60 offen offset:3072  lds
  s_add_u32 s60, s60, 229376
  s_cmp_lg_u32 s3, 0
  s_cbranch_scc1 L_pad_2
  v_lshl_add_u32 v30, v1, 7, s88
  s_mov_b64 exec, 3
  v_mov_b32 v88, 0
  v_mov_b32 v89, 0
  v_mov_b32 v90, 0
  v_mov_b32 v91, 0
  buffer_store_dword v88, v30, s[52:55], 0 offen sc1
  s_mov_b64 exec, -1
  s_add_u32 s57, s4, 1
  s_and_b32 s57, s57, 30
  s_cmp_lg_u32 s57, 0
  s_cbranch_scc1 L_pad_2
  s_cmp_eq_u32 s4, 0
  s_cselect_b32 s57, 0, 32896
  s_mul_i32 s56, s5, 264192
  s_add_u32 s56, s56, s57
  v_lshrrev_b32 v30, 3, v1
  v_mul_u32_u24 v30, 33024, v30
  v_and_b32 v31, 0x70, v0
  v_add_u32 v30, v30, v31
  v_mov_b32 v88, 0
  v_mov_b32 v89, 0
  v_mov_b32 v90, 0
  v_mov_b32 v91, 0
  buffer_store_dwordx4 v[88:91], v30, s[52:55], s56 offen sc1
L_pad_2:
  s_waitcnt lgkmcnt(8)
  v_mfma_f32_16x16x32_bf16 v[128:131], a[0:3], a[64:67], 0
  v_mfma_f32_16x16x32_bf16 v[144:147], a[4:7], a[64:67], 0
  s_waitcnt lgkmcnt(0)
  v_mfma_f32_16x16x32_bf16 v[148:151], a[4:7], a[68:71], 0
  s_add_u32 m0, s61, 0
  v_mfma_f32_16x16x32_bf16 v[132:135], a[0:3], a[68:71], 0
  buffer_load_dwordx4 v20, s[20:23], s60 offen offset:0  lds
  v_mfma_f32_16x16x32_bf16 v[136:139], a[0:3], a[72:75], 0
  v_mfma_f32_16x16x32_bf16 v[152:155], a[4:7], a[72:75], 0
  v_mfma_f32_16x16x32_bf16 v[156:159], a[4:7], a[76:79], 0
  buffer_load_dwordx4 v21, s[20:23], s60 offen offset:1024  lds
  v_mfma_f32_16x16x32_bf16 v[140:143], a[0:3], a[76:79], 0
  v_mfma_f32_16x16x32_bf16 v[168:171], a[8:11], a[72:75], 0
  s_waitcnt vmcnt(12)
  v_mfma_f32_16x16x32_bf16 v[184:187], a[12:15], a[72:75], 0
  ds_read_b128 a[80:83], v2 offset:1024
  ds_read_b128 a[84:87], v2 offset:17408
  v_mfma_f32_16x16x32_bf16 v[188:191], a[12:15], a[76:79], 0
  buffer_load_dwordx4 v22, s[20:23], s60 offen offset:2048  lds
  v_mfma_f32_16x16x32_bf16 v[172:175], a[8:11], a[76:79], 0
  ds_read_b64_tr_b16 a[32:33], v4 offset:32768
  ds_read_b64_tr_b16 a[34:35], v4 offset:36864
  v_mfma_f32_16x16x32_bf16 v[160:163], a[8:11], a[64:67], 0
  v_mfma_f32_16x16x32_bf16 v[176:179], a[12:15], a[64:67], 0
  ds_read_b128 a[88:91], v2 offset:33792
  ds_read_b128 a[92:95], v2 offset:50176
  v_mfma_f32_16x16x32_bf16 v[180:183], a[12:15], a[68:71], 0
  buffer_load_dwordx4 v23, s[20:23], s60 offen offset:3072  lds
  v_mfma_f32_16x16x32_bf16 v[164:167], a[8:11], a[68:71], 0
  ds_read_b64_tr_b16 a[36:37], v5 offset:32768
  ds_read_b64_tr_b16 a[38:39], v5 offset:36864
  v_mfma_f32_16x16x32_bf16 v[192:195], a[16:19], a[64:67], 0
  s_add_u32 s60, s60, 32768
  v_mfma_f32_16x16x32_bf16 v[208:211], a[20:23], a[64:67], 0
  s_add_u32 m0, s61, 4096
  v_mfma_f32_16x16x32_bf16 v[212:215], a[20:23], a[68:71], 0
  buffer_load_dwordx4 v20, s[20:23], s60 offen offset:0  lds
  v_mfma_f32_16x16x32_bf16 v[196:199], a[16:19], a[68:71], 0
  ds_read_b64_tr_b16 a[40:41], v6 offset:32768
  ds_read_b64_tr_b16 a[42:43], v6 offset:36864
  v_mfma_f32_16x16x32_bf16 v[200:203], a[16:19], a[72:75], 0
  v_mfma_f32_16x16x32_bf16 v[216:219], a[20:23], a[72:75], 0
  ds_read_b64_tr_b16 a[44:45], v7 offset:32768
  ds_read_b64_tr_b16 a[46:47], v7 offset:36864
  v_mfma_f32_16x16x32_bf16 v[220:223], a[20:23], a[76:79], 0
  buffer_load_dwordx4 v21, s[20:23], s60 offen offset:1024  lds
  v_mfma_f32_16x16x32_bf16 v[204:207], a[16:19], a[76:79], 0
  ds_read_b64_tr_b16 a[48:49], v8 offset:32768
  ds_read_b64_tr_b16 a[50:51], v8 offset:36864
  v_mfma_f32_16x16x32_bf16 v[232:235], a[24:27], a[72:75], 0
  ds_read_b64_tr_b16 a[52:53], v9 offset:32768
  ds_read_b64_tr_b16 a[54:55], v9 offset:36864
  v_mfma_f32_16x16x32_bf16 v[248:251], a[28:31], a[72:75], 0
  ds_read_b64_tr_b16 a[56:57], v10 offset:32768
  ds_read_b64_tr_b16 a[58:59], v10 offset:36864
  v_mfma_f32_16x16x32_bf16 v[252:255], a[28:31], a[76:79], 0
  buffer_load_dwordx4 v22, s[20:23], s60 offen offset:2048  lds
  v_mfma_f32_16x16x32_bf16 v[236:239], a[24:27], a[76:79], 0
  ds_read_b64_tr_b16 a[60:61], v11 offset:32768
  ds_read_b64_tr_b16 a[62:63], v11 offset:36864
  v_lshrrev_b32 v30, 3, v1
  v_mul_u32_u24 v30, 1024, v30
  v_mfma_f32_16x16x32_bf16 v[224:227], a[24:27], a[64:67], 0
  v_lshrrev_b32 v31, 4, v1
  v_lshlrev_b32 v31, 5, v31
  v_mfma_f32_16x16x32_bf16 v[240:243], a[28:31], a[64:67], 0
  v_and_b32 v40, 0x70, v0
  v_xor_b32 v31, v31, v40
  v_mfma_f32_16x16x32_bf16 v[244:247], a[28:31], a[68:71], 0
  buffer_load_dwordx4 v23, s[20:23], s60 offen offset:3072  lds
  v_add_u32 v24, v30, v31
  v_add_u32 v25, 7168, v24
  v_mfma_f32_16x16x32_bf16 v[228:231], a[24:27], a[68:71], 0
  s_add_u32 s60, s60, 229376
  v_add_u32 v26, 14336, v24
  v_add_u32 v27, 21504, v24
  s_waitcnt lgkmcnt(8)
  v_mfma_f32_16x16x32_bf16 v[128:131], a[32:35], a[80:83], v[128:131]
  v_mfma_f32_16x16x32_bf16 v[144:147], a[36:39], a[80:83], v[144:147]
  s_waitcnt lgkmcnt(0)
  v_mfma_f32_16x16x32_bf16 v[148:151], a[36:39], a[84:87], v[148:151]
  s_add_u32 m0, s61, 32768
  v_mfma_f32_16x16x32_bf16 v[132:135], a[32:35], a[84:87], v[132:135]
  buffer_load_dwordx4 v20, s[20:23], s60 offen offset:0  lds
  v_mfma_f32_16x16x32_bf16 v[136:139], a[32:35], a[88:91], v[136:139]
  v_mfma_f32_16x16x32_bf16 v[152:155], a[36:39], a[88:91], v[152:155]
  v_mfma_f32_16x16x32_bf16 v[156:159], a[36:39], a[92:95], v[156:159]
  buffer_load_dwordx4 v21, s[20:23], s60 offen offset:1024  lds
  v_mfma_f32_16x16x32_bf16 v[140:143], a[32:35], a[92:95], v[140:143]
  v_mfma_f32_16x16x32_bf16 v[168:171], a[40:43], a[88:91], v[168:171]
  s_waitcnt vmcnt(10)
  v_mfma_f32_16x16x32_bf16 v[184:187], a[44:47], a[88:91], v[184:187]
  ds_read_b128 a[64:67], v2 offset:2048
  ds_read_b128 a[68:71], v2 offset:18432
  v_mfma_f32_16x16x32_bf16 v[188:191], a[44:47], a[92:95], v[188:191]
  buffer_load_dwordx4 v22, s[20:23], s60 offen offset:2048  lds
  v_mfma_f32_16x16x32_bf16 v[172:175], a[40:43], a[92:95], v[172:175]
  ds_read_b64_tr_b16 a[0:1], v12 offset:0
  ds_read_b64_tr_b16 a[2:3], v12 offset:4096
  v_mfma_f32_16x16x32_bf16 v[160:163], a[40:43], a[80:83], v[160:163]
  v_mfma_f32_16x16x32_bf16 v[176:179], a[44:47], a[80:83], v[176:179]
  ds_read_b128 a[72:75], v2 offset:34816
  ds_read_b128 a[76:79], v2 offset:51200
  v_mfma_f32_16x16x32_bf16 v[180:183], a[44:47], a[84:87], v[180:183]
  buffer_load_dwordx4 v23, s[20:23], s60 offen offset:3072  lds
  v_mfma_f32_16x16x32_bf16 v[164:167], a[40:43], a[84:87], v[164:167]
  ds_read_b64_tr_b16 a[4:5], v13 offset:0
  ds_read_b64_tr_b16 a[6:7], v13 offset:4096
  v_mfma_f32_16x16x32_bf16 v[192:195], a[48:51], a[80:83], v[192:195]
  s_add_u32 s60, s60, 32768
  v_mfma_f32_16x16x32_bf16 v[208:211], a[52:55], a[80:83], v[208:211]
  s_add_u32 m0, s61, 36864
  v_mfma_f32_16x16x32_bf16 v[212:215], a[52:55], a[84:87], v[212:215]
  buffer_load_dwordx4 v20, s[20:23], s60 offen offset:0  lds
  v_mfma_f32_16x16x32_bf16 v[196:199], a[48:51], a[84:87], v[196:199]
  ds_read_b64_tr_b16 a[8:9], v14 offset:0
  ds_read_b64_tr_b16 a[10:11], v14 offset:4096
  v_mfma_f32_16x16x32_bf16 v[200:203], a[48:51], a[88:91], v[200:203]
  v_mfma_f32_16x16x32_bf16 v[216:219], a[52:55], a[88:91], v[216:219]
  ds_read_b64_tr_b16 a[12:13], v15 offset:0
  ds_read_b64_tr_b16 a[14:15], v15 offset:4096
  v_mfma_f32_16x16x32_bf16 v[220:223], a[52:55], a[92:95], v[220:223]
  buffer_load_dwordx4 v21, s[20:23], s60 offen offset:1024  lds
  v_mfma_f32_16x16x32_bf16 v[204:207], a[48:51], a[92:95], v[204:207]
  ds_read_b64_tr_b16 a[16:17], v16 offset:0
  ds_read_b64_tr_b16 a[18:19], v16 offset:4096
  v_mfma_f32_16x16x32_bf16 v[232:235], a[56:59], a[88:91], v[232:235]
  ds_read_b64_tr_b16 a[20:21], v17 offset:0
  ds_read_b64_tr_b16 a[22:23], v17 offset:4096
  v_mfma_f32_16x16x32_bf16 v[248:251], a[60:63], a[88:91], v[248:251]
  ds_read_b64_tr_b16 a[24:25], v18 offset:0
  ds_read_b64_tr_b16 a[26:27], v18 offset:4096
  v_mfma_f32_16x16x32_bf16 v[252:255], a[60:63], a[92:95], v[252:255]
  buffer_load_dwordx4 v22, s[20:23], s60 offen offset:2048  lds
  v_mfma_f32_16x16x32_bf16 v[236:239], a[56:59], a[92:95], v[236:239]
  ds_read_b64_tr_b16 a[28:29], v19 offset:0
  ds_read_b64_tr_b16 a[30:31], v19 offset:4096
  v_mfma_f32_16x16x32_bf16 v[224:227], a[56:59], a[80:83], v[224:227]
  v_mfma_f32_16x16x32_bf16 v[240:243], a[60:63], a[80:83], v[240:243]
  v_mfma_f32_16x16x32_bf16 v[244:247], a[60:63], a[84:87], v[244:247]
  buffer_load_dwordx4 v23, s[20:23], s60 offen offset:3072  lds
  v_mfma_f32_16x16x32_bf16 v[228:231], a[56:59], a[84:87], v[228:231]
  s_add_u32 s60, s60, 229376
  s_waitcnt lgkmcnt(8)
  v_mfma_f32_16x16x32_bf16 v[128:131], a[0:3], a[64:67], v[128:131]
  v_mfma_f32_16x16x32_bf16 v[144:147], a[4:7], a[64:67], v[144:147]
  s_waitcnt lgkmcnt(0)
  v_mfma_f32_16x16x32_bf16 v[148:151], a[4:7], a[68:71], v[148:151]
  s_add_u32 m0, s61, 65536
  v_mfma_f32_16x16x32_bf16 v[132:135], a[0:3], a[68:71], v[132:135]
  buffer_load_dwordx4 v20, s[20:23], s60 offen offset:0  lds
  v_mfma_f32_16x16x32_bf16 v[136:139], a[0:3], a[72:75], v[136:139]
  v_mfma_f32_16x16x32_bf16 v[152:155], a[4:7], a[72:75], v[152:155]
  v_mfma_f32_16x16x32_bf16 v[156:159], a[4:7], a[76:79], v[156:159]
  buffer_load_dwordx4 v21, s[20:23], s60 offen offset:1024  lds
  v_mfma_f32_16x16x32_bf16 v[140:143], a[0:3], a[76:79], v[140:143]
  v_mfma_f32_16x16x32_bf16 v[168:171], a[8:11], a[72:75], v[168:171]
  s_waitcnt vmcnt(10)
  s_barrier
  s_mov_b32 s56, s3
  s_cmp_lg_u32 s56, 0
  s_cbranch_scc1 L_sig_3
  s_lshl_b32 s56, s4, 3
  v_mov_b32 v30, s56
  v_mov_b32 v31, 1
  s_mov_b64 exec, 1
  buffer_atomic_add v31, v30, s[48:51], 0 offen sc1
  s_mov_b64 exec, -1
L_sig_3:
  v_mfma_f32_16x16x32_bf16 v[184:187], a[12:15], a[72:75], v[184:187]
  ds_read_b128 a[80:83], v2 offset:3072
  ds_read_b128 a[84:87], v2 offset:19456
  v_mfma_f32_16x16x32_bf16 v[188:191], a[12:15], a[76:79], v[188:191]
  buffer_load_dwordx4 v22, s[20:23], s60 offen offset:2048  lds
  v_mfma_f32_16x16x32_bf16 v[172:175], a[8:11], a[76:79], v[172:175]
  ds_read_b64_tr_b16 a[32:33], v4 offset:0
  ds_read_b64_tr_b16 a[34:35], v4 offset:4096
  v_mfma_f32_16x16x32_bf16 v[160:163], a[8:11], a[64:67], v[160:163]
  v_mfma_f32_16x16x32_bf16 v[176:179], a[12:15], a[64:67], v[176:179]
  ds_read_b128 a[88:91], v2 offset:35840
  ds_read_b128 a[92:95], v2 offset:52224
  v_mfma_f32_16x16x32_bf16 v[180:183], a[12:15], a[68:71], v[180:183]
  buffer_load_dwordx4 v23, s[20:23], s60 offen offset:3072  lds
  v_mfma_f32_16x16x32_bf16 v[164:167], a[8:11], a[68:71], v[164:167]
  ds_read_b64_tr_b16 a[36:37], v5 offset:0
  ds_read_b64_tr_b16 a[38:39], v5 offset:4096
  v_mfma_f32_16x16x32_bf16 v[192:195], a[16:19], a[64:67], v[192:195]
  s_add_u32 s60, s60, 32768
  v_mfma_f32_16x16x32_bf16 v[208:211], a[20:23], a[64:67], v[208:211]
  s_add_u32 m0, s61, 69632
  v_mfma_f32_16x16x32_bf16 v[212:215], a[20:23], a[68:71], v[212:215]
  buffer_load_dwordx4 v20, s[20:23], s60 offen offset:0  lds
  v_mfma_f32_16x16x32_bf16 v[196:199], a[16:19], a[68:71], v[196:199]
  ds_read_b64_tr_b16 a[40:41], v6 offset:0
  ds_read_b64_tr_b16 a[42:43], v6 offset:4096
  v_mfma_f32_16x16x32_bf16 v[200:203], a[16:19], a[72:75], v[200:203]
  v_mfma_f32_16x16x32_bf16 v[216:219], a[20:23], a[72:75], v[216:219]
  ds_read_b64_tr_b16 a[44:45], v7 offset:0
  ds_read_b64_tr_b16 a[46:47], v7 offset:4096
  v_mfma_f32_16x16x32_bf16 v[220:223], a[20:23], a[76:79], v[220:223]
  buffer_load_dwordx4 v21, s[20:23], s60 offen offset:1024  lds
  v_mfma_f32_16x16x32_bf16 v[204:207], a[16:19], a[76:79], v[204:207]
  ds_read_b64_tr_b16 a[48:49], v8 offset:0
  ds_read_b64_tr_b16 a[50:51], v8 offset:4096
  v_mfma_f32_16x16x32_bf16 v[232:235], a[24:27], a[72:75], v[232:235]
  ds_read_b64_tr_b16 a[52:53], v9 offset:0
  ds_read_b64_tr_b16 a[54:55], v9 offset:4096
  v_mfma_f32_16x16x32_bf16 v[248:251], a[28:31], a[72:75], v[248:251]
  ds_read_b64_tr_b16 a[56:57], v10 offset:0
  ds_read_b64_tr_b16 a[58:59], v10 offset:4096
  v_mfma_f32_16x16x32_bf16 v[252:255], a[28:31], a[76:79], v[252:255]
  buffer_load_dwordx4 v22, s[20:23], s60 offen offset:2048  lds
  v_mfma_f32_16x16x32_bf16 v[236:239], a[24:27], a[76:79], v[236:239]
  ds_read_b64_tr_b16 a[60:61], v11 offset:0
  ds_read_b64_tr_b16 a[62:63], v11 offset:4096
  v_mfma_f32_16x16x32_bf16 v[224:227], a[24:27], a[64:67], v[224:227]
  v_mfma_f32_16x16x32_bf16 v[240:243], a[28:31], a[64:67], v[240:243]
  v_mfma_f32_16x16x32_bf16 v[244:247], a[28:31], a[68:71], v[244:247]
  buffer_load_dwordx4 v23, s[20:23], s60 offen offset:3072  lds
  v_mfma_f32_16x16x32_bf16 v[228:231], a[24:27], a[68:71], v[228:231]
  s_add_u32 s60, s60, 229376
  s_waitcnt lgkmcnt(8)
  v_mfma_f32_16x16x32_bf16 v[128:131], a[32:35], a[80:83], v[128:131]
  v_mfma_f32_16x16x32_bf16 v[144:147], a[36:39], a[80:83], v[144:147]
  s_waitcnt lgkmcnt(0)
  v_mfma_f32_16x16x32_bf16 v[148:151], a[36:39], a[84:87], v[148:151]
  s_add_u32 m0, s61, 0
  v_mfma_f32_16x16x32_bf16 v[132:135], a[32:35], a[84:87], v[132:135]
  buffer_load_dwordx4 v20, s[20:23], s60 offen offset:0  lds
  v_mfma_f32_16x16x32_bf16 v[136:139], a[32:35], a[88:91], v[136:139]
  v_mfma_f32_16x16x32_bf16 v[152:155], a[36:39], a[88:91], v[152:155]
  v_mfma_f32_16x16x32_bf16 v[156:159], a[36:39], a[92:95], v[156:159]
  buffer_load_dwordx4 v21, s[20:23], s60 offen offset:1024  lds
  v_mfma_f32_16x16x32_bf16 v[140:143], a[32:35], a[92:95], v[140:143]
  v_mfma_f32_16x16x32_bf16 v[168:171], a[40:43], a[88:91], v[168:171]
  s_waitcnt vmcnt(10)
  v_mfma_f32_16x16x32_bf16 v[184:187], a[44:47], a[88:91], v[184:187]
  ds_read_b128 a[64:67], v2 offset:4096
  ds_read_b128 a[68:71], v2 offset:20480
  v_mfma_f32_16x16x32_bf16 v[188:191], a[44:47], a[92:95], v[188:191]
  buffer_load_dwordx4 v22, s[20:23], s60 offen offset:2048  lds
  v_mfma_f32_16x16x32_bf16 v[172:175], a[40:43], a[92:95], v[172:175]
  ds_read_b64_tr_b16 a[0:1], v4 offset:32768
  ds_read_b64_tr_b16 a[2:3], v4 offset:36864
  v_mfma_f32_16x16x32_bf16 v[160:163], a[40:43], a[80:83], v[160:163]
  v_mfma_f32_16x16x32_bf16 v[176:179], a[44:47], a[80:83], v[176:179]
  ds_read_b128 a[72:75], v2 offset:36864
  ds_read_b128 a[76:79], v2 offset:53248
  v_mfma_f32_16x16x32_bf16 v[180:183], a[44:47], a[84:87], v[180:183]
  buffer_load_dwordx4 v23, s[20:23], s60 offen offset:3072  lds
  v_mfma_f32_16x16x32_bf16 v[164:167], a[40:43], a[84:87], v[164:167]
  ds_read_b64_tr_b16 a[4:5], v5 offset:32768
  ds_read_b64_tr_b16 a[6:7], v5 offset:36864
  v_mfma_f32_16x16x32_bf16 v[192:195], a[48:51], a[80:83], v[192:195]
  s_add_u32 s60, s60, 32768
  v_mfma_f32_16x16x32_bf16 v[208:211], a[52:55], a[80:83], v[208:211]
  s_add_u32 m0, s61, 4096
  v_mfma_f32_16x16x32_bf16 v[212:215], a[52:55], a[84:87], v[212:215]
  buffer_load_dwordx4 v20, s[20:23], s60 offen offset:0  lds
  v_mfma_f32_16x16x32_bf16 v[196:199], a[48:51], a[84:87], v[196:199]
  ds_read_b64_tr_b16 a[8:9], v6 offset:32768
  ds_read_b64_tr_b16 a[10:11], v6 offset:36864
  v_mfma_f32_16x16x32_bf16 v[200:203], a[48:51], a[88:91], v[200:203]
  v_mfma_f32_16x16x32_bf16 v[216:219], a[52:55], a[88:91], v[216:219]
  ds_read_b64_tr_b16 a[12:13], v7 offset:32768
  ds_read_b64_tr_b16 a[14:15], v7 offset:36864
  v_mfma_f32_16x16x32_bf16 v[220:223], a[52:55], a[92:95], v[220:223]
  buffer_load_dwordx4 v21, s[20:23], s60 offen offset:1024  lds
  v_mfma_f32_16x16x32_bf16 v[204:207], a[48:51], a[92:95], v[204:207]
  ds_read_b64_tr_b16 a[16:17], v8 offset:32768
  ds_read_b64_tr_b16 a[18:19], v8 offset:36864
  v_mfma_f32_16x16x32_bf16 v[232:235], a[56:59], a[88:91], v[232:235]
  ds_read_b64_tr_b16 a[20:21], v9 offset:32768
  ds_read_b64_tr_b16 a[22:23], v9 offset:36864
  v_mfma_f32_16x16x32_bf16 v[248:251], a[60:63], a[88:91], v[248:251]
  ds_read_b64_tr_b16 a[24:25], v10 offset:32768
  ds_read_b64_tr_b16 a[26:27], v10 offset:36864
  v_mfma_f32_16x16x32_bf16 v[252:255], a[60:63], a[92:95], v[252:255]
  buffer_load_dwordx4 v22, s[20:23], s60 offen offset:2048  lds
  v_mfma_f32_16x16x32_bf16 v[236:239], a[56:59], a[92:95], v[236:239]
  ds_read_b64_tr_b16 a[28:29], v11 offset:32768
  ds_read_b64_tr_b16 a[30:31], v11 offset:36864
  v_mfma_f32_16x16x32_bf16 v[224:227], a[56:59], a[80:83], v[224:227]
  v_mfma_f32_16x16x32_bf16 v[240:243], a[60:63], a[80:83], v[240:243]
  v_mfma_f32_16x16x32_bf16 v[244:247], a[60:63], a[84:87], v[244:247]
  buffer_load_dwordx4 v23, s[20:23], s60 offen offset:3072  lds
  v_mfma_f32_16x16x32_bf16 v[228:231], a[56:59], a[84:87], v[228:231]
  s_add_u32 s60, s60, 229376
  s_waitcnt lgkmcnt(8)
  v_mfma_f32_16x16x32_bf16 v[128:131], a[0:3], a[64:67], v[128:131]
  v_mfma_f32_16x16x32_bf16 v[144:147], a[4:7], a[64:67], v[144:147]
  s_waitcnt lgkmcnt(0)
  v_mfma_f32_16x16x32_bf16 v[148:151], a[4:7], a[68:71], v[148:151]
  s_add_u32 m0, s61, 32768
  v_mfma_f32_16x16x32_bf16 v[132:135], a[0:3], a[68:71], v[132:135]
  buffer_load_dwordx4 v20, s[20:23], s60 offen offset:0  lds
  v_mfma_f32_16x16x32_bf16 v[136:139], a[0:3], a[72:75], v[136:139]
  v_mfma_f32_16x16x32_bf16 v[152:155], a[4:7], a[72:75], v[152:155]
  v_mfma_f32_16x16x32_bf16 v[156:159], a[4:7], a[76:79], v[156:159]
  buffer_load_dwordx4 v21, s[20:23], s60 offen offset:1024  lds
  v_mfma_f32_16x16x32_bf16 v[140:143], a[0:3], a[76:79], v[140:143]
  v_mfma_f32_16x16x32_bf16 v[168:171], a[8:11], a[72:75], v[168:171]
  s_waitcnt vmcnt(10)
  v_mfma_f32_16x16x32_bf16 v[184:187], a[12:15], a[72:75], v[184:187]
  ds_read_b128 a[80:83], v2 offset:5120
  ds_read_b128 a[84:87], v2 offset:21504
  v_mfma_f32_16x16x32_bf16 v[188:191], a[12:15], a[76:79], v[188:191]
  buffer_load_dwordx4 v22, s[20:23], s60 offen offset:2048  lds
  v_mfma_f32_16x16x32_bf16 v[172:175], a[8:11], a[76:79], v[172:175]
  ds_read_b64_tr_b16 a[32:33], v12 offset:0
  ds_read_b64_tr_b16 a[34:35], v12 offset:4096
  v_mfma_f32_16x16x32_bf16 v[160:163], a[8:11], a[64:67], v[160:163]
  v_mfma_f32_16x16x32_bf16 v[176:179], a[12:15], a[64:67], v[176:179]
  ds_read_b128 a[88:91], v2 offset:37888
  ds_read_b128 a[92:95], v2 offset:54272
  v_mfma_f32_16x16x32_bf16 v[180:183], a[12:15], a[68:71], v[180:183]
  buffer_load_dwordx4 v23, s[20:23], s60 offen offset:3072  lds
  v_mfma_f32_16x16x32_bf16 v[164:167], a[8:11], a[68:71], v[164:167]
  ds_read_b64_tr_b16 a[36:37], v13 offset:0
  ds_read_b64_tr_b16 a[38:39], v13 offset:4096
  v_mfma_f32_16x16x32_bf16 v[192:195], a[16:19], a[64:67], v[192:195]
  s_add_u32 s60, s60, 32768
  v_mfma_f32_16x16x32_bf16 v[208:211], a[20:23], a[64:67], v[208:211]
  s_add_u32 m0, s61, 36864
  v_mfma_f32_16x16x32_bf16 v[212:215], a[20:23], a[68:71], v[212:215]
  buffer_load_dwordx4 v20, s[20:23], s60 offen offset:0  lds
  v_mfma_f32_16x16x32_bf16 v[196:199], a[16:19], a[68:71], v[196:199]
  ds_read_b64_tr_b16 a[40:41], v14 offset:0
  ds_read_b64_tr_b16 a[42:43], v14 offset:4096
  v_mfma_f32_16x16x32_bf16 v[200:203], a[16:19], a[72:75], v[200:203]
  v_mfma_f32_16x16x32_bf16 v[216:219], a[20:23], a[72:75], v[216:219]
  ds_read_b64_tr_b16 a[44:45], v15 offset:0
  ds_read_b64_tr_b16 a[46:47], v15 offset:4096
  v_mfma_f32_16x16x32_bf16 v[220:223], a[20:23], a[76:79], v[220:223]
  buffer_load_dwordx4 v21, s[20:23], s60 offen offset:1024  lds
  v_mfma_f32_16x16x32_bf16 v[204:207], a[16:19], a[76:79], v[204:207]
  ds_read_b64_tr_b16 a[48:49], v16 offset:0
  ds_read_b64_tr_b16 a[50:51], v16 offset:4096
  v_mfma_f32_16x16x32_bf16 v[232:235], a[24:27], a[72:75], v[232:235]
  ds_read_b64_tr_b16 a[52:53], v17 offset:0
  ds_read_b64_tr_b16 a[54:55], v17 offset:4096
  v_mfma_f32_16x16x32_bf16 v[248:251], a[28:31], a[72:75], v[248:251]
  ds_read_b64_tr_b16 a[56:57], v18 offset:0
  ds_read_b64_tr_b16 a[58:59], v18 offset:4096
  v_mfma_f32_16x16x32_bf16 v[252:255], a[28:31], a[76:79], v[252:255]
  buffer_load_dwordx4 v22, s[20:23], s60 offen offset:2048  lds
  v_mfma_f32_16x16x32_bf16 v[236:239], a[24:27], a[76:79], v[236:239]
  ds_read_b64_tr_b16 a[60:61], v19 offset:0
  ds_read_b64_tr_b16 a[62:63], v19 offset:4096
  v_mfma_f32_16x16x32_bf16 v[224:227], a[24:27], a[64:67], v[224:227]
  v_mfma_f32_16x16x32_bf16 v[240:243], a[28:31], a[64:67], v[240:243]
  v_mfma_f32_16x16x32_bf16 v[244:247], a[28:31], a[68:71], v[244:247]
  buffer_load_dwordx4 v23, s[20:23], s60 offen offset:3072  lds
  v_mfma_f32_16x16x32_bf16 v[228:231], a[24:27], a[68:71], v[228:231]
  s_add_u32 s60, s60, 229376
  s_waitcnt lgkmcnt(8)
  v_mfma_f32_16x16x32_bf16 v[128:131], a[32:35], a[80:83], v[128:131]
  v_mfma_f32_16x16x32_bf16 v[144:147], a[36:39], a[80:83], v[144:147]
  s_waitcnt lgkmcnt(0)
  v_mfma_f32_16x16x32_bf16 v[148:151], a[36:39], a[84:87], v[148:151]
  s_add_u32 m0, s61, 65536
  v_mfma_f32_16x16x32_bf16 v[132:135], a[32:35], a[84:87], v[132:135]
  buffer_load_dwordx4 v20, s[20:23], s60 offen offset:0  lds
  v_mfma_f32_16x16x32_bf16 v[136:139], a[32:35], a[88:91], v[136:139]
  v_mfma_f32_16x16x32_bf16 v[152:155], a[36:39], a[88:91], v[152:155]
  v_mfma_f32_16x16x32_bf16 v[156:159], a[36:39], a[92:95], v[156:159]
  buffer_load_dwordx4 v21, s[20:23], s60 offen offset:1024  lds
  v_mfma_f32_16x16x32_bf16 v[140:143], a[32:35], a[92:95], v[140:143]
  v_mfma_f32_16x16x32_bf16 v[168:171], a[40:43], a[88:91], v[168:171]
  s_waitcnt vmcnt(10)
  v_mfma_f32_16x16x32_bf16 v[184:187], a[44:47], a[88:91], v[184:187]
  ds_read_b128 a[64:67], v2 offset:6144
  ds_read_b128 a[68:71], v2 offset:22528
  v_mfma_f32_16x16x32_bf16 v[188:191], a[44:47], a[92:95], v[188:191]
  buffer_load_dwordx4 v22, s[20:23], s60 offen offset:2048  lds
  v_mfma_f32_16x16x32_bf16 v[172:175], a[40:43], a[92:95], v[172:175]
  ds_read_b64_tr_b16 a[0:1], v4 offset:0
  ds_read_b64_tr_b16 a[2:3], v4 offset:4096
  v_mfma_f32_16x16x32_bf16 v[160:163], a[40:43], a[80:83], v[160:163]
  v_mfma_f32_16x16x32_bf16 v[176:179], a[44:47], a[80:83], v[176:179]
  ds_read_b128 a[72:75], v2 offset:38912
  ds_read_b128 a[76:79], v2 offset:55296
  v_mfma_f32_16x16x32_bf16 v[180:183], a[44:47], a[84:87], v[180:183]
  buffer_load_dwordx4 v23, s[20:23], s60 offen offset:3072  lds
  v_mfma_f32_16x16x32_bf16 v[164:167], a[40:43], a[84:87], v[164:167]
  ds_read_b64_tr_b16 a[4:5], v5 offset:0
  ds_read_b64_tr_b16 a[6:7], v5 offset:4096
  v_mfma_f32_16x16x32_bf16 v[192:195], a[48:51], a[80:83], v[192:195]
  s_add_u32 s60, s60, 32768
  v_mfma_f32_16x16x32_bf16 v[208:211], a[52:55], a[80:83], v[208:211]
  s_add_u32 m0, s61, 69632
  v_mfma_f32_16x16x32_bf16 v[212:215], a[52:55], a[84:87], v[212:215]
  buffer_load_dwordx4 v20, s[20:23], s60 offen offset:0  lds
  v_mfma_f32_16x16x32_bf16 v[196:199], a[48:51], a[84:87], v[196:199]
  ds_read_b64_tr_b16 a[8:9], v6 offset:0
  ds_read_b64_tr_b16 a[10:11], v6 offset:4096
  v_mfma_f32_16x16x32_bf16 v[200:203], a[48:51], a[88:91], v[200:203]
  v_mfma_f32_16x16x32_bf16 v[216:219], a[52:55], a[88:91], v[216:219]
  ds_read_b64_tr_b16 a[12:13], v7 offset:0
  ds_read_b64_tr_b16 a[14:15], v7 offset:4096
  v_mfma_f32_16x16x32_bf16 v[220:223], a[52:55], a[92:95], v[220:223]
  buffer_load_dwordx4 v21, s[20:23], s60 offen offset:1024  lds
  v_mfma_f32_16x16x32_bf16 v[204:207], a[48:51], a[92:95], v[204:207]
  ds_read_b64_tr_b16 a[16:17], v8 offset:0
  ds_read_b64_tr_b16 a[18:19], v8 offset:4096
  v_mfma_f32_16x16x32_bf16 v[232:235], a[56:59], a[88:91], v[232:235]
  ds_read_b64_tr_b16 a[20:21], v9 offset:0
  ds_read_b64_tr_b16 a[22:23], v9 offset:4096
  v_mfma_f32_16x16x32_bf16 v[248:251], a[60:63], a[88:91], v[248:251]
  ds_read_b64_tr_b16 a[24:25], v10 offset:0
  ds_read_b64_tr_b16 a[26:27], v10 offset:4096
  v_mfma_f32_16x16x32_bf16 v[252:255], a[60:63], a[92:95], v[252:255]
  buffer_load_dwordx4 v22, s[20:23], s60 offen offset:2048  lds
  v_mfma_f32_16x16x32_bf16 v[236:239], a[56:59], a[92:95], v[236:239]
  ds_read_b64_tr_b16 a[28:29], v11 offset:0
  ds_read_b64_tr_b16 a[30:31], v11 offset:4096
  v_mfma_f32_16x16x32_bf16 v[224:227], a[56:59], a[80:83], v[224:227]
  v_mfma_f32_16x16x32_bf16 v[240:243], a[60:63], a[80:83], v[240:243]
  v_mfma_f32_16x16x32_bf16 v[244:247], a[60:63], a[84:87], v[244:247]
  buffer_load_dwordx4 v23, s[20:23], s60 offen offset:3072  lds
  v_mfma_f32_16x16x32_bf16 v[228:231], a[56:59], a[84:87], v[228:231]
  s_add_u32 s60, s60, 229376
  s_waitcnt lgkmcnt(8)
  v_mfma_f32_16x16x32_bf16 v[128:131], a[0:3], a[64:67], v[128:131]
  v_mfma_f32_16x16x32_bf16 v[144:147], a[4:7], a[64:67], v[144:147]
  s_waitcnt lgkmcnt(0)
  v_mfma_f32_16x16x32_bf16 v[148:151], a[4:7], a[68:71], v[148:151]
  s_add_u32 m0, s61, 0
  v_mfma_f32_16x16x32_bf16 v[132:135], a[0:3], a[68:71], v[132:135]
  buffer_load_dwordx4 v20, s[20:23], s60 offen offset:0  lds
  v_mfma_f32_16x16x32_bf16 v[136:139], a[0:3], a[72:75], v[136:139]
  v_mfma_f32_16x16x32_bf16 v[152:155], a[4:7], a[72:75], v[152:155]
  v_mfma_f32_16x16x32_bf16 v[156:159], a[4:7], a[76:79], v[156:159]
  buffer_load_dwordx4 v21, s[20:23], s60 offen offset:1024  lds
  v_mfma_f32_16x16x32_bf16 v[140:143], a[0:3], a[76:79], v[140:143]
  v_mfma_f32_16x16x32_bf16 v[168:171], a[8:11], a[72:75], v[168:171]
  s_waitcnt vmcnt(10)
  v_mfma_f32_16x16x32_bf16 v[184:187], a[12:15], a[72:75], v[184:187]
  ds_read_b128 a[80:83], v2 offset:7168
  ds_read_b128 a[84:87], v2 offset:23552
  v_mfma_f32_16x16x32_bf16 v[188:191], a[12:15], a[76:79], v[188:191]
  buffer_load_dwordx4 v22, s[20:23], s60 offen offset:2048  lds
  v_mfma_f32_16x16x32_bf16 v[172:175], a[8:11], a[76:79], v[172:175]
  ds_read_b64_tr_b16 a[32:33], v4 offset:32768
  ds_read_b64_tr_b16 a[34:35], v4 offset:36864
  v_mfma_f32_16x16x32_bf16 v[160:163], a[8:11], a[64:67], v[160:163]
  v_mfma_f32_16x16x32_bf16 v[176:179], a[12:15], a[64:67], v[176:179]
  ds_read_b128 a[88:91], v2 offset:39936
  ds_read_b128 a[92:95], v2 offset:56320
  v_mfma_f32_16x16x32_bf16 v[180:183], a[12:15], a[68:71], v[180:183]
  buffer_load_dwordx4 v23, s[20:23], s60 offen offset:3072  lds
  v_mfma_f32_16x16x32_bf16 v[164:167], a[8:11], a[68:71], v[164:167]
  ds_read_b64_tr_b16 a[36:37], v5 offset:32768
  ds_read_b64_tr_b16 a[38:39], v5 offset:36864
  v_mfma_f32_16x16x32_bf16 v[192:195], a[16:19], a[64:67], v[192:195]
  s_add_u32 s60, s60, 32768
  v_mfma_f32_16x16x32_bf16 v[208:211], a[20:23], a[64:67], v[208:211]
  s_add_u32 m0, s61, 4096
  v_mfma_f32_16x16x32_bf16 v[212:215], a[20:23], a[68:71], v[212:215]
  buffer_load_dwordx4 v20, s[20:23], s60 offen offset:0  lds
  v_mfma_f32_16x16x32_bf16 v[196:199], a[16:19], a[68:71], v[196:199]
  ds_read_b64_tr_b16 a[40:41], v6 offset:32768
  ds_read_b64_tr_b16 a[42:43], v6 offset:36864
  v_mfma_f32_16x16x32_bf16 v[200:203], a[16:19], a[72:75], v[200:203]
  v_mfma_f32_16x16x32_bf16 v[216:219], a[20:23], a[72:75], v[216:219]
  ds_read_b64_tr_b16 a[44:45], v7 offset:32768
  ds_read_b64_tr_b16 a[46:47], v7 offset:36864
  v_mfma_f32_16x16x32_bf16 v[220:223], a[20:23], a[76:79], v[220:223]
  buffer_load_dwordx4 v21, s[20:23], s60 offen offset:1024  lds
  v_mfma_f32_16x16x32_bf16 v[204:207], a[16:19], a[76:79], v[204:207]
  ds_read_b64_tr_b16 a[48:49], v8 offset:32768
  ds_read_b64_tr_b16 a[50:51], v8 offset:36864
  v_mfma_f32_16x16x32_bf16 v[232:235], a[24:27], a[72:75], v[232:235]
  ds_read_b64_tr_b16 a[52:53], v9 offset:32768
  ds_read_b64_tr_b16 a[54:55], v9 offset:36864
  v_mfma_f32_16x16x32_bf16 v[248:251], a[28:31], a[72:75], v[248:251]
  ds_read_b64_tr_b16 a[56:57], v10 offset:32768
  ds_read_b64_tr_b16 a[58:59], v10 offset:36864
  v_mfma_f32_16x16x32_bf16 v[252:255], a[28:31], a[76:79], v[252:255]
  buffer_load_dwordx4 v22, s[20:23], s60 offen offset:2048  lds
  v_mfma_f32_16x16x32_bf16 v[236:239], a[24:27], a[76:79], v[236:239]
  ds_read_b64_tr_b16 a[60:61], v11 offset:32768
  ds_read_b64_tr_b16 a[62:63], v11 offset:36864
  v_mfma_f32_16x16x32_bf16 v[224:227], a[24:27], a[64:67], v[224:227]
  v_mfma_f32_16x16x32_bf16 v[240:243], a[28:31], a[64:67], v[240:243]
  v_mfma_f32_16x16x32_bf16 v[244:247], a[28:31], a[68:71], v[244:247]
  buffer_load_dwordx4 v23, s[20:23], s60 offen offset:3072  lds
  v_mfma_f32_16x16x32_bf16 v[228:231], a[24:27], a[68:71], v[228:231]
  s_add_u32 s60, s60, 229376
  s_waitcnt lgkmcnt(8)
  v_mfma_f32_16x16x32_bf16 v[128:131], a[32:35], a[80:83], v[128:131]
  v_mfma_f32_16x16x32_bf16 v[144:147], a[36:39], a[80:83], v[144:147]
  s_waitcnt lgkmcnt(0)
  v_mfma_f32_16x16x32_bf16 v[148:151], a[36:39], a[84:87], v[148:151]
  s_add_u32 m0, s61, 32768
  v_mfma_f32_16x16x32_bf16 v[132:135], a[32:35], a[84:87], v[132:135]
  buffer_load_dwordx4 v20, s[20:23], s60 offen offset:0  lds
  v_mfma_f32_16x16x32_bf16 v[136:139], a[32:35], a[88:91], v[136:139]
  v_mfma_f32_16x16x32_bf16 v[152:155], a[36:39], a[88:91], v[152:155]
  v_mfma_f32_16x16x32_bf16 v[156:159], a[36:39], a[92:95], v[156:159]
  buffer_load_dwordx4 v21, s[20:23], s60 offen offset:1024  lds
  v_mfma_f32_16x16x32_bf16 v[140:143], a[32:35], a[92:95], v[140:143]
  v_mfma_f32_16x16x32_bf16 v[168:171], a[40:43], a[88:91], v[168:171]
  s_waitcnt vmcnt(10)
  v_mfma_f32_16x16x32_bf16 v[184:187], a[44:47], a[88:91], v[184:187]
  ds_read_b128 a[64:67], v2 offset:8192
  ds_read_b128 a[68:71], v2 offset:24576
  v_mfma_f32_16x16x32_bf16 v[188:191], a[44:47], a[92:95], v[188:191]
  buffer_load_dwordx4 v22, s[20:23], s60 offen offset:2048  lds
  v_mfma_f32_16x16x32_bf16 v[172:175], a[40:43], a[92:95], v[172:175]
  ds_read_b64_tr_b16 a[0:1], v12 offset:0
  ds_read_b64_tr_b16 a[2:3], v12 offset:4096
  v_mfma_f32_16x16x32_bf16 v[160:163], a[40:43], a[80:83], v[160:163]
  v_mfma_f32_16x16x32_bf16 v[176:179], a[44:47], a[80:83], v[176:179]
  ds_read_b128 a[72:75], v2 offset:40960
  ds_read_b128 a[76:79], v2 offset:57344
  v_mfma_f32_16x16x32_bf16 v[180:183], a[44:47], a[84:87], v[180:183]
  buffer_load_dwordx4 v23, s[20:23], s60 offen offset:3072  lds
  v_mfma_f32_16x16x32_bf16 v[164:167], a[40:43], a[84:87], v[164:167]
  ds_read_b64_tr_b16 a[4:5], v13 offset:0
  ds_read_b64_tr_b16 a[6:7], v13 offset:4096
  v_mfma_f32_16x16x32_bf16 v[192:195], a[48:51], a[80:83], v[192:195]
  s_add_u32 s60, s60, 32768
  v_mfma_f32_16x16x32_bf16 v[208:211], a[52:55], a[80:83], v[208:211]
  s_add_u32 m0, s61, 36864
  v_mfma_f32_16x16x32_bf16 v[212:215], a[52:55], a[84:87], v[212:215]
  buffer_load_dwordx4 v20, s[20:23], s60 offen offset:0  lds
  v_mfma_f32_16x16x32_bf16 v[196:199], a[48:51], a[84:87], v[196:199]
  ds_read_b64_tr_b16 a[8:9], v14 offset:0
  ds_read_b64_tr_b16 a[10:11], v14 offset:4096
  v_mfma_f32_16x16x32_bf16 v[200:203], a[48:51], a[88:91], v[200:203]
  v_mfma_f32_16x16x32_bf16 v[216:219], a[52:55], a[88:91], v[216:219]
  ds_read_b64_tr_b16 a[12:13], v15 offset:0
  ds_read_b64_tr_b16 a[14:15], v15 offset:4096
  v_mfma_f32_16x16x32_bf16 v[220:223], a[52:55], a[92:95], v[220:223]
  buffer_load_dwordx4 v21, s[20:23], s60 offen offset:1024  lds
  v_mfma_f32_16x16x32_bf16 v[204:207], a[48:51], a[92:95], v[204:207]
  ds_read_b64_tr_b16 a[16:17], v16 offset:0
  ds_read_b64_tr_b16 a[18:19], v16 offset:4096
  v_mfma_f32_16x16x32_bf16 v[232:235], a[56:59], a[88:91], v[232:235]
  ds_read_b64_tr_b16 a[20:21], v17 offset:0
  ds_read_b64_tr_b16 a[22:23], v17 offset:4096
  v_mfma_f32_16x16x32_bf16 v[248:251], a[60:63], a[88:91], v[248:251]
  ds_read_b64_tr_b16 a[24:25], v18 offset:0
  ds_read_b64_tr_b16 a[26:27], v18 offset:4096
  v_mfma_f32_16x16x32_bf16 v[252:255], a[60:63], a[92:95], v[252:255]
  buffer_load_dwordx4 v22, s[20:23], s60 offen offset:2048  lds
  v_mfma_f32_16x16x32_bf16 v[236:239], a[56:59], a[92:95], v[236:239]
  ds_read_b64_tr_b16 a[28:29], v19 offset:0
  ds_read_b64_tr_b16 a[30:31], v19 offset:4096
  v_mfma_f32_16x16x32_bf16 v[224:227], a[56:59], a[80:83], v[224:227]
  v_mfma_f32_16x16x32_bf16 v[240:243], a[60:63], a[80:83], v[240:243]
  v_mfma_f32_16x16x32_bf16 v[244:247], a[60:63], a[84:87], v[244:247]
  buffer_load_dwordx4 v23, s[20:23], s60 offen offset:3072  lds
  v_mfma_f32_16x16x32_bf16 v[228:231], a[56:59], a[84:87], v[228:231]
  s_add_u32 s60, s60, 229376
  s_waitcnt lgkmcnt(8)
  v_mfma_f32_16x16x32_bf16 v[128:131], a[0:3], a[64:67], v[128:131]
  v_mfma_f32_16x16x32_bf16 v[144:147], a[4:7], a[64:67], v[144:147]
  s_waitcnt lgkmcnt(0)
  v_mfma_f32_16x16x32_bf16 v[148:151], a[4:7], a[68:71], v[148:151]
  s_add_u32 m0, s61, 65536
  v_mfma_f32_16x16x32_bf16 v[132:135], a[0:3], a[68:71], v[132:135]
  buffer_load_dwordx4 v20, s[20:23], s60 offen offset:0  lds
  v_mfma_f32_16x16x32_bf16 v[136:139], a[0:3], a[72:75], v[136:139]
  v_mfma_f32_16x16x32_bf16 v[152:155], a[4:7], a[72:75], v[152:155]
  v_mfma_f32_16x16x32_bf16 v[156:159], a[4:7], a[76:79], v[156:159]
  buffer_load_dwordx4 v21, s[20:23], s60 offen offset:1024  lds
  v_mfma_f32_16x16x32_bf16 v[140:143], a[0:3], a[76:79], v[140:143]
  v_mfma_f32_16x16x32_bf16 v[168:171], a[8:11], a[72:75], v[168:171]
  s_waitcnt vmcnt(10)
  v_mfma_f32_16x16x32_bf16 v[184:187], a[12:15], a[72:75], v[184:187]
  ds_read_b128 a[80:83], v2 offset:9216
  ds_read_b128 a[84:87], v2 offset:25600
  v_mfma_f32_16x16x32_bf16 v[188:191], a[12:15], a[76:79], v[188:191]
  buffer_load_dwordx4 v22, s[20:23], s60 offen offset:2048  lds
  v_mfma_f32_16x16x32_bf16 v[172:175], a[8:11], a[76:79], v[172:175]
  ds_read_b64_tr_b16 a[32:33], v4 offset:0
  ds_read_b64_tr_b16 a[34:35], v4 offset:4096
  v_mfma_f32_16x16x32_bf16 v[160:163], a[8:11], a[64:67], v[160:163]
  v_mfma_f32_16x16x32_bf16 v[176:179], a[12:15], a[64:67], v[176:179]
  ds_read_b128 a[88:91], v2 offset:41984
  ds_read_b128 a[92:95], v2 offset:58368
  v_mfma_f32_16x16x32_bf16 v[180:183], a[12:15], a[68:71], v[180:183]
  buffer_load_dwordx4 v23, s[20:23], s60 offen offset:3072  lds
  v_mfma_f32_16x16x32_bf16 v[164:167], a[8:11], a[68:71], v[164:167]
  ds_read_b64_tr_b16 a[36:37], v5 offset:0
  ds_read_b64_tr_b16 a[38:39], v5 offset:4096
  v_mfma_f32_16x16x32_bf16 v[192:195], a[16:19], a[64:67], v[192:195]
  s_add_u32 s60, s60, 32768
  v_mfma_f32_16x16x32_bf16 v[208:211], a[20:23], a[64:67], v[208:211]
  s_add_u32 m0, s61, 69632
  v_mfma_f32_16x16x32_bf16 v[212:215], a[20:23], a[68:71], v[212:215]
  buffer_load_dwordx4 v20, s[20:23], s60 offen offset:0  lds
  v_mfma_f32_16x16x32_bf16 v[196:199], a[16:19], a[68:71], v[196:199]
  ds_read_b64_tr_b16 a[40:41], v6 offset:0
  ds_read_b64_tr_b16 a[42:43], v6 offset:4096
  v_mfma_f32_16x16x32_bf16 v[200:203], a[16:19], a[72:75], v[200:203]
  v_mfma_f32_16x16x32_bf16 v[216:219], a[20:23], a[72:75], v[216:219]
  ds_read_b64_tr_b16 a[44:45], v7 offset:0
  ds_read_b64_tr_b16 a[46:47], v7 offset:4096
  v_mfma_f32_16x16x32_bf16 v[220:223], a[20:23], a[76:79], v[220:223]
  buffer_load_dwordx4 v21, s[20:23], s60 offen offset:1024  lds
  v_mfma_f32_16x16x32_bf16 v[204:207], a[16:19], a[76:79], v[204:207]
  ds_read_b64_tr_b16 a[48:49], v8 offset:0
  ds_read_b64_tr_b16 a[50:51], v8 offset:4096
  v_mfma_f32_16x16x32_bf16 v[232:235], a[24:27], a[72:75], v[232:235]
  ds_read_b64_tr_b16 a[52:53], v9 offset:0
  ds_read_b64_tr_b16 a[54:55], v9 offset:4096
  v_mfma_f32_16x16x32_bf16 v[248:251], a[28:31], a[72:75], v[248:251]
  ds_read_b64_tr_b16 a[56:57], v10 offset:0
  ds_read_b64_tr_b16 a[58:59], v10 offset:4096
  v_mfma_f32_16x16x32_bf16 v[252:255], a[28:31], a[76:79], v[252:255]
  buffer_load_dwordx4 v22, s[20:23], s60 offen offset:2048  lds
  v_mfma_f32_16x16x32_bf16 v[236:239], a[24:27], a[76:79], v[236:239]
  ds_read_b64_tr_b16 a[60:61], v11 offset:0
  ds_read_b64_tr_b16 a[62:63], v11 offset:4096
  v_mfma_f32_16x16x32_bf16 v[224:227], a[24:27], a[64:67], v[224:227]
  v_mfma_f32_16x16x32_bf16 v[240:243], a[28:31], a[64:67], v[240:243]
  v_mfma_f32_16x16x32_bf16 v[244:247], a[28:31], a[68:71], v[244:247]
  buffer_load_dwordx4 v23, s[20:23], s60 offen offset:3072  lds
  v_mfma_f32_16x16x32_bf16 v[228:231], a[24:27], a[68:71], v[228:231]
  s_add_u32 s60, s60, 229376
  s_waitcnt lgkmcnt(8)
  v_mfma_f32_16x16x32_bf16 v[128:131], a[32:35], a[80:83], v[128:131]
  v_mfma_f32_16x16x32_bf16 v[144:147], a[36:39], a[80:83], v[144:147]
  s_waitcnt lgkmcnt(0)
  v_mfma_f32_16x16x32_bf16 v[148:151], a[36:39], a[84:87], v[148:151]
  s_add_u32 m0, s61, 0
  v_mfma_f32_16x16x32_bf16 v[132:135], a[32:35], a[84:87], v[132:135]
  buffer_load_dwordx4 v20, s[20:23], s60 offen offset:0  lds
  v_mfma_f32_16x16x32_bf16 v[136:139], a[32:35], a[88:91], v[136:139]
  v_mfma_f32_16x16x32_bf16 v[152:155], a[36:39], a[88:91], v[152:155]
  v_mfma_f32_16x16x32_bf16 v[156:159], a[36:39], a[92:95], v[156:159]
  buffer_load_dwordx4 v21, s[20:23], s60 offen offset:1024  lds
  v_mfma_f32_16x16x32_bf16 v[140:143], a[32:35], a[92:95], v[140:143]
  v_mfma_f32_16x16x32_bf16 v[168:171], a[40:43], a[88:91], v[168:171]
  s_waitcnt vmcnt(10)
  v_mfma_f32_16x16x32_bf16 v[184:187], a[44:47], a[88:91], v[184:187]
  ds_read_b128 a[64:67], v2 offset:10240
  ds_read_b128 a[68:71], v2 offset:26624
  v_mfma_f32_16x16x32_bf16 v[188:191], a[44:47], a[92:95], v[188:191]
  buffer_load_dwordx4 v22, s[20:23], s60 offen offset:2048  lds
  v_mfma_f32_16x16x32_bf16 v[172:175], a[40:43], a[92:95], v[172:175]
  ds_read_b64_tr_b16 a[0:1], v4 offset:32768
  ds_read_b64_tr_b16 a[2:3], v4 offset:36864
  v_mfma_f32_16x16x32_bf16 v[160:163], a[40:43], a[80:83], v[160:163]
  v_mfma_f32_16x16x32_bf16 v[176:179], a[44:47], a[80:83], v[176:179]
  ds_read_b128 a[72:75], v2 offset:43008
  ds_read_b128 a[76:79], v2 offset:59392
  v_mfma_f32_16x16x32_bf16 v[180:183], a[44:47], a[84:87], v[180:183]
  buffer_load_dwordx4 v23, s[20:23], s60 offen offset:3072  lds
  v_mfma_f32_16x16x32_bf16 v[164:167], a[40:43], a[84:87], v[164:167]
  ds_read_b64_tr_b16 a[4:5], v5 offset:32768
  ds_read_b64_tr_b16 a[6:7], v5 offset:36864
  v_mfma_f32_16x16x32_bf16 v[192:195], a[48:51], a[80:83], v[192:195]
  s_add_u32 s60, s60, 32768
  v_mfma_f32_16x16x32_bf16 v[208:211], a[52:55], a[80:83], v[208:211]
  s_add_u32 m0, s61, 4096
  v_mfma_f32_16x16x32_bf16 v[212:215], a[52:55], a[84:87], v[212:215]
  buffer_load_dwordx4 v20, s[20:23], s60 offen offset:0  lds
  v_mfma_f32_16x16x32_bf16 v[196:199], a[48:51], a[84:87], v[196:199]
  ds_read_b64_tr_b16 a[8:9], v6 offset:32768
  ds_read_b64_tr_b16 a[10:11], v6 offset:36864
  v_mfma_f32_16x16x32_bf16 v[200:203], a[48:51], a[88:91], v[200:203]
  v_mfma_f32_16x16x32_bf16 v[216:219], a[52:55], a[88:91], v[216:219]
  ds_read_b64_tr_b16 a[12:13], v7 offset:32768
  ds_read_b64_tr_b16 a[14:15], v7 offset:36864
  v_mfma_f32_16x16x32_bf16 v[220:223], a[52:55], a[92:95], v[220:223]
  buffer_load_dwordx4 v21, s[20:23], s60 offen offset:1024  lds
  v_mfma_f32_16x16x32_bf16 v[204:207], a[48:51], a[92:95], v[204:207]
  ds_read_b64_tr_b16 a[16:17], v8 offset:32768
  ds_read_b64_tr_b16 a[18:19], v8 offset:36864
  v_mfma_f32_16x16x32_bf16 v[232:235], a[56:59], a[88:91], v[232:235]
  ds_read_b64_tr_b16 a[20:21], v9 offset:32768
  ds_read_b64_tr_b16 a[22:23], v9 offset:36864
  v_mfma_f32_16x16x32_bf16 v[248:251], a[60:63], a[88:91], v[248:251]
  ds_read_b64_tr_b16 a[24:25], v10 offset:32768
  ds_read_b64_tr_b16 a[26:27], v10 offset:36864
  v_mfma_f32_16x16x32_bf16 v[252:255], a[60:63], a[92:95], v[252:255]
  buffer_load_dwordx4 v22, s[20:23], s60 offen offset:2048  lds
  v_mfma_f32_16x16x32_bf16 v[236:239], a[56:59], a[92:95], v[236:239]
  ds_read_b64_tr_b16 a[28:29], v11 offset:32768
  ds_read_b64_tr_b16 a[30:31], v11 offset:36864
  v_mfma_f32_16x16x32_bf16 v[224:227], a[56:59], a[80:83], v[224:227]
  v_lshlrev_b32 v30, 10, v1
  s_mul_i32 s99, s96, 32768
  v_cmp_gt_u32 vcc, 32, v1
  s_cmp_lg_u32 s3, 2
  s_nop 0
  v_cndmask_b32 v30, -1, v30, vcc
  s_cbranch_scc1 L_tw_4
  buffer_load_dword a255, v30, s[32:35], s99 offen
L_tw_4:
  v_mfma_f32_16x16x32_bf16 v[240:243], a[60:63], a[80:83], v[240:243]
  v_mfma_f32_16x16x32_bf16 v[244:247], a[60:63], a[84:87], v[244:247]
  buffer_load_dwordx4 v23, s[20:23], s60 offen offset:3072  lds
  v_mfma_f32_16x16x32_bf16 v[228:231], a[56:59], a[84:87], v[228:231]
  s_add_u32 s60, s60, 229376
  s_waitcnt lgkmcnt(8)
  v_mfma_f32_16x16x32_bf16 v[128:131], a[0:3], a[64:67], v[128:131]
  v_mfma_f32_16x16x32_bf16 v[144:147], a[4:7], a[64:67], v[144:147]
  s_waitcnt lgkmcnt(0)
  v_mfma_f32_16x16x32_bf16 v[148:151], a[4:7], a[68:71], v[148:151]
  s_add_u32 m0, s61, 32768
  v_mfma_f32_16x16x32_bf16 v[132:135], a[0:3], a[68:71], v[132:135]
  buffer_load_dwordx4 v20, s[20:23], s60 offen offset:0  lds
  v_mfma_f32_16x16x32_bf16 v[136:139], a[0:3], a[72:75], v[136:139]
  v_mfma_f32_16x16x32_bf16 v[152:155], a[4:7], a[72:75], v[152:155]
  v_mfma_f32_16x16x32_bf16 v[156:159], a[4:7], a[76:79], v[156:159]
  buffer_load_dwordx4 v21, s[20:23], s60 offen offset:1024  lds
  v_mfma_f32_16x16x32_bf16 v[140:143], a[0:3], a[76:79], v[140:143]
  v_mfma_f32_16x16x32_bf16 v[168:171], a[8:11], a[72:75], v[168:171]
  s_waitcnt vmcnt(10)
  v_mfma_f32_16x16x32_bf16 v[184:187], a[12:15], a[72:75], v[184:187]
  ds_read_b128 a[80:83], v2 offset:11264
  ds_read_b128 a[84:87], v2 offset:27648
  v_mfma_f32_16x16x32_bf16 v[188:191], a[12:15], a[76:79], v[188:191]
  buffer_load_dwordx4 v22, s[20:23], s60 offen offset:2048  lds
  v_mfma_f32_16x16x32_bf16 v[172:175], a[8:11], a[76:79], v[172:175]
  ds_read_b64_tr_b16 a[32:33], v12 offset:0
  ds_read_b64_tr_b16 a[34:35], v12 offset:4096
  v_mfma_f32_16x16x32_bf16 v[160:163], a[8:11], a[64:67], v[160:163]
  v_min_u32 v46, 2, v1
  v_add_u32 v46, s4, v46
  v_subrev_u32 v46, 1, v46
  v_max_i32 v46, 0, v46
  v_min_i32 v46, 31, v46
  v_lshlrev_b32 v46, 3, v46
  buffer_load_dword v47, v46, s[48:51], 0 offen sc1
  v_mfma_f32_16x16x32_bf16 v[176:179], a[12:15], a[64:67], v[176:179]
  ds_read_b128 a[88:91], v2 offset:44032
  ds_read_b128 a[92:95], v2 offset:60416
  v_mfma_f32_16x16x32_bf16 v[180:183], a[12:15], a[68:71], v[180:183]
  buffer_load_dwordx4 v23, s[20:23], s60 offen offset:3072  lds
  v_mfma_f32_16x16x32_bf16 v[164:167], a[8:11], a[68:71], v[164:167]
  ds_read_b64_tr_b16 a[36:37], v13 offset:0
  ds_read_b64_tr_b16 a[38:39], v13 offset:4096
  v_mfma_f32_16x16x32_bf16 v[192:195], a[16:19], a[64:67], v[192:195]
  s_add_u32 s60, s60, 32768
  v_mfma_f32_16x16x32_bf16 v[208:211], a[20:23], a[64:67], v[208:211]
  s_add_u32 m0, s61, 36864
  v_mfma_f32_16x16x32_bf16 v[212:215], a[20:23], a[68:71], v[212:215]
  buffer_load_dwordx4 v20, s[20:23], s60 offen offset:0  lds
  v_mfma_f32_16x16x32_bf16 v[196:199], a[16:19], a[68:71], v[196:199]
  ds_read_b64_tr_b16 a[40:41], v14 offset:0
  ds_read_b64_tr_b16 a[42:43], v14 offset:4096
  v_mfma_f32_16x16x32_bf16 v[200:203], a[16:19], a[72:75], v[200:203]
  v_mfma_f32_16x16x32_bf16 v[216:219], a[20:23], a[72:75], v[216:219]
  ds_read_b64_tr_b16 a[44:45], v15 offset:0
  ds_read_b64_tr_b16 a[46:47], v15 offset:4096
  v_mfma_f32_16x16x32_bf16 v[220:223], a[20:23], a[76:79], v[220:223]
  buffer_load_dwordx4 v21, s[20:23], s60 offen offset:1024  lds
  v_mfma_f32_16x16x32_bf16 v[204:207], a[16:19], a[76:79], v[204:207]
  ds_read_b64_tr_b16 a[48:49], v16 offset:0
  ds_read_b64_tr_b16 a[50:51], v16 offset:4096
  v_mfma_f32_16x16x32_bf16 v[232:235], a[24:27], a[72:75], v[232:235]
  ds_read_b64_tr_b16 a[52:53], v17 offset:0
  ds_read_b64_tr_b16 a[54:55], v17 offset:4096
  v_mfma_f32_16x16x32_bf16 v[248:251], a[28:31], a[72:75], v[248:251]
  ds_read_b64_tr_b16 a[56:57], v18 offset:0
  ds_read_b64_tr_b16 a[58:59], v18 offset:4096
  v_mfma_f32_16x16x32_bf16 v[252:255], a[28:31], a[76:79], v[252:255]
  buffer_load_dwordx4 v22, s[20:23], s60 offen offset:2048  lds
  v_mfma_f32_16x16x32_bf16 v[236:239], a[24:27], a[76:79], v[236:239]
  ds_read_b64_tr_b16 a[60:61], v19 offset:0
  ds_read_b64_tr_b16 a[62:63], v19 offset:4096
  v_mfma_f32_16x16x32_bf16 v[224:227], a[24:27], a[64:67], v[224:227]
  v_mfma_f32_16x16x32_bf16 v[240:243], a[28:31], a[64:67], v[240:243]
  v_mfma_f32_16x16x32_bf16 v[244:247], a[28:31], a[68:71], v[244:247]
  buffer_load_dwordx4 v23, s[20:23], s60 offen offset:3072  lds
  v_mfma_f32_16x16x32_bf16 v[228:231], a[24:27], a[68:71], v[228:231]
  s_add_u32 s60, s60, 229376
  s_waitcnt lgkmcnt(8)
  v_mfma_f32_16x16x32_bf16 v[128:131], a[32:35], a[80:83], v[128:131]
  v_mfma_f32_16x16x32_bf16 v[144:147], a[36:39], a[80:83], v[144:147]
  s_waitcnt lgkmcnt(0)
  v_mfma_f32_16x16x32_bf16 v[148:151], a[36:39], a[84:87], v[148:151]
  s_add_u32 m0, s61, 65536
  v_mfma_f32_16x16x32_bf16 v[132:135], a[32:35], a[84:87], v[132:135]
  buffer_load_dwordx4 v20, s[20:23], s60 offen offset:0  lds
  v_mfma_f32_16x16x32_bf16 v[136:139], a[32:35], a[88:91], v[136:139]
  v_mfma_f32_16x16x32_bf16 v[152:155], a[36:39], a[88:91], v[152:155]
  v_mfma_f32_16x16x32_bf16 v[156:159], a[36:39], a[92:95], v[156:159]
  buffer_load_dwordx4 v21, s[20:23], s60 offen offset:1024  lds
  v_mfma_f32_16x16x32_bf16 v[140:143], a[32:35], a[92:95], v[140:143]
  v_mfma_f32_16x16x32_bf16 v[168:171], a[40:43], a[88:91], v[168:171]
  s_waitcnt vmcnt(11)
  v_mfma_f32_16x16x32_bf16 v[184:187], a[44:47], a[88:91], v[184:187]
  ds_read_b128 a[64:67], v2 offset:12288
  ds_read_b128 a[68:71], v2 offset:28672
  v_mfma_f32_16x16x32_bf16 v[188:191], a[44:47], a[92:95], v[188:191]
  buffer_load_dwordx4 v22, s[20:23], s60 offen offset:2048  lds
  v_mfma_f32_16x16x32_bf16 v[172:175], a[40:43], a[92:95], v[172:175]
  ds_read_b64_tr_b16 a[0:1], v4 offset:0
  ds_read_b64_tr_b16 a[2:3], v4 offset:4096
  v_mfma_f32_16x16x32_bf16 v[160:163], a[40:43], a[80:83], v[160:163]
  v_mfma_f32_16x16x32_bf16 v[176:179], a[44:47], a[80:83], v[176:179]
  ds_read_b128 a[72:75], v2 offset:45056
  ds_read_b128 a[76:79], v2 offset:61440
  v_mfma_f32_16x16x32_bf16 v[180:183], a[44:47], a[84:87], v[180:183]
  buffer_load_dwordx4 v23, s[20:23], s60 offen offset:3072  lds
  v_lshrrev_b32 v30, 3, v1
  v_mfma_f32_16x16x32_bf16 v[164:167], a[40:43], a[84:87], v[164:167]
  ds_read_b64_tr_b16 a[4:5], v5 offset:0
  ds_read_b64_tr_b16 a[6:7], v5 offset:4096
  v_mul_u32_u24 v30, 1024, v30
  v_mfma_f32_16x16x32_bf16 v[192:195], a[48:51], a[80:83], v[192:195]
  s_add_u32 s60, s60, 32768
  v_mfma_f32_16x16x32_bf16 v[208:211], a[52:55], a[80:83], v[208:211]
  s_add_u32 m0, s61, 69632
  v_lshrrev_b32 v31, 4, v1
  v_mfma_f32_16x16x32_bf16 v[212:215], a[52:55], a[84:87], v[212:215]
  buffer_load_dwordx4 v20, s[20:23], s60 offen offset:0  lds
  v_mfma_f32_16x16x32_bf16 v[196:199], a[48:51], a[84:87], v[196:199]
  ds_read_b64_tr_b16 a[8:9], v6 offset:0
  ds_read_b64_tr_b16 a[10:11], v6 offset:4096
  v_lshlrev_b32 v31, 5, v31
  v_mfma_f32_16x16x32_bf16 v[200:203], a[48:51], a[88:91], v[200:203]
  v_mfma_f32_16x16x32_bf16 v[216:219], a[52:55], a[88:91], v[216:219]
  ds_read_b64_tr_b16 a[12:13], v7 offset:0
  ds_read_b64_tr_b16 a[14:15], v7 offset:4096
  v_and_b32 v40, 0x70, v0
  v_mfma_f32_16x16x32_bf16 v[220:223], a[52:55], a[92:95], v[220:223]
  buffer_load_dwordx4 v21, s[20:23], s60 offen offset:1024  lds
  v_mfma_f32_16x16x32_bf16 v[204:207], a[48:51], a[92:95], v[204:207]
  ds_read_b64_tr_b16 a[16:17], v8 offset:0
  ds_read_b64_tr_b16 a[18:19], v8 offset:4096
  v_xor_b32 v31, v31, v40
  v_mfma_f32_16x16x32_bf16 v[232:235], a[56:59], a[88:91], v[232:235]
  ds_read_b64_tr_b16 a[20:21], v9 offset:0
  ds_read_b64_tr_b16 a[22:23], v9 offset:4096
  v_add_u32 v42, v30, v31
  v_mfma_f32_16x16x32_bf16 v[248:251], a[60:63], a[88:91], v[248:251]
  ds_read_b64_tr_b16 a[24:25], v10 offset:0
  ds_read_b64_tr_b16 a[26:27], v10 offset:4096
  v_mfma_f32_16x16x32_bf16 v[252:255], a[60:63], a[92:95], v[252:255]
  buffer_load_dwordx4 v22, s[20:23], s60 offen offset:2048  lds
  v_add_u32 v43, 7168, v42
  v_mfma_f32_16x16x32_bf16 v[236:239], a[56:59], a[92:95], v[236:239]
  ds_read_b64_tr_b16 a[28:29], v11 offset:0
  ds_read_b64_tr_b16 a[30:31], v11 offset:4096
  v_mfma_f32_16x16x32_bf16 v[224:227], a[56:59], a[80:83], v[224:227]
  v_add_u32 v44, 14336, v42
  v_mfma_f32_16x16x32_bf16 v[240:243], a[60:63], a[80:83], v[240:243]
  v_mfma_f32_16x16x32_bf16 v[244:247], a[60:63], a[84:87], v[244:247]
  buffer_load_dwordx4 v23, s[20:23], s60 offen offset:3072  lds
  v_add_u32 v45, 21504, v42
  v_mfma_f32_16x16x32_bf16 v[228:231], a[56:59], a[84:87], v[228:231]
  s_add_u32 s60, s60, 229376
  s_waitcnt lgkmcnt(8)
  v_mfma_f32_16x16x32_bf16 v[128:131], a[0:3], a[64:67], v[128:131]
  v_mfma_f32_16x16x32_bf16 v[144:147], a[4:7], a[64:67], v[144:147]
  s_waitcnt lgkmcnt(0)
  v_mfma_f32_16x16x32_bf16 v[148:151], a[4:7], a[68:71], v[148:151]
  s_add_u32 m0, s61, 0
  v_mfma_f32_16x16x32_bf16 v[132:135], a[0:3], a[68:71], v[132:135]
  buffer_load_dwordx4 v20, s[20:23], s60 offen offset:0  lds
  v_mfma_f32_16x16x32_bf16 v[136:139], a[0:3], a[72:75], v[136:139]
  v_mfma_f32_16x16x32_bf16 v[152:155], a[4:7], a[72:75], v[152:155]
  v_mfma_f32_16x16x32_bf16 v[156:159], a[4:7], a[76:79], v[156:159]
  buffer_load_dwordx4 v21, s[20:23], s60 offen offset:1024  lds
  v_mfma_f32_16x16x32_bf16 v[140:143], a[0:3], a[76:79], v[140:143]
  v_mfma_f32_16x16x32_bf16 v[168:171], a[8:11], a[72:75], v[168:171]
  s_waitcnt vmcnt(10)
  v_mfma_f32_16x16x32_bf16 v[184:187], a[12:15], a[72:75], v[184:187]
  ds_read_b128 a[80:83], v2 offset:13312
  ds_read_b128 a[84:87], v2 offset:29696
  v_mfma_f32_16x16x32_bf16 v[188:191], a[12:15], a[76:79], v[188:191]
  buffer_load_dwordx4 v22, s[20:23], s60 offen offset:2048  lds
  v_mfma_f32_16x16x32_bf16 v[172:175], a[8:11], a[76:79], v[172:175]
  ds_read_b64_tr_b16 a[32:33], v4 offset:32768
  ds_read_b64_tr_b16 a[34:35], v4 offset:36864
  v_mfma_f32_16x16x32_bf16 v[160:163], a[8:11], a[64:67], v[160:163]
  v_mfma_f32_16x16x32_bf16 v[176:179], a[12:15], a[64:67], v[176:179]
  ds_read_b128 a[88:91], v2 offset:46080
  ds_read_b128 a[92:95], v2 offset:62464
  v_mfma_f32_16x16x32_bf16 v[180:183], a[12:15], a[68:71], v[180:183]
  buffer_load_dwordx4 v23, s[20:23], s60 offen offset:3072  lds
  v_mfma_f32_16x16x32_bf16 v[164:167], a[8:11], a[68:71], v[164:167]
  ds_read_b64_tr_b16 a[36:37], v5 offset:32768
  ds_read_b64_tr_b16 a[38:39], v5 offset:36864
  v_mfma_f32_16x16x32_bf16 v[192:195], a[16:19], a[64:67], v[192:195]
  s_add_u32 s60, s60, 32768
  v_mfma_f32_16x16x32_bf16 v[208:211], a[20:23], a[64:67], v[208:211]
  s_add_u32 m0, s61, 4096
  v_mfma_f32_16x16x32_bf16 v[212:215], a[20:23], a[68:71], v[212:215]
  buffer_load_dwordx4 v20, s[20:23], s60 offen offset:0  lds
  v_mfma_f32_16x16x32_bf16 v[196:199], a[16:19], a[68:71], v[196:199]
  ds_read_b64_tr_b16 a[40:41], v6 offset:32768
  ds_read_b64_tr_b16 a[42:43], v6 offset:36864
  v_mfma_f32_16x16x32_bf16 v[200:203], a[16:19], a[72:75], v[200:203]
  v_mfma_f32_16x16x32_bf16 v[216:219], a[20:23], a[72:75], v[216:219]
  ds_read_b64_tr_b16 a[44:45], v7 offset:32768
  ds_read_b64_tr_b16 a[46:47], v7 offset:36864
  v_mfma_f32_16x16x32_bf16 v[220:223], a[20:23], a[76:79], v[220:223]
  buffer_load_dwordx4 v21, s[20:23], s60 offen offset:1024  lds
  v_mfma_f32_16x16x32_bf16 v[204:207], a[16:19], a[76:79], v[204:207]
  ds_read_b64_tr_b16 a[48:49], v8 offset:32768
  ds_read_b64_tr_b16 a[50:51], v8 offset:36864
  v_mfma_f32_16x16x32_bf16 v[232:235], a[24:27], a[72:75], v[232:235]
  ds_read_b64_tr_b16 a[52:53], v9 offset:32768
  ds_read_b64_tr_b16 a[54:55], v9 offset:36864
  v_mfma_f32_16x16x32_bf16 v[248:251], a[28:31], a[72:75], v[248:251]
  ds_read_b64_tr_b16 a[56:57], v10 offset:32768
  ds_read_b64_tr_b16 a[58:59], v10 offset:36864
  v_mfma_f32_16x16x32_bf16 v[252:255], a[28:31], a[76:79], v[252:255]
  buffer_load_dwordx4 v22, s[20:23], s60 offen offset:2048  lds
  v_mfma_f32_16x16x32_bf16 v[236:239], a[24:27], a[76:79], v[236:239]
  ds_read_b64_tr_b16 a[60:61], v11 offset:32768
  ds_read_b64_tr_b16 a[62:63], v11 offset:36864
  ds_read_b128 a[96:99], v2 offset:14336
  ds_read_b128 a[100:103], v2 offset:30720
  v_mfma_f32_16x16x32_bf16 v[224:227], a[24:27], a[64:67], v[224:227]
  ds_read_b128 a[104:107], v2 offset:47104
  ds_read_b128 a[108:111], v2 offset:63488
  v_mfma_f32_16x16x32_bf16 v[240:243], a[28:31], a[64:67], v[240:243]
  ds_read_b128 a[112:115], v2 offset:15360
  ds_read_b128 a[116:119], v2 offset:31744
  v_mfma_f32_16x16x32_bf16 v[244:247], a[28:31], a[68:71], v[244:247]
  buffer_load_dwordx4 v23, s[20:23], s60 offen offset:3072  lds
  ds_read_b128 a[120:123], v2 offset:48128
  ds_read_b128 a[124:127], v2 offset:64512
  v_mfma_f32_16x16x32_bf16 v[228:231], a[24:27], a[68:71], v[228:231]
  s_add_u32 s60, s60, 229376
  s_waitcnt lgkmcnt(15)
  v_mfma_f32_16x16x32_bf16 v[128:131], a[32:35], a[80:83], v[128:131]
  v_mfma_f32_16x16x32_bf16 v[144:147], a[36:39], a[80:83], v[144:147]
  s_waitcnt lgkmcnt(0)
  v_mfma_f32_16x16x32_bf16 v[148:151], a[36:39], a[84:87], v[148:151]
  s_lshl_b32 s98, s3, 16
  v_mfma_f32_16x16x32_bf16 v[132:135], a[32:35], a[84:87], v[132:135]
  s_add_u32 s98, s98, 0
  v_mfma_f32_16x16x32_bf16 v[136:139], a[32:35], a[88:91], v[136:139]
  v_mfma_f32_16x16x32_bf16 v[152:155], a[36:39], a[88:91], v[152:155]
  s_add_u32 m0, s61, 32768
  v_mfma_f32_16x16x32_bf16 v[156:159], a[36:39], a[92:95], v[156:159]
  v_mfma_f32_16x16x32_bf16 v[140:143], a[32:35], a[92:95], v[140:143]
  buffer_load_dwordx4 v24, s[32:35], s98 offen offset:0  lds
  v_mfma_f32_16x16x32_bf16 v[168:171], a[40:43], a[88:91], v[168:171]
  buffer_load_dwordx4 v25, s[32:35], s98 offen offset:1024  lds
  s_waitcnt vmcnt(10)
  v_mfma_f32_16x16x32_bf16 v[184:187], a[44:47], a[88:91], v[184:187]
  ds_read_b64_tr_b16 a[0:1], v12 offset:0
  ds_read_b64_tr_b16 a[2:3], v12 offset:4096
  v_mfma_f32_16x16x32_bf16 v[188:191], a[44:47], a[92:95], v[188:191]
  buffer_load_dwordx4 v26, s[32:35], s98 offen offset:2048  lds
  v_mfma_f32_16x16x32_bf16 v[172:175], a[40:43], a[92:95], v[172:175]
  ds_read_b64_tr_b16 a[4:5], v13 offset:0
  ds_read_b64_tr_b16 a[6:7], v13 offset:4096
  v_lshrrev_b32 v30, 3, v1
  v_mfma_f32_16x16x32_bf16 v[160:163], a[40:43], a[80:83], v[160:163]
  buffer_load_dwordx4 v27, s[32:35], s98 offen offset:3072  lds
  v_mul_u32_u24 v30, 3584, v30
  v_mfma_f32_16x16x32_bf16 v[176:179], a[44:47], a[80:83], v[176:179]
  s_lshl_b32 s98, s3, 16
  ds_read_b64_tr_b16 a[8:9], v14 offset:0
  ds_read_b64_tr_b16 a[10:11], v14 offset:4096
  v_mfma_f32_16x16x32_bf16 v[180:183], a[44:47], a[84:87], v[180:183]
  v_lshrrev_b32 v31, 4, v1
  v_mfma_f32_16x16x32_bf16 v[164:167], a[40:43], a[84:87], v[164:167]
  s_add_u32 s98, s98, 32768
  ds_read_b64_tr_b16 a[12:13], v15 offset:0
  ds_read_b64_tr_b16 a[14:15], v15 offset:4096
  v_lshlrev_b32 v31, 5, v31
  v_mfma_f32_16x16x32_bf16 v[192:195], a[48:51], a[80:83], v[192:195]
  v_mfma_f32_16x16x32_bf16 v[208:211], a[52:55], a[80:83], v[208:211]
  s_add_u32 m0, s61, 36864
  v_and_b32 v40, 0x70, v0
  v_mfma_f32_16x16x32_bf16 v[212:215], a[52:55], a[84:87], v[212:215]
  v_xor_b32 v31, v31, v40
  v_mfma_f32_16x16x32_bf16 v[196:199], a[48:51], a[84:87], v[196:199]
  buffer_load_dwordx4 v24, s[32:35], s98 offen offset:0  lds
  ds_read_b64_tr_b16 a[16:17], v16 offset:0
  ds_read_b64_tr_b16 a[18:19], v16 offset:4096
  v_mfma_f32_16x16x32_bf16 v[200:203], a[48:51], a[88:91], v[200:203]
  buffer_load_dwordx4 v25, s[32:35], s98 offen offset:1024  lds
  v_add_u32 v20, v30, v31
  v_mfma_f32_16x16x32_bf16 v[216:219], a[52:55], a[88:91], v[216:219]
  ds_read_b64_tr_b16 a[20:21], v17 offset:0
  ds_read_b64_tr_b16 a[22:23], v17 offset:4096
  s_cmp_eq_u32 s3, 3
  s_cselect_b32 s56, 23, 31
  v_mfma_f32_16x16x32_bf16 v[220:223], a[52:55], a[92:95], v[220:223]
  buffer_load_dwordx4 v26, s[32:35], s98 offen offset:2048  lds
  v_mfma_f32_16x16x32_bf16 v[204:207], a[48:51], a[92:95], v[204:207]
  ds_read_b64_tr_b16 a[24:25], v18 offset:0
  ds_read_b64_tr_b16 a[26:27], v18 offset:4096
  v_and_b32 v31, 64, v31
  v_mfma_f32_16x16x32_bf16 v[232:235], a[56:59], a[88:91], v[232:235]
  buffer_load_dwordx4 v27, s[32:35], s98 offen offset:3072  lds
  ds_read_b64_tr_b16 a[28:29], v19 offset:0
  ds_read_b64_tr_b16 a[30:31], v19 offset:4096
  v_lshlrev_b32 v31, s56, v31
  v_mfma_f32_16x16x32_bf16 v[248:251], a[60:63], a[88:91], v[248:251]
  s_waitcnt vmcnt(29)
  v_bfe_u32 v47, v47, 0, 8
  v_cmp_gt_u32 vcc, 8, v47
  s_cbranch_vccz L_rdy_5
  s_mov_b32 s101, 0
L_spin_6:
  buffer_load_dword v47, v46, s[48:51], 0 offen sc1
  s_waitcnt vmcnt(0)
  s_add_u32 s101, s101, 1
  s_cmp_gt_u32 s101, 0x40000
  s_cbranch_scc1 L_ok_7
  v_bfe_u32 v47, v47, 0, 8
  v_cmp_gt_u32 vcc, 8, v47
  s_cbranch_vccnz L_spin_6
L_ok_7:
L_rdy_5:
  s_barrier
  v_mfma_f32_16x16x32_bf16 v[252:255], a[60:63], a[92:95], v[252:255]
  v_add_u32 v20, v20, v31
  v_mfma_f32_16x16x32_bf16 v[236:239], a[56:59], a[92:95], v[236:239]
  s_add_u32 m0, s75, 0
  s_add_u32 s99, s77, 112
  buffer_load_dwordx4 v41, s[52:55], s99 offen sc1 lds
  v_add_u32 v21, 27648, v20
  v_mfma_f32_16x16x32_bf16 v[224:227], a[56:59], a[80:83], v[224:227]
  v_mfma_f32_16x16x32_bf16 v[240:243], a[60:63], a[80:83], v[240:243]
  s_add_u32 m0, s75, 1024
  s_add_u32 s99, s77, 132208
  buffer_load_dwordx4 v41, s[52:55], s99 offen sc1 lds
  v_add_u32 v22, 55296, v20
  v_mfma_f32_16x16x32_bf16 v[244:247], a[60:63], a[84:87], v[244:247]
  v_add_u32 v23, 82944, v20
  v_mfma_f32_16x16x32_bf16 v[228:231], a[56:59], a[84:87], v[228:231]
  s_waitcnt lgkmcnt(8)
  v_mfma_f32_16x16x32_bf16 v[128:131], a[0:3], a[96:99], v[128:131]
  v_mfma_f32_16x16x32_bf16 v[144:147], a[4:7], a[96:99], v[144:147]
  s_waitcnt lgkmcnt(0)
  v_mfma_f32_16x16x32_bf16 v[148:151], a[4:7], a[100:103], v[148:151]
  s_lshl_b32 s98, s3, 16
  v_mfma_f32_16x16x32_bf16 v[132:135], a[0:3], a[100:103], v[132:135]
  s_add_u32 s98, s98, 262144
  v_mfma_f32_16x16x32_bf16 v[136:139], a[0:3], a[104:107], v[136:139]
  v_mfma_f32_16x16x32_bf16 v[152:155], a[4:7], a[104:107], v[152:155]
  s_add_u32 m0, s61, 65536
  v_mfma_f32_16x16x32_bf16 v[156:159], a[4:7], a[108:111], v[156:159]
  v_mfma_f32_16x16x32_bf16 v[140:143], a[0:3], a[108:111], v[140:143]
  buffer_load_dwordx4 v24, s[32:35], s98 offen offset:0  lds
  v_mfma_f32_16x16x32_bf16 v[168:171], a[8:11], a[104:107], v[168:171]
  s_waitcnt vmcnt(11)
  v_mfma_f32_16x16x32_bf16 v[184:187], a[12:15], a[104:107], v[184:187]
  buffer_load_dwordx4 v25, s[32:35], s98 offen offset:1024  lds
  ds_read_b64_tr_b16 a[32:33], v4 offset:0
  ds_read_b64_tr_b16 a[34:35], v4 offset:4096
  v_mfma_f32_16x16x32_bf16 v[188:191], a[12:15], a[108:111], v[188:191]
  v_mfma_f32_16x16x32_bf16 v[172:175], a[8:11], a[108:111], v[172:175]
  buffer_load_dwordx4 v26, s[32:35], s98 offen offset:2048  lds
  ds_read_b64_tr_b16 a[36:37], v5 offset:0
  ds_read_b64_tr_b16 a[38:39], v5 offset:4096
  v_mfma_f32_16x16x32_bf16 v[160:163], a[8:11], a[96:99], v[160:163]
  buffer_load_dwordx4 v27, s[32:35], s98 offen offset:3072  lds
  v_mfma_f32_16x16x32_bf16 v[176:179], a[12:15], a[96:99], v[176:179]
  ds_read_b64_tr_b16 a[40:41], v6 offset:0
  ds_read_b64_tr_b16 a[42:43], v6 offset:4096
  v_mfma_f32_16x16x32_bf16 v[180:183], a[12:15], a[100:103], v[180:183]
  s_lshl_b32 s98, s3, 16
  v_mfma_f32_16x16x32_bf16 v[164:167], a[8:11], a[100:103], v[164:167]
  ds_read_b64_tr_b16 a[44:45], v7 offset:0
  ds_read_b64_tr_b16 a[46:47], v7 offset:4096
  v_mfma_f32_16x16x32_bf16 v[192:195], a[16:19], a[96:99], v[192:195]
  s_add_u32 s98, s98, 294912
  v_mfma_f32_16x16x32_bf16 v[208:211], a[20:23], a[96:99], v[208:211]
  v_mfma_f32_16x16x32_bf16 v[212:215], a[20:23], a[100:103], v[212:215]
  s_add_u32 m0, s61, 69632
  v_mfma_f32_16x16x32_bf16 v[196:199], a[16:19], a[100:103], v[196:199]
  ds_read_b64_tr_b16 a[48:49], v8 offset:0
  ds_read_b64_tr_b16 a[50:51], v8 offset:4096
  v_mfma_f32_16x16x32_bf16 v[200:203], a[16:19], a[104:107], v[200:203]
  buffer_load_dwordx4 v24, s[32:35], s98 offen offset:0  lds
  v_mfma_f32_16x16x32_bf16 v[216:219], a[20:23], a[104:107], v[216:219]
  buffer_load_dwordx4 v25, s[32:35], s98 offen offset:1024  lds
  ds_read_b64_tr_b16 a[52:53], v9 offset:0
  ds_read_b64_tr_b16 a[54:55], v9 offset:4096
  v_mfma_f32_16x16x32_bf16 v[220:223], a[20:23], a[108:111], v[220:223]
  v_mfma_f32_16x16x32_bf16 v[204:207], a[16:19], a[108:111], v[204:207]
  buffer_load_dwordx4 v26, s[32:35], s98 offen offset:2048  lds
  ds_read_b64_tr_b16 a[56:57], v10 offset:0
  ds_read_b64_tr_b16 a[58:59], v10 offset:4096
  v_mfma_f32_16x16x32_bf16 v[232:235], a[24:27], a[104:107], v[232:235]
  ds_read_b64_tr_b16 a[60:61], v11 offset:0
  ds_read_b64_tr_b16 a[62:63], v11 offset:4096
  v_mfma_f32_16x16x32_bf16 v[248:251], a[28:31], a[104:107], v[248:251]
  buffer_load_dwordx4 v27, s[32:35], s98 offen offset:3072  lds
  v_mfma_f32_16x16x32_bf16 v[252:255], a[28:31], a[108:111], v[252:255]
  v_lshrrev_b32 v30, 4, v1
  s_lshl_b32 s56, s3, 3
  v_add_u32 v30, s56, v30
  v_mfma_f32_16x16x32_bf16 v[236:239], a[24:27], a[108:111], v[236:239]
  s_add_u32 m0, s75, 2048
  s_add_u32 s99, s77, 264304
  buffer_load_dwordx4 v41, s[52:55], s99 offen sc1 lds
  v_and_b32 v31, 0xf0, v0
  v_lshl_add_u32 v31, v30, 8, v31
  v_mfma_f32_16x16x32_bf16 v[224:227], a[24:27], a[96:99], v[224:227]
  v_and_b32 v40, 15, v30
  v_lshlrev_b32 v40, 4, v40
  v_mfma_f32_16x16x32_bf16 v[240:243], a[28:31], a[96:99], v[240:243]
  s_add_u32 m0, s75, 3072
  s_add_u32 s99, s77, 396400
  buffer_load_dwordx4 v41, s[52:55], s99 offen sc1 lds
  v_xor_b32 v24, v31, v40
  v_xor_b32 v25, 0x40, v24
  v_mfma_f32_16x16x32_bf16 v[244:247], a[28:31], a[100:103], v[244:247]
  v_and_b32 v40, 7, v30
  v_lshlrev_b32 v40, 5, v40
  v_mfma_f32_16x16x32_bf16 v[228:231], a[24:27], a[100:103], v[228:231]
  v_xor_b32 v26, v31, v40
  v_xor_b32 v27, 0x80, v26
  s_waitcnt lgkmcnt(8)
  v_mfma_f32_16x16x32_bf16 v[128:131], a[32:35], a[112:115], v[128:131]
  v_mfma_f32_16x16x32_bf16 v[144:147], a[36:39], a[112:115], v[144:147]
  s_waitcnt lgkmcnt(0)
  v_mfma_f32_16x16x32_bf16 v[148:151], a[36:39], a[116:119], v[148:151]
  s_barrier
  v_lshrrev_b32 v30, 4, v1
  v_mfma_f32_16x16x32_bf16 v[132:135], a[32:35], a[116:119], v[132:135]
  v_bfe_u32 v31, v1, 2, 2
  v_mfma_f32_16x16x32_bf16 v[136:139], a[32:35], a[120:123], v[136:139]
  v_and_b32 v40, 1, v30
  v_mfma_f32_16x16x32_bf16 v[152:155], a[36:39], a[120:123], v[152:155]
  v_lshl_add_u32 v40, v40, 2, v31
  v_mfma_f32_16x16x32_bf16 v[156:159], a[36:39], a[124:127], v[156:159]
  s_add_u32 m0, s75, 4096
  s_add_u32 s99, s77, 528528
  buffer_load_dwordx4 v41, s[52:55], s99 offen sc1 lds
  v_lshrrev_b32 v30, 1, v30
  v_mfma_f32_16x16x32_bf16 v[140:143], a[32:35], a[124:127], v[140:143]
  v_lshlrev_b32 v30, 12, v30
  v_mfma_f32_16x16x32_bf16 v[168:171], a[40:43], a[120:123], v[168:171]
  v_lshl_add_u32 v4, v40, 8, v30
  v_mfma_f32_16x16x32_bf16 v[184:187], a[44:47], a[120:123], v[184:187]
  v_and_b32 v31, 3, v1
  v_mfma_f32_16x16x32_bf16 v[188:191], a[44:47], a[124:127], v[188:191]
  s_add_u32 m0, s75, 5120
  s_add_u32 s99, s77, 660624
  buffer_load_dwordx4 v41, s[52:55], s99 offen sc1 lds
  v_lshl_add_u32 v4, v31, 3, v4
  v_mfma_f32_16x16x32_bf16 v[172:175], a[40:43], a[124:127], v[172:175]
  v_lshl_add_u32 v4, v40, 5, v4
  v_mfma_f32_16x16x32_bf16 v[160:163], a[40:43], a[112:115], v[160:163]
  v_add_u32 v4, 34816, v4
  v_mfma_f32_16x16x32_bf16 v[176:179], a[44:47], a[112:115], v[176:179]
  v_xor_b32 v5, 32, v4
  v_mfma_f32_16x16x32_bf16 v[180:183], a[44:47], a[116:119], v[180:183]
  s_add_u32 m0, s75, 6144
  s_add_u32 s99, s77, 792720
  buffer_load_dwordx4 v41, s[52:55], s99 offen sc1 lds
  v_xor_b32 v6, 64, v4
  v_mfma_f32_16x16x32_bf16 v[164:167], a[40:43], a[116:119], v[164:167]
  v_xor_b32 v7, 96, v4
  v_mfma_f32_16x16x32_bf16 v[192:195], a[48:51], a[112:115], v[192:195]
  v_xor_b32 v8, 128, v4
  v_mfma_f32_16x16x32_bf16 v[208:211], a[52:55], a[112:115], v[208:211]
  v_xor_b32 v9, 160, v4
  v_mfma_f32_16x16x32_bf16 v[212:215], a[52:55], a[116:119], v[212:215]
  v_xor_b32 v10, 192, v4
  v_mfma_f32_16x16x32_bf16 v[196:199], a[48:51], a[116:119], v[196:199]
  s_add_u32 m0, s75, 7168
  s_add_u32 s99, s77, 924816
  buffer_load_dwordx4 v41, s[52:55], s99 offen sc1 lds
  v_xor_b32 v11, 224, v4
  v_mfma_f32_16x16x32_bf16 v[200:203], a[48:51], a[120:123], v[200:203]
  v_and_b32 v30, 8, v1
  v_mfma_f32_16x16x32_bf16 v[216:219], a[52:55], a[120:123], v[216:219]
  v_lshlrev_b32 v30, 9, v30
  v_mfma_f32_16x16x32_bf16 v[220:223], a[52:55], a[124:127], v[220:223]
  v_and_b32 v31, 7, v1
  v_mfma_f32_16x16x32_bf16 v[204:207], a[48:51], a[124:127], v[204:207]
  s_add_u32 m0, s75, 8192
  s_add_u32 s99, s77, 1056864
  buffer_load_dwordx4 v41, s[52:55], s99 offen sc1 lds
  v_lshl_add_u32 v30, v31, 8, v30
  v_mfma_f32_16x16x32_bf16 v[232:235], a[56:59], a[120:123], v[232:235]
  v_lshrrev_b32 v31, 4, v1
  v_mfma_f32_16x16x32_bf16 v[248:251], a[60:63], a[120:123], v[248:251]
  v_and_b32 v40, 15, v1
  v_mfma_f32_16x16x32_bf16 v[252:255], a[60:63], a[124:127], v[252:255]
  v_xor_b32 v31, v31, v40
  v_mfma_f32_16x16x32_bf16 v[236:239], a[56:59], a[124:127], v[236:239]
  s_add_u32 m0, s75, 9216
  s_add_u32 s99, s77, 1188960
  buffer_load_dwordx4 v41, s[52:55], s99 offen sc1 lds
  v_lshl_add_u32 v30, v31, 4, v30
  v_mfma_f32_16x16x32_bf16 v[224:227], a[56:59], a[112:115], v[224:227]
  v_add_u32 v12, 32768, v30
  v_mfma_f32_16x16x32_bf16 v[240:243], a[60:63], a[112:115], v[240:243]
  v_xor_b32 v13, 64, v12
  v_mfma_f32_16x16x32_bf16 v[244:247], a[60:63], a[116:119], v[244:247]
  v_xor_b32 v14, 128, v12
  v_mfma_f32_16x16x32_bf16 v[228:231], a[56:59], a[116:119], v[228:231]
  v_xor_b32 v15, 192, v12
  v_pk_mul_f32 v[128:129], v[128:129], v[48:49] op_sel_hi:[1,0]
  s_add_u32 m0, s75, 10240
  s_add_u32 s99, s77, 1321056
  buffer_load_dwordx4 v41, s[52:55], s99 offen sc1 lds
  v_pk_mul_f32 v[130:131], v[130:131], v[48:49] op_sel_hi:[1,0]
  v_pk_mul_f32 v[144:145], v[144:145], v[48:49] op_sel_hi:[1,0]
  v_pk_mul_f32 v[146:147], v[146:147], v[48:49] op_sel_hi:[1,0]
  v_cvt_pk_bf16_f32 v64, v128, v129
  v_cvt_pk_bf16_f32 v65, v130, v131
  v_cvt_pk_bf16_f32 v66, v144, v145
  v_cvt_pk_bf16_f32 v67, v146, v147
  v_pk_mul_f32 v[132:133], v[132:133], v[50:51] op_sel_hi:[1,0]
  v_pk_mul_f32 v[134:135], v[134:135], v[50:51] op_sel_hi:[1,0]
  v_pk_mul_f32 v[148:149], v[148:149], v[50:51] op_sel_hi:[1,0]
  v_pk_mul_f32 v[150:151], v[150:151], v[50:51] op_sel_hi:[1,0]
  v_cvt_pk_bf16_f32 v68, v132, v133
  v_cvt_pk_bf16_f32 v69, v134, v135
  v_cvt_pk_bf16_f32 v70, v148, v149
  v_cvt_pk_bf16_f32 v71, v150, v151
  v_pk_mul_f32 v[136:137], v[136:137], v[52:53] op_sel_hi:[1,0]
  v_pk_mul_f32 v[138:139], v[138:139], v[52:53] op_sel_hi:[1,0]
  v_pk_mul_f32 v[152:153], v[152:153], v[52:53] op_sel_hi:[1,0]
  v_pk_mul_f32 v[154:155], v[154:155], v[52:53] op_sel_hi:[1,0]
  v_cvt_pk_bf16_f32 v72, v136, v137
  v_cvt_pk_bf16_f32 v73, v138, v139
  v_cvt_pk_bf16_f32 v74, v152, v153
  v_cvt_pk_bf16_f32 v75, v154, v155
  v_pk_mul_f32 v[140:141], v[140:141], v[54:55] op_sel_hi:[1,0]
  v_pk_mul_f32 v[142:143], v[142:143], v[54:55] op_sel_hi:[1,0]
  v_pk_mul_f32 v[156:157], v[156:157], v[54:55] op_sel_hi:[1,0]
  v_pk_mul_f32 v[158:159], v[158:159], v[54:55] op_sel_hi:[1,0]
  v_cvt_pk_bf16_f32 v76, v140, v141
  v_cvt_pk_bf16_f32 v77, v142, v143
  v_cvt_pk_bf16_f32 v78, v156, v157
  s_add_u32 m0, s75, 11264
  s_add_u32 s99, s77, 1453152
  buffer_load_dwordx4 v41, s[52:55], s99 offen sc1 lds
  v_cvt_pk_bf16_f32 v79, v158, v159
  v_permlane32_swap_b32 v64, v66
  v_permlane32_swap_b32 v65, v67
  v_permlane32_swap_b32 v68, v70
  v_permlane32_swap_b32 v69, v71
  v_permlane32_swap_b32 v72, v74
  v_permlane32_swap_b32 v73, v75
  v_permlane32_swap_b32 v76, v78
  v_permlane32_swap_b32 v77, v79
  v_permlane16_swap_b32 v64, v66
  v_permlane16_swap_b32 v65, v67
  v_permlane16_swap_b32 v68, v70
  v_permlane16_swap_b32 v69, v71
  v_permlane16_swap_b32 v72, v74
  v_permlane16_swap_b32 v73, v75
  v_permlane16_swap_b32 v76, v78
  v_permlane16_swap_b32 v77, v79
  v_accvgpr_write_b32 a0, v64
  v_accvgpr_write_b32 a1, v65
  v_accvgpr_write_b32 a2, v66
  v_accvgpr_write_b32 a3, v67
  v_accvgpr_write_b32 a4, v68
  v_accvgpr_write_b32 a5, v69
  v_accvgpr_write_b32 a6, v70
  v_accvgpr_write_b32 a7, v71
  v_accvgpr_write_b32 a8, v72
  v_accvgpr_write_b32 a9, v73
  v_accvgpr_write_b32 a10, v74
  v_accvgpr_write_b32 a11, v75
  v_accvgpr_write_b32 a12, v76
  s_add_u32 m0, s75, 12288
  s_add_u32 s99, s77, 1585312
  buffer_load_dwordx4 v41, s[52:55], s99 offen sc1 lds
  v_accvgpr_write_b32 a13, v77
  v_accvgpr_write_b32 a14, v78
  v_accvgpr_write_b32 a15, v79
  v_pk_mul_f32 v[160:161], v[160:161], v[48:49] op_sel_hi:[1,0]
  v_pk_mul_f32 v[162:163], v[162:163], v[48:49] op_sel_hi:[1,0]
  v_pk_mul_f32 v[176:177], v[176:177], v[48:49] op_sel_hi:[1,0]
  v_pk_mul_f32 v[178:179], v[178:179], v[48:49] op_sel_hi:[1,0]
  v_cvt_pk_bf16_f32 v80, v160, v161
  v_cvt_pk_bf16_f32 v81, v162, v163
  v_cvt_pk_bf16_f32 v82, v176, v177
  v_cvt_pk_bf16_f32 v83, v178, v179
  v_pk_mul_f32 v[164:165], v[164:165], v[50:51] op_sel_hi:[1,0]
  v_pk_mul_f32 v[166:167], v[166:167], v[50:51] op_sel_hi:[1,0]
  v_pk_mul_f32 v[180:181], v[180:181], v[50:51] op_sel_hi:[1,0]
  v_pk_mul_f32 v[182:183], v[182:183], v[50:51] op_sel_hi:[1,0]
  v_cvt_pk_bf16_f32 v84, v164, v165
  v_cvt_pk_bf16_f32 v85, v166, v167
  v_cvt_pk_bf16_f32 v86, v180, v181
  v_cvt_pk_bf16_f32 v87, v182, v183
  v_pk_mul_f32 v[168:169], v[168:169], v[52:53] op_sel_hi:[1,0]
  v_pk_mul_f32 v[170:171], v[170:171], v[52:53] op_sel_hi:[1,0]
  v_pk_mul_f32 v[184:185], v[184:185], v[52:53] op_sel_hi:[1,0]
  v_pk_mul_f32 v[186:187], v[186:187], v[52:53] op_sel_hi:[1,0]
  v_cvt_pk_bf16_f32 v88, v168, v169
  v_cvt_pk_bf16_f32 v89, v170, v171
  v_cvt_pk_bf16_f32 v90, v184, v185
  v_cvt_pk_bf16_f32 v91, v186, v187
  v_pk_mul_f32 v[172:173], v[172:173], v[54:55] op_sel_hi:[1,0]
  v_pk_mul_f32 v[174:175], v[174:175], v[54:55] op_sel_hi:[1,0]
  v_pk_mul_f32 v[188:189], v[188:189], v[54:55] op_sel_hi:[1,0]
  v_pk_mul_f32 v[190:191], v[190:191], v[54:55] op_sel_hi:[1,0]
  s_add_u32 m0, s75, 13312
  s_add_u32 s99, s77, 1717408
  buffer_load_dwordx4 v41, s[52:55], s99 offen sc1 lds
  v_cvt_pk_bf16_f32 v92, v172, v173
  v_cvt_pk_bf16_f32 v93, v174, v175
  v_cvt_pk_bf16_f32 v94, v188, v189
  v_cvt_pk_bf16_f32 v95, v190, v191
  v_permlane32_swap_b32 v80, v82
  v_permlane32_swap_b32 v81, v83
  v_permlane32_swap_b32 v84, v86
  v_permlane32_swap_b32 v85, v87
  v_permlane32_swap_b32 v88, v90
  v_permlane32_swap_b32 v89, v91
  v_permlane32_swap_b32 v92, v94
  v_permlane32_swap_b32 v93, v95
  v_permlane16_swap_b32 v80, v82
  v_permlane16_swap_b32 v81, v83
  v_permlane16_swap_b32 v84, v86
  v_permlane16_swap_b32 v85, v87
  v_permlane16_swap_b32 v88, v90
  v_permlane16_swap_b32 v89, v91
  v_permlane16_swap_b32 v92, v94
  v_permlane16_swap_b32 v93, v95
  v_accvgpr_write_b32 a16, v80
  v_accvgpr_write_b32 a17, v81
  v_accvgpr_write_b32 a18, v82
  v_accvgpr_write_b32 a19, v83
  v_accvgpr_write_b32 a20, v84
  v_accvgpr_write_b32 a21, v85
  v_accvgpr_write_b32 a22, v86
  v_accvgpr_write_b32 a23, v87
  v_accvgpr_write_b32 a24, v88
  v_accvgpr_write_b32 a25, v89
  s_add_u32 m0, s75, 14336
  s_add_u32 s99, s77, 1849504
  buffer_load_dwordx4 v41, s[52:55], s99 offen sc1 lds
  v_accvgpr_write_b32 a26, v90
  v_accvgpr_write_b32 a27, v91
  v_accvgpr_write_b32 a28, v92
  v_accvgpr_write_b32 a29, v93
  v_accvgpr_write_b32 a30, v94
  v_accvgpr_write_b32 a31, v95
  v_pk_mul_f32 v[192:193], v[192:193], v[48:49] op_sel_hi:[1,0]
  v_pk_mul_f32 v[194:195], v[194:195], v[48:49] op_sel_hi:[1,0]
  v_pk_mul_f32 v[208:209], v[208:209], v[48:49] op_sel_hi:[1,0]
  v_pk_mul_f32 v[210:211], v[210:211], v[48:49] op_sel_hi:[1,0]
  v_cvt_pk_bf16_f32 v96, v192, v193
  v_cvt_pk_bf16_f32 v97, v194, v195
  v_cvt_pk_bf16_f32 v98, v208, v209
  v_cvt_pk_bf16_f32 v99, v210, v211
  v_pk_mul_f32 v[196:197], v[196:197], v[50:51] op_sel_hi:[1,0]
  v_pk_mul_f32 v[198:199], v[198:199], v[50:51] op_sel_hi:[1,0]
  v_pk_mul_f32 v[212:213], v[212:213], v[50:51] op_sel_hi:[1,0]
  v_pk_mul_f32 v[214:215], v[214:215], v[50:51] op_sel_hi:[1,0]
  v_cvt_pk_bf16_f32 v100, v196, v197
  v_cvt_pk_bf16_f32 v101, v198, v199
  v_cvt_pk_bf16_f32 v102, v212, v213
  v_cvt_pk_bf16_f32 v103, v214, v215
  v_pk_mul_f32 v[200:201], v[200:201], v[52:53] op_sel_hi:[1,0]
  v_pk_mul_f32 v[202:203], v[202:203], v[52:53] op_sel_hi:[1,0]
  v_pk_mul_f32 v[216:217], v[216:217], v[52:53] op_sel_hi:[1,0]
  v_pk_mul_f32 v[218:219], v[218:219], v[52:53] op_sel_hi:[1,0]
  v_cvt_pk_bf16_f32 v104, v200, v201
  v_cvt_pk_bf16_f32 v105, v202, v203
  v_cvt_pk_bf16_f32 v106, v216, v217
  v_cvt_pk_bf16_f32 v107, v218, v219
  s_add_u32 m0, s75, 15360
  s_add_u32 s99, s77, 1981600
  buffer_load_dwordx4 v41, s[52:55], s99 offen sc1 lds
  v_pk_mul_f32 v[204:205], v[204:205], v[54:55] op_sel_hi:[1,0]
  v_pk_mul_f32 v[206:207], v[206:207], v[54:55] op_sel_hi:[1,0]
  v_pk_mul_f32 v[220:221], v[220:221], v[54:55] op_sel_hi:[1,0]
  v_pk_mul_f32 v[222:223], v[222:223], v[54:55] op_sel_hi:[1,0]
  v_cvt_pk_bf16_f32 v108, v204, v205
  v_cvt_pk_bf16_f32 v109, v206, v207
  v_cvt_pk_bf16_f32 v110, v220, v221
  v_cvt_pk_bf16_f32 v111, v222, v223
  v_permlane32_swap_b32 v96, v98
  v_permlane32_swap_b32 v97, v99
  v_permlane32_swap_b32 v100, v102
  v_permlane32_swap_b32 v101, v103
  v_permlane32_swap_b32 v104, v106
  v_permlane32_swap_b32 v105, v107
  v_permlane32_swap_b32 v108, v110
  v_permlane32_swap_b32 v109, v111
  v_permlane16_swap_b32 v96, v98
  v_permlane16_swap_b32 v97, v99
  v_permlane16_swap_b32 v100, v102
  v_permlane16_swap_b32 v101, v103
  v_permlane16_swap_b32 v104, v106
  v_permlane16_swap_b32 v105, v107
  v_permlane16_swap_b32 v108, v110
  v_permlane16_swap_b32 v109, v111
  v_accvgpr_write_b32 a32, v96
  v_accvgpr_write_b32 a33, v97
  v_accvgpr_write_b32 a34, v98
  v_accvgpr_write_b32 a35, v99
  v_accvgpr_write_b32 a36, v100
  v_accvgpr_write_b32 a37, v101
  v_accvgpr_write_b32 a38, v102
  s_add_u32 m0, s63, 65536
  s_nop 0
  buffer_load_dwordx4 v24, s[12:15], s62 offen offset:0 lds
  v_accvgpr_write_b32 a39, v103
  v_accvgpr_write_b32 a40, v104
  v_accvgpr_write_b32 a41, v105
  v_accvgpr_write_b32 a42, v106
  v_accvgpr_write_b32 a43, v107
  v_accvgpr_write_b32 a44, v108
  v_accvgpr_write_b32 a45, v109
  v_accvgpr_write_b32 a46, v110
  v_accvgpr_write_b32 a47, v111
  v_pk_mul_f32 v[224:225], v[224:225], v[48:49] op_sel_hi:[1,0]
  v_pk_mul_f32 v[226:227], v[226:227], v[48:49] op_sel_hi:[1,0]
  v_pk_mul_f32 v[240:241], v[240:241], v[48:49] op_sel_hi:[1,0]
  v_pk_mul_f32 v[242:243], v[242:243], v[48:49] op_sel_hi:[1,0]
  v_cvt_pk_bf16_f32 v112, v224, v225
  v_cvt_pk_bf16_f32 v113, v226, v227
  v_cvt_pk_bf16_f32 v114, v240, v241
  v_cvt_pk_bf16_f32 v115, v242, v243
  v_pk_mul_f32 v[228:229], v[228:229], v[50:51] op_sel_hi:[1,0]
  v_pk_mul_f32 v[230:231], v[230:231], v[50:51] op_sel_hi:[1,0]
  v_pk_mul_f32 v[244:245], v[244:245], v[50:51] op_sel_hi:[1,0]
  v_pk_mul_f32 v[246:247], v[246:247], v[50:51] op_sel_hi:[1,0]
  v_cvt_pk_bf16_f32 v116, v228, v229
  v_cvt_pk_bf16_f32 v117, v230, v231
  v_cvt_pk_bf16_f32 v118, v244, v245
  v_cvt_pk_bf16_f32 v119, v246, v247
  v_pk_mul_f32 v[232:233], v[232:233], v[52:53] op_sel_hi:[1,0]
  v_pk_mul_f32 v[234:235], v[234:235], v[52:53] op_sel_hi:[1,0]
  v_pk_mul_f32 v[248:249], v[248:249], v[52:53] op_sel_hi:[1,0]
  v_pk_mul_f32 v[250:251], v[250:251], v[52:53] op_sel_hi:[1,0]
  v_cvt_pk_bf16_f32 v120, v232, v233
  buffer_load_dwordx4 v25, s[12:15], s62 offen offset:1024 lds
  s_add_u32 s62, s62, 8192
  v_cvt_pk_bf16_f32 v121, v234, v235
  v_cvt_pk_bf16_f32 v122, v248, v249
  v_cvt_pk_bf16_f32 v123, v250, v251
  v_pk_mul_f32 v[236:237], v[236:237], v[54:55] op_sel_hi:[1,0]
  v_pk_mul_f32 v[238:239], v[238:239], v[54:55] op_sel_hi:[1,0]
  v_pk_mul_f32 v[252:253], v[252:253], v[54:55] op_sel_hi:[1,0]
  v_pk_mul_f32 v[254:255], v[254:255], v[54:55] op_sel_hi:[1,0]
  v_cvt_pk_bf16_f32 v124, v236, v237
  v_cvt_pk_bf16_f32 v125, v238, v239
  v_cvt_pk_bf16_f32 v126, v252, v253
  v_cvt_pk_bf16_f32 v127, v254, v255
  v_permlane32_swap_b32 v112, v114
  v_permlane32_swap_b32 v113, v115
  v_permlane32_swap_b32 v116, v118
  v_permlane32_swap_b32 v117, v119
  v_permlane32_swap_b32 v120, v122
  v_permlane32_swap_b32 v121, v123
  v_permlane32_swap_b32 v124, v126
  v_permlane32_swap_b32 v125, v127
  v_permlane16_swap_b32 v112, v114
  v_permlane16_swap_b32 v113, v115
  v_permlane16_swap_b32 v116, v118
  v_permlane16_swap_b32 v117, v119
  v_permlane16_swap_b32 v120, v122
  v_permlane16_swap_b32 v121, v123
  v_permlane16_swap_b32 v124, v126
  v_permlane16_swap_b32 v125, v127
  v_accvgpr_write_b32 a48, v112
  v_accvgpr_write_b32 a49, v113
  v_accvgpr_write_b32 a50, v114
  v_accvgpr_write_b32 a51, v115
  v_accvgpr_write_b32 a52, v116
  v_accvgpr_write_b32 a53, v117
  v_accvgpr_write_b32 a54, v118
  v_accvgpr_write_b32 a55, v119
  v_accvgpr_write_b32 a56, v120
  v_accvgpr_write_b32 a57, v121
  v_accvgpr_write_b32 a58, v122
  v_accvgpr_write_b32 a59, v123
  v_accvgpr_write_b32 a60, v124
  v_accvgpr_write_b32 a61, v125
  v_accvgpr_write_b32 a62, v126
  v_accvgpr_write_b32 a63, v127
  s_waitcnt vmcnt(2)
  s_barrier
  ds_read_b128 a[72:75], v3 offset:0
  ds_read_b128 a[76:79], v3 offset:16384
  ds_read_b64_tr_b16 a[64:65], v28 offset:0
  ds_read_b64_tr_b16 a[66:67], v28 offset:2048
  ds_read_b64_tr_b16 a[68:69], v29 offset:0
  ds_read_b64_tr_b16 a[70:71], v29 offset:2048
  ds_read_b128 a[88:91], v3 offset:1024
  ds_read_b128 a[92:95], v3 offset:17408
  ds_read_b64_tr_b16 a[80:81], v28 offset:4096
  ds_read_b64_tr_b16 a[82:83], v28 offset:6144
  ds_read_b64_tr_b16 a[84:85], v29 offset:4096
  ds_read_b64_tr_b16 a[86:87], v29 offset:6144
  ds_read_b128 a[104:107], v3 offset:2048
  ds_read_b128 a[108:111], v3 offset:18432
  ds_read_b64_tr_b16 a[96:97], v28 offset:8192
  ds_read_b64_tr_b16 a[98:99], v28 offset:10240
  ds_read_b64_tr_b16 a[100:101], v29 offset:8192
  ds_read_b64_tr_b16 a[102:103], v29 offset:10240
  s_waitcnt lgkmcnt(12)
  v_mfma_f32_16x16x32_bf16 v[48:51], a[64:67], a[72:75], 0
  ds_read_b128 a[120:123], v3 offset:3072
  ds_read_b128 a[124:127], v3 offset:19456
  v_mfma_f32_16x16x32_bf16 v[52:55], a[64:67], a[76:79], 0
  ds_read_b64_tr_b16 a[112:113], v28 offset:12288
  ds_read_b64_tr_b16 a[114:115], v28 offset:14336
  s_add_u32 m0, s63, 81920
  v_mfma_f32_16x16x32_bf16 v[56:59], a[68:71], a[72:75], 0
  ds_read_b64_tr_b16 a[116:117], v29 offset:12288
  ds_read_b64_tr_b16 a[118:119], v29 offset:14336
  v_mfma_f32_16x16x32_bf16 v[60:63], a[68:71], a[76:79], 0
  s_waitcnt lgkmcnt(12)
  v_mfma_f32_16x16x32_bf16 v[48:51], a[80:83], a[88:91], v[48:51]
  ds_read_b128 a[72:75], v3 offset:4096
  ds_read_b128 a[76:79], v3 offset:20480
  buffer_load_dwordx4 v24, s[12:15], s62 offen offset:0 lds
  v_mfma_f32_16x16x32_bf16 v[52:55], a[80:83], a[92:95], v[52:55]
  ds_read_b64_tr_b16 a[64:65], v28 offset:16384
  ds_read_b64_tr_b16 a[66:67], v28 offset:18432
  v_mfma_f32_16x16x32_bf16 v[56:59], a[84:87], a[88:91], v[56:59]
  ds_read_b64_tr_b16 a[68:69], v29 offset:16384
  ds_read_b64_tr_b16 a[70:71], v29 offset:18432
  v_mfma_f32_16x16x32_bf16 v[60:63], a[84:87], a[92:95], v[60:63]
  s_waitcnt lgkmcnt(12)
  buffer_load_dwordx4 v25, s[12:15], s62 offen offset:1024 lds
  v_mfma_f32_16x16x32_bf16 v[48:51], a[96:99], a[104:107], v[48:51]
  ds_read_b128 a[88:91], v3 offset:5120
  ds_read_b128 a[92:95], v3 offset:21504
  v_mfma_f32_16x16x32_bf16 v[52:55], a[96:99], a[108:111], v[52:55]
  ds_read_b64_tr_b16 a[80:81], v28 offset:20480
  ds_read_b64_tr_b16 a[82:83], v28 offset:22528
  v_mfma_f32_16x16x32_bf16 v[56:59], a[100:103], a[104:107], v[56:59]
  ds_read_b64_tr_b16 a[84:85], v29 offset:20480
  ds_read_b64_tr_b16 a[86:87], v29 offset:22528
  v_mfma_f32_16x16x32_bf16 v[60:63], a[100:103], a[108:111], v[60:63]
  s_waitcnt lgkmcnt(12)
  buffer_load_dwordx4 v26, s[16:19], s62 offen offset:2048 lds
  v_mfma_f32_16x16x32_bf16 v[48:51], a[112:115], a[120:123], v[48:51]
  ds_read_b128 a[104:107], v3 offset:6144
  ds_read_b128 a[108:111], v3 offset:22528
  v_mfma_f32_16x16x32_bf16 v[52:55], a[112:115], a[124:127], v[52:55]
  ds_read_b64_tr_b16 a[96:97], v28 offset:24576
  ds_read_b64_tr_b16 a[98:99], v28 offset:26624
  v_mfma_f32_16x16x32_bf16 v[56:59], a[116:119], a[120:123], v[56:59]
  ds_read_b64_tr_b16 a[100:101], v29 offset:24576
  ds_read_b64_tr_b16 a[102:103], v29 offset:26624
  buffer_load_dwordx4 v27, s[16:19], s62 offen offset:3072 lds
  v_mfma_f32_16x16x32_bf16 v[60:63], a[116:119], a[124:127], v[60:63]
  s_waitcnt lgkmcnt(12)
  v_mfma_f32_16x16x32_bf16 v[48:51], a[64:67], a[72:75], v[48:51]
  ds_read_b128 a[120:123], v3 offset:7168
  ds_read_b128 a[124:127], v3 offset:23552
  v_mfma_f32_16x16x32_bf16 v[52:55], a[64:67], a[76:79], v[52:55]
  ds_read_b64_tr_b16 a[112:113], v28 offset:28672
  ds_read_b64_tr_b16 a[114:115], v28 offset:30720
  s_add_u32 s62, s62, 8192
  v_mfma_f32_16x16x32_bf16 v[56:59], a[68:71], a[72:75], v[56:59]
  ds_read_b64_tr_b16 a[116:117], v29 offset:28672
  ds_read_b64_tr_b16 a[118:119], v29 offset:30720
  v_mfma_f32_16x16x32_bf16 v[60:63], a[68:71], a[76:79], v[60:63]
  s_waitcnt lgkmcnt(12)
  v_mfma_f32_16x16x32_bf16 v[48:51], a[80:83], a[88:91], v[48:51]
  ds_read_b128 a[72:75], v3 offset:8192
  ds_read_b128 a[76:79], v3 offset:24576
  v_mfma_f32_16x16x32_bf16 v[52:55], a[80:83], a[92:95], v[52:55]
  ds_read_b64_tr_b16 a[64:65], v28 offset:32768
  ds_read_b64_tr_b16 a[66:67], v28 offset:34816
  v_mfma_f32_16x16x32_bf16 v[56:59], a[84:87], a[88:91], v[56:59]
  ds_read_b64_tr_b16 a[68:69], v29 offset:32768
  ds_read_b64_tr_b16 a[70:71], v29 offset:34816
  v_mfma_f32_16x16x32_bf16 v[60:63], a[84:87], a[92:95], v[60:63]
  s_waitcnt lgkmcnt(12)
  v_mfma_f32_16x16x32_bf16 v[48:51], a[96:99], a[104:107], v[48:51]
  ds_read_b128 a[88:91], v3 offset:9216
  ds_read_b128 a[92:95], v3 offset:25600
  v_mfma_f32_16x16x32_bf16 v[52:55], a[96:99], a[108:111], v[52:55]
  ds_read_b64_tr_b16 a[80:81], v28 offset:36864
  ds_read_b64_tr_b16 a[82:83], v28 offset:38912
  v_mfma_f32_16x16x32_bf16 v[56:59], a[100:103], a[104:107], v[56:59]
  ds_read_b64_tr_b16 a[84:85], v29 offset:36864
  ds_read_b64_tr_b16 a[86:87], v29 offset:38912
  v_mfma_f32_16x16x32_bf16 v[60:63], a[100:103], a[108:111], v[60:63]
  s_waitcnt lgkmcnt(12)
  v_mfma_f32_16x16x32_bf16 v[48:51], a[112:115], a[120:123], v[48:51]
  ds_read_b128 a[104:107], v3 offset:10240
  ds_read_b128 a[108:111], v3 offset:26624
  v_mfma_f32_16x16x32_bf16 v[52:55], a[112:115], a[124:127], v[52:55]
  ds_read_b64_tr_b16 a[96:97], v28 offset:40960
  ds_read_b64_tr_b16 a[98:99], v28 offset:43008
  v_mfma_f32_16x16x32_bf16 v[56:59], a[116:119], a[120:123], v[56:59]
  ds_read_b64_tr_b16 a[100:101], v29 offset:40960
  ds_read_b64_tr_b16 a[102:103], v29 offset:43008
  v_mfma_f32_16x16x32_bf16 v[60:63], a[116:119], a[124:127], v[60:63]
  s_waitcnt lgkmcnt(12)
  v_mfma_f32_16x16x32_bf16 v[48:51], a[64:67], a[72:75], v[48:51]
  ds_read_b128 a[120:123], v3 offset:11264
  ds_read_b128 a[124:127], v3 offset:27648
  v_mfma_f32_16x16x32_bf16 v[52:55], a[64:67], a[76:79], v[52:55]
  ds_read_b64_tr_b16 a[112:113], v28 offset:45056
  ds_read_b64_tr_b16 a[114:115], v28 offset:47104
  v_mfma_f32_16x16x32_bf16 v[56:59], a[68:71], a[72:75], v[56:59]
  ds_read_b64_tr_b16 a[116:117], v29 offset:45056
  ds_read_b64_tr_b16 a[118:119], v29 offset:47104
  v_mfma_f32_16x16x32_bf16 v[60:63], a[68:71], a[76:79], v[60:63]
  s_waitcnt lgkmcnt(12)
  v_mfma_f32_16x16x32_bf16 v[48:51], a[80:83], a[88:91], v[48:51]
  ds_read_b128 a[72:75], v3 offset:12288
  ds_read_b128 a[76:79], v3 offset:28672
  v_mfma_f32_16x16x32_bf16 v[52:55], a[80:83], a[92:95], v[52:55]
  ds_read_b64_tr_b16 a[64:65], v28 offset:49152
  ds_read_b64_tr_b16 a[66:67], v28 offset:51200
  v_mfma_f32_16x16x32_bf16 v[56:59], a[84:87], a[88:91], v[56:59]
  ds_read_b64_tr_b16 a[68:69], v29 offset:49152
  ds_read_b64_tr_b16 a[70:71], v29 offset:51200
  v_mfma_f32_16x16x32_bf16 v[60:63], a[84:87], a[92:95], v[60:63]
  s_waitcnt lgkmcnt(12)
  v_mfma_f32_16x16x32_bf16 v[48:51], a[96:99], a[104:107], v[48:51]
  ds_read_b128 a[88:91], v3 offset:13312
  ds_read_b128 a[92:95], v3 offset:29696
  v_mfma_f32_16x16x32_bf16 v[52:55], a[96:99], a[108:111], v[52:55]
  ds_read_b64_tr_b16 a[80:81], v28 offset:53248
  ds_read_b64_tr_b16 a[82:83], v28 offset:55296
  v_mfma_f32_16x16x32_bf16 v[56:59], a[100:103], a[104:107], v[56:59]
  ds_read_b64_tr_b16 a[84:85], v29 offset:53248
  ds_read_b64_tr_b16 a[86:87], v29 offset:55296
  v_mfma_f32_16x16x32_bf16 v[60:63], a[100:103], a[108:111], v[60:63]
  s_waitcnt lgkmcnt(12)
  v_mfma_f32_16x16x32_bf16 v[48:51], a[112:115], a[120:123], v[48:51]
  ds_read_b128 a[104:107], v3 offset:14336
  ds_read_b128 a[108:111], v3 offset:30720
  v_mfma_f32_16x16x32_bf16 v[52:55], a[112:115], a[124:127], v[52:55]
  ds_read_b64_tr_b16 a[96:97], v28 offset:57344
  ds_read_b64_tr_b16 a[98:99], v28 offset:59392
  v_mfma_f32_16x16x32_bf16 v[56:59], a[116:119], a[120:123], v[56:59]
  ds_read_b64_tr_b16 a[100:101], v29 offset:57344
  ds_read_b64_tr_b16 a[102:103], v29 offset:59392
  v_mfma_f32_16x16x32_bf16 v[60:63], a[116:119], a[124:127], v[60:63]
  s_waitcnt lgkmcnt(12)
  v_mfma_f32_16x16x32_bf16 v[48:51], a[64:67], a[72:75], v[48:51]
  ds_read_b128 a[120:123], v3 offset:15360
  ds_read_b128 a[124:127], v3 offset:31744
  v_mfma_f32_16x16x32_bf16 v[52:55], a[64:67], a[76:79], v[52:55]
  ds_read_b64_tr_b16 a[112:113], v28 offset:61440
  ds_read_b64_tr_b16 a[114:115], v28 offset:63488
  v_mfma_f32_16x16x32_bf16 v[56:59], a[68:71], a[72:75], v[56:59]
  ds_read_b64_tr_b16 a[116:117], v29 offset:61440
  ds_read_b64_tr_b16 a[118:119], v29 offset:63488
  v_mfma_f32_16x16x32_bf16 v[60:63], a[68:71], a[76:79], v[60:63]
  s_waitcnt lgkmcnt(12)
  v_mfma_f32_16x16x32_bf16 v[48:51], a[80:83], a[88:91], v[48:51]
  v_mfma_f32_16x16x32_bf16 v[52:55], a[80:83], a[92:95], v[52:55]
  v_mfma_f32_16x16x32_bf16 v[56:59], a[84:87], a[88:91], v[56:59]
  v_mfma_f32_16x16x32_bf16 v[60:63], a[84:87], a[92:95], v[60:63]
  s_waitcnt lgkmcnt(6)
  v_mfma_f32_16x16x32_bf16 v[48:51], a[96:99], a[104:107], v[48:51]
  v_mfma_f32_16x16x32_bf16 v[52:55], a[96:99], a[108:111], v[52:55]
  v_mfma_f32_16x16x32_bf16 v[56:59], a[100:103], a[104:107], v[56:59]
  v_mfma_f32_16x16x32_bf16 v[60:63], a[100:103], a[108:111], v[60:63]
  s_waitcnt lgkmcnt(0)
  v_mfma_f32_16x16x32_bf16 v[48:51], a[112:115], a[120:123], v[48:51]
  v_mfma_f32_16x16x32_bf16 v[52:55], a[112:115], a[124:127], v[52:55]
  v_mfma_f32_16x16x32_bf16 v[56:59], a[116:119], a[120:123], v[56:59]
  v_mfma_f32_16x16x32_bf16 v[60:63], a[116:119], a[124:127], v[60:63]
  s_waitcnt vmcnt(4) lgkmcnt(0)
  s_barrier
  s_mov_b32 s60, 0
  ds_read_b128 a[144:147], v12 offset:32768
  ds_read_b128 a[148:151], v13 offset:32768
  ds_read_b128 a[152:155], v14 offset:32768
  ds_read_b128 a[156:159], v15 offset:32768
  ds_read_b128 a[160:163], v12 offset:40960
  ds_read_b128 a[164:167], v13 offset:40960
  ds_read_b128 a[168:171], v14 offset:40960
  ds_read_b128 a[172:175], v15 offset:40960
  v_mfma_f32_16x16x32_bf16 v[48:51], a[214:217], v[32:35], v[48:51]
  v_mfma_f32_16x16x32_bf16 v[52:55], a[214:217], v[36:39], v[52:55]
  v_mfma_f32_16x16x32_bf16 v[56:59], a[212:215], v[32:35], v[56:59]
  v_mfma_f32_16x16x32_bf16 v[60:63], a[212:215], v[36:39], v[60:63]
  s_waitcnt lgkmcnt(4)
  v_mfma_f32_16x16x32_bf16 v[64:67], a[144:147], a[0:3], 0
  v_mfma_f32_16x16x32_bf16 v[64:67], a[148:151], a[16:19], v[64:67]
  v_mfma_f32_16x16x32_bf16 v[64:67], a[152:155], a[32:35], v[64:67]
  v_mfma_f32_16x16x32_bf16 v[64:67], a[156:159], a[48:51], v[64:67]
  s_waitcnt lgkmcnt(0)
  v_cvt_pk_bf16_f32 v32, v48, v49
  v_cvt_pk_bf16_f32 v33, v50, v51
  v_mfma_f32_16x16x32_bf16 v[68:71], a[172:175], a[48:51], 0
  v_cvt_pk_bf16_f32 v34, v56, v57
  v_cvt_pk_bf16_f32 v35, v58, v59
  v_mfma_f32_16x16x32_bf16 v[68:71], a[168:171], a[32:35], v[68:71]
  v_cvt_pk_bf16_f32 v36, v52, v53
  v_mfma_f32_16x16x32_bf16 v[68:71], a[164:167], a[16:19], v[68:71]
  v_cvt_pk_bf16_f32 v37, v54, v55
  v_cvt_pk_bf16_f32 v38, v60, v61
  v_mfma_f32_16x16x32_bf16 v[68:71], a[160:163], a[0:3], v[68:71]
  v_cvt_pk_bf16_f32 v39, v62, v63
  v_mfma_f32_16x16x32_bf16 v[72:75], a[144:147], a[4:7], 0
  buffer_store_dwordx4 v[32:35], v0, s[52:55], s78 offen sc1
  s_add_u32 s98, s78, 16384
  v_mfma_f32_16x16x32_bf16 v[72:75], a[148:151], a[20:23], v[72:75]
  buffer_store_dwordx4 v[36:39], v0, s[52:55], s98 offen sc1
  v_mfma_f32_16x16x32_bf16 v[72:75], a[152:155], a[36:39], v[72:75]
  v_max3_f32 v48, v64, v65, v66
  v_max3_f32 v49, v67, v68, v69
  v_max3_f32 v48, v48, v70, v71
  v_max_f32 v48, v48, v49
  v_mfma_f32_16x16x32_bf16 v[72:75], a[156:159], a[52:55], v[72:75]
  v_mov_b32 v49, v48
  s_nop 1
  v_permlane32_swap_b32 v48, v49
  v_max_f32 v48, v48, v49
  v_mfma_f32_16x16x32_bf16 v[76:79], a[172:175], a[52:55], 0
  v_mov_b32 v49, v48
  s_nop 1
  v_permlane16_swap_b32 v48, v49
  v_max_f32 v48, v48, v49
  v_sub_f32 v48, 0, v48
  v_mfma_f32_16x16x32_bf16 v[76:79], a[168:171], a[36:39], v[76:79]
  v_mov_b32 v49, v48
  v_mov_b32 v50, v48
  v_mov_b32 v51, v48
  v_mfma_f32_16x16x32_bf16 v[76:79], a[164:167], a[20:23], v[76:79]
  v_add_f32 v64, v64, v48
  v_add_f32 v65, v65, v48
  v_add_f32 v66, v66, v48
  v_add_f32 v67, v67, v48
  v_mfma_f32_16x16x32_bf16 v[76:79], a[160:163], a[4:7], v[76:79]
  v_add_f32 v68, v68, v48
  v_add_f32 v69, v69, v48
  v_add_f32 v70, v70, v48
  v_mfma_f32_16x16x32_bf16 v[80:83], a[144:147], a[8:11], 0
  v_add_f32 v71, v71, v48
  s_add_u32 m0, s63, 32768
  s_nop 0
  buffer_load_dwordx4 v24, s[12:15], s62 offen offset:0 lds
  buffer_load_dwordx4 v25, s[12:15], s62 offen offset:1024 lds
  v_mfma_f32_16x16x32_bf16 v[80:83], a[148:151], a[24:27], v[80:83]
  buffer_load_dwordx4 v26, s[16:19], s62 offen offset:2048 lds
  buffer_load_dwordx4 v27, s[16:19], s62 offen offset:3072 lds
  s_add_u32 s62, s62, 8192
  v_mfma_f32_16x16x32_bf16 v[80:83], a[152:155], a[40:43], v[80:83]
  v_max3_f32 v52, v72, v73, v74
  v_max3_f32 v53, v75, v76, v77
  v_max3_f32 v52, v52, v78, v79
  v_max_f32 v52, v52, v53
  v_mfma_f32_16x16x32_bf16 v[80:83], a[156:159], a[56:59], v[80:83]
  v_mov_b32 v53, v52
  s_nop 1
  v_permlane32_swap_b32 v52, v53
  v_max_f32 v52, v52, v53
  v_mfma_f32_16x16x32_bf16 v[84:87], a[172:175], a[56:59], 0
  v_mov_b32 v53, v52
  s_nop 1
  v_permlane16_swap_b32 v52, v53
  v_max_f32 v52, v52, v53
  v_sub_f32 v52, 0, v52
  v_mfma_f32_16x16x32_bf16 v[84:87], a[168:171], a[40:43], v[84:87]
  v_mov_b32 v53, v52
  v_mov_b32 v54, v52
  v_mov_b32 v55, v52
  v_mfma_f32_16x16x32_bf16 v[84:87], a[164:167], a[24:27], v[84:87]
  v_add_f32 v72, v72, v52
  v_add_f32 v73, v73, v52
  v_add_f32 v74, v74, v52
  v_add_f32 v75, v75, v52
  v_mfma_f32_16x16x32_bf16 v[84:87], a[160:163], a[8:11], v[84:87]
  v_add_f32 v76, v76, v52
  v_add_f32 v77, v77, v52
  v_add_f32 v78, v78, v52
  v_mfma_f32_16x16x32_bf16 v[88:91], a[144:147], a[12:15], 0
  v_add_f32 v79, v79, v52
  s_add_u32 m0, s63, 49152
  s_nop 0
  buffer_load_dwordx4 v24, s[12:15], s62 offen offset:0 lds
  buffer_load_dwordx4 v25, s[12:15], s62 offen offset:1024 lds
  v_mfma_f32_16x16x32_bf16 v[88:91], a[148:151], a[28:31], v[88:91]
  buffer_load_dwordx4 v26, s[16:19], s62 offen offset:2048 lds
  buffer_load_dwordx4 v27, s[16:19], s62 offen offset:3072 lds
  s_add_u32 s62, s62, 8192
  v_mfma_f32_16x16x32_bf16 v[88:91], a[152:155], a[44:47], v[88:91]
  v_max3_f32 v56, v80, v81, v82
  v_max3_f32 v57, v83, v84, v85
  v_max3_f32 v56, v56, v86, v87
  v_max_f32 v56, v56, v57
  v_mfma_f32_16x16x32_bf16 v[88:91], a[156:159], a[60:63], v[88:91]
  v_mov_b32 v57, v56
  s_nop 1
  v_permlane32_swap_b32 v56, v57
  v_max_f32 v56, v56, v57
  v_mov_b32 v57, v56
  v_mfma_f32_16x16x32_bf16 v[92:95], a[172:175], a[60:63], 0
  s_nop 0
  v_permlane16_swap_b32 v56, v57
  v_max_f32 v56, v56, v57
  v_sub_f32 v56, 0, v56
  v_mfma_f32_16x16x32_bf16 v[92:95], a[168:171], a[44:47], v[92:95]
  v_mov_b32 v57, v56
  v_mov_b32 v58, v56
  v_mov_b32 v59, v56
  v_add_f32 v80, v80, v56
  v_mfma_f32_16x16x32_bf16 v[92:95], a[164:167], a[28:31], v[92:95]
  v_add_f32 v81, v81, v56
  v_add_f32 v82, v82, v56
  v_add_f32 v83, v83, v56
  v_add_f32 v84, v84, v56
  v_mfma_f32_16x16x32_bf16 v[92:95], a[160:163], a[12:15], v[92:95]
  v_add_f32 v85, v85, v56
  v_add_f32 v86, v86, v56
  v_add_f32 v87, v87, v56
  s_waitcnt vmcnt(10)
  s_barrier
  ds_read_b128 a[144:147], v12 offset:49152
  ds_read_b128 a[148:151], v13 offset:49152
  ds_read_b128 a[152:155], v14 offset:49152
  ds_read_b128 a[156:159], v15 offset:49152
  ds_read_b128 a[160:163], v12 offset:57344
  ds_read_b128 a[164:167], v13 offset:57344
  ds_read_b128 a[168:171], v14 offset:57344
  ds_read_b128 a[172:175], v15 offset:57344
  v_exp_f32 v64, v64
  s_add_u32 m0, s63, 65536
  s_nop 0
  buffer_load_dwordx4 v24, s[12:15], s62 offen offset:0 lds
  v_exp_f32 v65, v65
  v_exp_f32 v66, v66
  v_exp_f32 v67, v67
  v_exp_f32 v68, v68
  v_exp_f32 v69, v69
  v_exp_f32 v70, v70
  v_exp_f32 v71, v71
  v_cvt_pk_bf16_f32 v96, v64, v65
  v_cvt_pk_bf16_f32 v97, v66, v67
  v_cvt_pk_bf16_f32 v98, v68, v69
  v_cvt_pk_bf16_f32 v99, v70, v71
  v_max3_f32 v60, v88, v89, v90
  v_max3_f32 v61, v91, v92, v93
  v_max3_f32 v60, v60, v94, v95
  buffer_load_dwordx4 v25, s[12:15], s62 offen offset:1024 lds
  v_max_f32 v60, v60, v61
  v_mov_b32 v61, v60
  s_nop 1
  v_permlane32_swap_b32 v60, v61
  v_max_f32 v60, v60, v61
  v_mov_b32 v61, v60
  s_nop 1
  v_permlane16_swap_b32 v60, v61
  v_max_f32 v60, v60, v61
  v_sub_f32 v60, 0, v60
  v_mov_b32 v61, v60
  v_mov_b32 v62, v60
  v_mov_b32 v63, v60
  v_add_f32 v88, v88, v60
  v_add_f32 v89, v89, v60
  v_add_f32 v90, v90, v60
  v_add_f32 v91, v91, v60
  buffer_load_dwordx4 v26, s[16:19], s62 offen offset:2048 lds
  v_add_f32 v92, v92, v60
  v_add_f32 v93, v93, v60
  v_add_f32 v94, v94, v60
  v_add_f32 v95, v95, v60
  v_exp_f32 v72, v72
  v_exp_f32 v73, v73
  v_exp_f32 v74, v74
  v_exp_f32 v75, v75
  v_exp_f32 v76, v76
  v_exp_f32 v77, v77
  v_exp_f32 v78, v78
  v_exp_f32 v79, v79
  v_cvt_pk_bf16_f32 v100, v72, v73
  v_cvt_pk_bf16_f32 v101, v74, v75
  buffer_load_dwordx4 v27, s[16:19], s62 offen offset:3072 lds
  s_add_u32 s62, s62, 8192
  v_cvt_pk_bf16_f32 v102, v76, v77
  v_cvt_pk_bf16_f32 v103, v78, v79
  v_exp_f32 v80, v80
  v_exp_f32 v81, v81
  v_exp_f32 v82, v82
  v_exp_f32 v83, v83
  v_exp_f32 v84, v84
  v_exp_f32 v85, v85
  v_exp_f32 v86, v86
  v_exp_f32 v87, v87
  v_cvt_pk_bf16_f32 v104, v80, v81
  v_cvt_pk_bf16_f32 v105, v82, v83
  v_cvt_pk_bf16_f32 v106, v84, v85
  v_cvt_pk_bf16_f32 v107, v86, v87
L_attn:
  s_waitcnt lgkmcnt(4)
  v_mfma_f32_16x16x32_bf16 v[64:67], a[144:147], a[0:3], v[48:51]
  v_exp_f32 v88, v88
  v_mfma_f32_16x16x32_bf16 v[64:67], a[148:151], a[16:19], v[64:67]
  ds_read_b64_tr_b16 a[176:177], v4 offset:49152
  ds_read_b64_tr_b16 a[178:179], v4 offset:57344
  v_mfma_f32_16x16x32_bf16 v[64:67], a[152:155], a[32:35], v[64:67]
  v_exp_f32 v89, v89
  v_mfma_f32_16x16x32_bf16 v[64:67], a[156:159], a[48:51], v[64:67]
  s_waitcnt lgkmcnt(2)
  ds_read_b64_tr_b16 a[180:181], v5 offset:49152
  ds_read_b64_tr_b16 a[182:183], v5 offset:57344
  v_mfma_f32_16x16x32_bf16 v[68:71], a[172:175], a[48:51], v[48:51]
  v_exp_f32 v90, v90
  v_mfma_f32_16x16x32_bf16 v[68:71], a[168:171], a[32:35], v[68:71]
  v_cvt_pk_bf16_f32 v108, v88, v89
  v_mfma_f32_16x16x32_bf16 v[68:71], a[164:167], a[16:19], v[68:71]
  v_exp_f32 v91, v91
  v_mfma_f32_16x16x32_bf16 v[68:71], a[160:163], a[0:3], v[68:71]
  v_cvt_pk_bf16_f32 v109, v90, v91
  v_mfma_f32_16x16x32_bf16 v[72:75], a[144:147], a[4:7], v[52:55]
  v_exp_f32 v92, v92
  v_mfma_f32_16x16x32_bf16 v[72:75], a[148:151], a[20:23], v[72:75]
  ds_read_b64_tr_b16 a[184:185], v6 offset:49152
  ds_read_b64_tr_b16 a[186:187], v6 offset:57344
  v_mfma_f32_16x16x32_bf16 v[72:75], a[152:155], a[36:39], v[72:75]
  v_exp_f32 v93, v93
  v_mfma_f32_16x16x32_bf16 v[72:75], a[156:159], a[52:55], v[72:75]
  ds_read_b64_tr_b16 a[188:189], v7 offset:49152
  ds_read_b64_tr_b16 a[190:191], v7 offset:57344
  v_mfma_f32_16x16x32_bf16 v[76:79], a[172:175], a[52:55], v[52:55]
  v_exp_f32 v94, v94
  v_mfma_f32_16x16x32_bf16 v[76:79], a[168:171], a[36:39], v[76:79]
  v_cvt_pk_bf16_f32 v110, v92, v93
  v_mfma_f32_16x16x32_bf16 v[76:79], a[164:167], a[20:23], v[76:79]
  v_exp_f32 v95, v95
  v_mfma_f32_16x16x32_bf16 v[76:79], a[160:163], a[4:7], v[76:79]
  v_cvt_pk_bf16_f32 v111, v94, v95
  v_mfma_f32_16x16x32_bf16 v[80:83], a[144:147], a[8:11], v[56:59]
  v_exp_f32 v64, v64
  v_mfma_f32_16x16x32_bf16 v[80:83], a[148:151], a[24:27], v[80:83]
  ds_read_b64_tr_b16 a[192:193], v8 offset:49152
  ds_read_b64_tr_b16 a[194:195], v8 offset:57344
  v_mfma_f32_16x16x32_bf16 v[80:83], a[152:155], a[40:43], v[80:83]
  v_exp_f32 v65, v65
  v_mfma_f32_16x16x32_bf16 v[80:83], a[156:159], a[56:59], v[80:83]
  ds_read_b64_tr_b16 a[196:197], v9 offset:49152
  ds_read_b64_tr_b16 a[198:199], v9 offset:57344
  v_mfma_f32_16x16x32_bf16 v[84:87], a[172:175], a[56:59], v[56:59]
  v_exp_f32 v66, v66
  v_mfma_f32_16x16x32_bf16 v[84:87], a[168:171], a[40:43], v[84:87]
  v_cvt_pk_bf16_f32 v112, v64, v65
  v_mfma_f32_16x16x32_bf16 v[84:87], a[164:167], a[24:27], v[84:87]
  v_exp_f32 v67, v67
  v_mfma_f32_16x16x32_bf16 v[84:87], a[160:163], a[8:11], v[84:87]
  v_cvt_pk_bf16_f32 v113, v66, v67
  v_mfma_f32_16x16x32_bf16 v[88:91], a[144:147], a[12:15], v[60:63]
  v_exp_f32 v68, v68
  v_mfma_f32_16x16x32_bf16 v[88:91], a[148:151], a[28:31], v[88:91]
  ds_read_b64_tr_b16 a[200:201], v10 offset:49152
  ds_read_b64_tr_b16 a[202:203], v10 offset:57344
  v_mfma_f32_16x16x32_bf16 v[88:91], a[152:155], a[44:47], v[88:91]
  v_exp_f32 v69, v69
  v_mfma_f32_16x16x32_bf16 v[88:91], a[156:159], a[60:63], v[88:91]
  ds_read_b64_tr_b16 a[204:205], v11 offset:49152
  ds_read_b64_tr_b16 a[206:207], v11 offset:57344
  v_mfma_f32_16x16x32_bf16 v[92:95], a[172:175], a[60:63], v[60:63]
  v_exp_f32 v70, v70
  v_mfma_f32_16x16x32_bf16 v[92:95], a[168:171], a[44:47], v[92:95]
  v_cvt_pk_bf16_f32 v114, v68, v69
  v_mfma_f32_16x16x32_bf16 v[92:95], a[164:167], a[28:31], v[92:95]
  v_exp_f32 v71, v71
  v_mfma_f32_16x16x32_bf16 v[92:95], a[160:163], a[12:15], v[92:95]
  v_cvt_pk_bf16_f32 v115, v70, v71
  s_waitcnt lgkmcnt(8)
  v_mfma_f32_16x16x32_bf16 v[128:131], a[176:179], v[96:99], 0
  v_exp_f32 v72, v72
  v_mfma_f32_16x16x32_bf16 v[132:135], a[176:179], v[100:103], 0
  v_mfma_f32_16x16x32_bf16 v[148:151], a[180:183], v[100:103], 0
  v_exp_f32 v73, v73
  v_mfma_f32_16x16x32_bf16 v[144:147], a[180:183], v[96:99], 0
  s_waitcnt lgkmcnt(0)
  v_cvt_pk_bf16_f32 v116, v72, v73
  v_mfma_f32_16x16x32_bf16 v[160:163], a[184:187], v[96:99], 0
  v_exp_f32 v74, v74
  v_mfma_f32_16x16x32_bf16 v[164:167], a[184:187], v[100:103], 0
  s_waitcnt vmcnt(8)
  s_barrier
  s_or_b32 s56, s3, s100
  s_cmp_lg_u32 s56, 0
  s_cbranch_scc1 L_sig_8
  s_lshl_b32 s56, s4, 3
  v_mov_b32 v30, s56
  v_mov_b32 v31, 256
  s_mov_b64 exec, 1
  buffer_atomic_add v31, v30, s[48:51], 0 offen sc1
  s_mov_b64 exec, -1
L_sig_8:
  v_mfma_f32_16x16x32_bf16 v[180:183], a[188:191], v[100:103], 0
  v_exp_f32 v75, v75
  v_mfma_f32_16x16x32_bf16 v[176:179], a[188:191], v[96:99], 0
  v_cvt_pk_bf16_f32 v117, v74, v75
  v_mfma_f32_16x16x32_bf16 v[192:195], a[192:195], v[96:99], 0
  ds_read_b128 a[144:147], v12 offset:0
  ds_read_b128 a[148:151], v13 offset:0
  v_mfma_f32_16x16x32_bf16 v[196:199], a[192:195], v[100:103], 0
  v_exp_f32 v76, v76
  v_mfma_f32_16x16x32_bf16 v[212:215], a[196:199], v[100:103], 0
  s_add_u32 m0, s63, 81920
  v_mfma_f32_16x16x32_bf16 v[208:211], a[196:199], v[96:99], 0
  v_exp_f32 v77, v77
  v_mfma_f32_16x16x32_bf16 v[224:227], a[200:203], v[96:99], 0
  v_cvt_pk_bf16_f32 v118, v76, v77
  v_mfma_f32_16x16x32_bf16 v[228:231], a[200:203], v[100:103], 0
  v_exp_f32 v78, v78
  v_mfma_f32_16x16x32_bf16 v[244:247], a[204:207], v[100:103], 0
  buffer_load_dwordx4 v24, s[12:15], s62 offen offset:0 lds
  v_mfma_f32_16x16x32_bf16 v[240:243], a[204:207], v[96:99], 0
  v_exp_f32 v79, v79
  v_mfma_f32_16x16x32_bf16 a[128:131], a[208:211], v[96:99], 0
  v_cvt_pk_bf16_f32 v119, v78, v79
  v_mfma_f32_16x16x32_bf16 a[132:135], a[208:211], v[100:103], 0
  ds_read_b128 a[152:155], v14 offset:0
  ds_read_b128 a[156:159], v15 offset:0
  v_mfma_f32_16x16x32_bf16 v[252:255], a[204:207], v[108:111], 0
  v_exp_f32 v80, v80
  v_mfma_f32_16x16x32_bf16 v[248:251], a[204:207], v[104:107], 0
  buffer_load_dwordx4 v25, s[12:15], s62 offen offset:1024 lds
  v_mfma_f32_16x16x32_bf16 v[232:235], a[200:203], v[104:107], 0
  v_exp_f32 v81, v81
  v_mfma_f32_16x16x32_bf16 v[236:239], a[200:203], v[108:111], 0
  v_cvt_pk_bf16_f32 v120, v80, v81
  v_mfma_f32_16x16x32_bf16 v[220:223], a[196:199], v[108:111], 0
  v_exp_f32 v82, v82
  v_mfma_f32_16x16x32_bf16 v[216:219], a[196:199], v[104:107], 0
  buffer_load_dwordx4 v26, s[16:19], s62 offen offset:2048 lds
  v_mfma_f32_16x16x32_bf16 v[200:203], a[192:195], v[104:107], 0
  v_exp_f32 v83, v83
  v_mfma_f32_16x16x32_bf16 v[204:207], a[192:195], v[108:111], 0
  v_cvt_pk_bf16_f32 v121, v82, v83
  v_mfma_f32_16x16x32_bf16 v[188:191], a[188:191], v[108:111], 0
  ds_read_b128 a[160:163], v12 offset:8192
  ds_read_b128 a[164:167], v13 offset:8192
  v_mfma_f32_16x16x32_bf16 v[184:187], a[188:191], v[104:107], 0
  v_exp_f32 v84, v84
  v_mfma_f32_16x16x32_bf16 v[168:171], a[184:187], v[104:107], 0
  buffer_load_dwordx4 v27, s[16:19], s62 offen offset:3072 lds
  v_mfma_f32_16x16x32_bf16 v[172:175], a[184:187], v[108:111], 0
  v_exp_f32 v85, v85
  v_mfma_f32_16x16x32_bf16 v[156:159], a[180:183], v[108:111], 0
  v_cvt_pk_bf16_f32 v122, v84, v85
  v_mfma_f32_16x16x32_bf16 v[152:155], a[180:183], v[104:107], 0
  v_exp_f32 v86, v86
  v_mfma_f32_16x16x32_bf16 v[136:139], a[176:179], v[104:107], 0
  ds_read_b128 a[168:171], v14 offset:8192
  ds_read_b128 a[172:175], v15 offset:8192
  v_mfma_f32_16x16x32_bf16 v[140:143], a[176:179], v[108:111], 0
  v_exp_f32 v87, v87
  v_mfma_f32_16x16x32_bf16 a[136:139], a[208:211], v[104:107], 0
  v_cvt_pk_bf16_f32 v123, v86, v87
  v_mfma_f32_16x16x32_bf16 a[140:143], a[208:211], v[108:111], 0
  s_add_u32 s62, s62, 8192
  s_mov_b32 s101, 2
L_attn_loop:
  s_waitcnt lgkmcnt(4)
  v_mfma_f32_16x16x32_bf16 v[64:67], a[144:147], a[0:3], v[48:51]
  v_exp_f32 v88, v88
  v_mfma_f32_16x16x32_bf16 v[64:67], a[148:151], a[16:19], v[64:67]
  ds_read_b64_tr_b16 a[176:177], v4 offset:0
  ds_read_b64_tr_b16 a[178:179], v4 offset:8192
  v_mfma_f32_16x16x32_bf16 v[64:67], a[152:155], a[32:35], v[64:67]
  v_exp_f32 v89, v89
  v_mfma_f32_16x16x32_bf16 v[64:67], a[156:159], a[48:51], v[64:67]
  s_waitcnt lgkmcnt(2)
  ds_read_b64_tr_b16 a[180:181], v5 offset:0
  ds_read_b64_tr_b16 a[182:183], v5 offset:8192
  v_mfma_f32_16x16x32_bf16 v[68:71], a[172:175], a[48:51], v[48:51]
  v_exp_f32 v90, v90
  v_mfma_f32_16x16x32_bf16 v[68:71], a[168:171], a[32:35], v[68:71]
  v_cvt_pk_bf16_f32 v124, v88, v89
  v_mfma_f32_16x16x32_bf16 v[68:71], a[164:167], a[16:19], v[68:71]
  v_exp_f32 v91, v91
  v_mfma_f32_16x16x32_bf16 v[68:71], a[160:163], a[0:3], v[68:71]
  v_cvt_pk_bf16_f32 v125, v90, v91
  v_mfma_f32_16x16x32_bf16 v[72:75], a[144:147], a[4:7], v[52:55]
  v_exp_f32 v92, v92
  v_mfma_f32_16x16x32_bf16 v[72:75], a[148:151], a[20:23], v[72:75]
  ds_read_b64_tr_b16 a[184:185], v6 offset:0
  ds_read_b64_tr_b16 a[186:187], v6 offset:8192
  v_mfma_f32_16x16x32_bf16 v[72:75], a[152:155], a[36:39], v[72:75]
  v_exp_f32 v93, v93
  v_mfma_f32_16x16x32_bf16 v[72:75], a[156:159], a[52:55], v[72:75]
  ds_read_b64_tr_b16 a[188:189], v7 offset:0
  ds_read_b64_tr_b16 a[190:191], v7 offset:8192
  v_mfma_f32_16x16x32_bf16 v[76:79], a[172:175], a[52:55], v[52:55]
  v_exp_f32 v94, v94
  v_mfma_f32_16x16x32_bf16 v[76:79], a[168:171], a[36:39], v[76:79]
  v_cvt_pk_bf16_f32 v126, v92, v93
  v_mfma_f32_16x16x32_bf16 v[76:79], a[164:167], a[20:23], v[76:79]
  v_exp_f32 v95, v95
  v_mfma_f32_16x16x32_bf16 v[76:79], a[160:163], a[4:7], v[76:79]
  v_cvt_pk_bf16_f32 v127, v94, v95
  v_mfma_f32_16x16x32_bf16 v[80:83], a[144:147], a[8:11], v[56:59]
  v_exp_f32 v64, v64
  v_mfma_f32_16x16x32_bf16 v[80:83], a[148:151], a[24:27], v[80:83]
  ds_read_b64_tr_b16 a[192:193], v8 offset:0
  ds_read_b64_tr_b16 a[194:195], v8 offset:8192
  v_mfma_f32_16x16x32_bf16 v[80:83], a[152:155], a[40:43], v[80:83]
  v_exp_f32 v65, v65
  v_mfma_f32_16x16x32_bf16 v[80:83], a[156:159], a[56:59], v[80:83]
  ds_read_b64_tr_b16 a[196:197], v9 offset:0
  ds_read_b64_tr_b16 a[198:199], v9 offset:8192
  v_mfma_f32_16x16x32_bf16 v[84:87], a[172:175], a[56:59], v[56:59]
  v_exp_f32 v66, v66
  v_mfma_f32_16x16x32_bf16 v[84:87], a[168:171], a[40:43], v[84:87]
  v_cvt_pk_bf16_f32 v96, v64, v65
  v_mfma_f32_16x16x32_bf16 v[84:87], a[164:167], a[24:27], v[84:87]
  v_exp_f32 v67, v67
  v_mfma_f32_16x16x32_bf16 v[84:87], a[160:163], a[8:11], v[84:87]
  v_cvt_pk_bf16_f32 v97, v66, v67
  v_mfma_f32_16x16x32_bf16 v[88:91], a[144:147], a[12:15], v[60:63]
  v_exp_f32 v68, v68
  v_mfma_f32_16x16x32_bf16 v[88:91], a[148:151], a[28:31], v[88:91]
  ds_read_b64_tr_b16 a[200:201], v10 offset:0
  ds_read_b64_tr_b16 a[202:203], v10 offset:8192
  v_mfma_f32_16x16x32_bf16 v[88:91], a[152:155], a[44:47], v[88:91]
  v_exp_f32 v69, v69
  v_mfma_f32_16x16x32_bf16 v[88:91], a[156:159], a[60:63], v[88:91]
  ds_read_b64_tr_b16 a[204:205], v11 offset:0
  ds_read_b64_tr_b16 a[206:207], v11 offset:8192
  v_mfma_f32_16x16x32_bf16 v[92:95], a[172:175], a[60:63], v[60:63]
  v_exp_f32 v70, v70
  v_mfma_f32_16x16x32_bf16 v[92:95], a[168:171], a[44:47], v[92:95]
  v_cvt_pk_bf16_f32 v98, v68, v69
  v_mfma_f32_16x16x32_bf16 v[92:95], a[164:167], a[28:31], v[92:95]
  v_exp_f32 v71, v71
  v_mfma_f32_16x16x32_bf16 v[92:95], a[160:163], a[12:15], v[92:95]
  v_cvt_pk_bf16_f32 v99, v70, v71
  s_waitcnt lgkmcnt(8)
  v_mfma_f32_16x16x32_bf16 v[128:131], a[176:179], v[112:115], v[128:131]
  v_exp_f32 v72, v72
  v_mfma_f32_16x16x32_bf16 v[132:135], a[176:179], v[116:119], v[132:135]
  v_mfma_f32_16x16x32_bf16 v[148:151], a[180:183], v[116:119], v[148:151]
  v_exp_f32 v73, v73
  v_mfma_f32_16x16x32_bf16 v[144:147], a[180:183], v[112:115], v[144:147]
  s_waitcnt lgkmcnt(0)
  v_cvt_pk_bf16_f32 v100, v72, v73
  v_mfma_f32_16x16x32_bf16 v[160:163], a[184:187], v[112:115], v[160:163]
  v_exp_f32 v74, v74
  v_mfma_f32_16x16x32_bf16 v[164:167], a[184:187], v[116:119], v[164:167]
  s_waitcnt vmcnt(8)
  s_barrier
  v_mfma_f32_16x16x32_bf16 v[180:183], a[188:191], v[116:119], v[180:183]
  v_exp_f32 v75, v75
  v_mfma_f32_16x16x32_bf16 v[176:179], a[188:191], v[112:115], v[176:179]
  v_cvt_pk_bf16_f32 v101, v74, v75
  v_mfma_f32_16x16x32_bf16 v[192:195], a[192:195], v[112:115], v[192:195]
  ds_read_b128 a[144:147], v12 offset:16384
  ds_read_b128 a[148:151], v13 offset:16384
  v_mfma_f32_16x16x32_bf16 v[196:199], a[192:195], v[116:119], v[196:199]
  v_exp_f32 v76, v76
  v_mfma_f32_16x16x32_bf16 v[212:215], a[196:199], v[116:119], v[212:215]
  s_add_u32 m0, s63, 32768
  v_mfma_f32_16x16x32_bf16 v[208:211], a[196:199], v[112:115], v[208:211]
  v_exp_f32 v77, v77
  v_mfma_f32_16x16x32_bf16 v[224:227], a[200:203], v[112:115], v[224:227]
  v_cvt_pk_bf16_f32 v102, v76, v77
  v_mfma_f32_16x16x32_bf16 v[228:231], a[200:203], v[116:119], v[228:231]
  v_exp_f32 v78, v78
  v_mfma_f32_16x16x32_bf16 v[244:247], a[204:207], v[116:119], v[244:247]
  buffer_load_dwordx4 v24, s[12:15], s62 offen offset:0 lds
  v_mfma_f32_16x16x32_bf16 v[240:243], a[204:207], v[112:115], v[240:243]
  v_exp_f32 v79, v79
  v_mfma_f32_16x16x32_bf16 a[128:131], a[208:211], v[112:115], a[128:131]
  v_cvt_pk_bf16_f32 v103, v78, v79
  v_mfma_f32_16x16x32_bf16 a[132:135], a[208:211], v[116:119], a[132:135]
  ds_read_b128 a[152:155], v14 offset:16384
  ds_read_b128 a[156:159], v15 offset:16384
  v_mfma_f32_16x16x32_bf16 v[252:255], a[204:207], v[124:127], v[252:255]
  v_exp_f32 v80, v80
  v_mfma_f32_16x16x32_bf16 v[248:251], a[204:207], v[120:123], v[248:251]
  buffer_load_dwordx4 v25, s[12:15], s62 offen offset:1024 lds
  v_mfma_f32_16x16x32_bf16 v[232:235], a[200:203], v[120:123], v[232:235]
  v_exp_f32 v81, v81
  v_mfma_f32_16x16x32_bf16 v[236:239], a[200:203], v[124:127], v[236:239]
  v_cvt_pk_bf16_f32 v104, v80, v81
  v_mfma_f32_16x16x32_bf16 v[220:223], a[196:199], v[124:127], v[220:223]
  v_exp_f32 v82, v82
  v_mfma_f32_16x16x32_bf16 v[216:219], a[196:199], v[120:123], v[216:219]
  buffer_load_dwordx4 v26, s[16:19], s62 offen offset:2048 lds
  v_mfma_f32_16x16x32_bf16 v[200:203], a[192:195], v[120:123], v[200:203]
  v_exp_f32 v83, v83
  v_mfma_f32_16x16x32_bf16 v[204:207], a[192:195], v[124:127], v[204:207]
  v_cvt_pk_bf16_f32 v105, v82, v83
  v_mfma_f32_16x16x32_bf16 v[188:191], a[188:191], v[124:127], v[188:191]
  ds_read_b128 a[160:163], v12 offset:24576
  ds_read_b128 a[164:167], v13 offset:24576
  v_mfma_f32_16x16x32_bf16 v[184:187], a[188:191], v[120:123], v[184:187]
  v_exp_f32 v84, v84
  v_mfma_f32_16x16x32_bf16 v[168:171], a[184:187], v[120:123], v[168:171]
  buffer_load_dwordx4 v27, s[16:19], s62 offen offset:3072 lds
  v_mfma_f32_16x16x32_bf16 v[172:175], a[184:187], v[124:127], v[172:175]
  v_exp_f32 v85, v85
  v_mfma_f32_16x16x32_bf16 v[156:159], a[180:183], v[124:127], v[156:159]
  v_cvt_pk_bf16_f32 v106, v84, v85
  v_mfma_f32_16x16x32_bf16 v[152:155], a[180:183], v[120:123], v[152:155]
  v_exp_f32 v86, v86
  v_mfma_f32_16x16x32_bf16 v[136:139], a[176:179], v[120:123], v[136:139]
  ds_read_b128 a[168:171], v14 offset:24576
  ds_read_b128 a[172:175], v15 offset:24576
  v_mfma_f32_16x16x32_bf16 v[140:143], a[176:179], v[124:127], v[140:143]
  v_exp_f32 v87, v87
  v_mfma_f32_16x16x32_bf16 a[136:139], a[208:211], v[120:123], a[136:139]
  v_cvt_pk_bf16_f32 v107, v86, v87
  v_mfma_f32_16x16x32_bf16 a[140:143], a[208:211], v[124:127], a[140:143]
  s_add_u32 s62, s62, 8192
  s_waitcnt lgkmcnt(4)
  v_mfma_f32_16x16x32_bf16 v[64:67], a[144:147], a[0:3], v[48:51]
  v_exp_f32 v88, v88
  v_mfma_f32_16x16x32_bf16 v[64:67], a[148:151], a[16:19], v[64:67]
  ds_read_b64_tr_b16 a[176:177], v4 offset:16384
  ds_read_b64_tr_b16 a[178:179], v4 offset:24576
  v_mfma_f32_16x16x32_bf16 v[64:67], a[152:155], a[32:35], v[64:67]
  v_exp_f32 v89, v89
  v_mfma_f32_16x16x32_bf16 v[64:67], a[156:159], a[48:51], v[64:67]
  s_waitcnt lgkmcnt(2)
  ds_read_b64_tr_b16 a[180:181], v5 offset:16384
  ds_read_b64_tr_b16 a[182:183], v5 offset:24576
  v_mfma_f32_16x16x32_bf16 v[68:71], a[172:175], a[48:51], v[48:51]
  v_exp_f32 v90, v90
  v_mfma_f32_16x16x32_bf16 v[68:71], a[168:171], a[32:35], v[68:71]
  v_cvt_pk_bf16_f32 v108, v88, v89
  v_mfma_f32_16x16x32_bf16 v[68:71], a[164:167], a[16:19], v[68:71]
  v_exp_f32 v91, v91
  v_mfma_f32_16x16x32_bf16 v[68:71], a[160:163], a[0:3], v[68:71]
  v_cvt_pk_bf16_f32 v109, v90, v91
  v_mfma_f32_16x16x32_bf16 v[72:75], a[144:147], a[4:7], v[52:55]
  v_exp_f32 v92, v92
  v_mfma_f32_16x16x32_bf16 v[72:75], a[148:151], a[20:23], v[72:75]
  ds_read_b64_tr_b16 a[184:185], v6 offset:16384
  ds_read_b64_tr_b16 a[186:187], v6 offset:24576
  v_mfma_f32_16x16x32_bf16 v[72:75], a[152:155], a[36:39], v[72:75]
  v_exp_f32 v93, v93
  v_mfma_f32_16x16x32_bf16 v[72:75], a[156:159], a[52:55], v[72:75]
  ds_read_b64_tr_b16 a[188:189], v7 offset:16384
  ds_read_b64_tr_b16 a[190:191], v7 offset:24576
  v_mfma_f32_16x16x32_bf16 v[76:79], a[172:175], a[52:55], v[52:55]
  v_exp_f32 v94, v94
  v_mfma_f32_16x16x32_bf16 v[76:79], a[168:171], a[36:39], v[76:79]
  v_cvt_pk_bf16_f32 v110, v92, v93
  v_mfma_f32_16x16x32_bf16 v[76:79], a[164:167], a[20:23], v[76:79]
  v_exp_f32 v95, v95
  v_mfma_f32_16x16x32_bf16 v[76:79], a[160:163], a[4:7], v[76:79]
  v_cvt_pk_bf16_f32 v111, v94, v95
  v_mfma_f32_16x16x32_bf16 v[80:83], a[144:147], a[8:11], v[56:59]
  v_exp_f32 v64, v64
  v_mfma_f32_16x16x32_bf16 v[80:83], a[148:151], a[24:27], v[80:83]
  ds_read_b64_tr_b16 a[192:193], v8 offset:16384
  ds_read_b64_tr_b16 a[194:195], v8 offset:24576
  v_mfma_f32_16x16x32_bf16 v[80:83], a[152:155], a[40:43], v[80:83]
  v_exp_f32 v65, v65
  v_mfma_f32_16x16x32_bf16 v[80:83], a[156:159], a[56:59], v[80:83]
  ds_read_b64_tr_b16 a[196:197], v9 offset:16384
  ds_read_b64_tr_b16 a[198:199], v9 offset:24576
  v_mfma_f32_16x16x32_bf16 v[84:87], a[172:175], a[56:59], v[56:59]
  v_exp_f32 v66, v66
  v_mfma_f32_16x16x32_bf16 v[84:87], a[168:171], a[40:43], v[84:87]
  v_cvt_pk_bf16_f32 v112, v64, v65
  v_mfma_f32_16x16x32_bf16 v[84:87], a[164:167], a[24:27], v[84:87]
  v_exp_f32 v67, v67
  v_mfma_f32_16x16x32_bf16 v[84:87], a[160:163], a[8:11], v[84:87]
  v_cvt_pk_bf16_f32 v113, v66, v67
  v_mfma_f32_16x16x32_bf16 v[88:91], a[144:147], a[12:15], v[60:63]
  v_exp_f32 v68, v68
  v_mfma_f32_16x16x32_bf16 v[88:91], a[148:151], a[28:31], v[88:91]
  ds_read_b64_tr_b16 a[200:201], v10 offset:16384
  ds_read_b64_tr_b16 a[202:203], v10 offset:24576
  v_mfma_f32_16x16x32_bf16 v[88:91], a[152:155], a[44:47], v[88:91]
  v_exp_f32 v69, v69
  v_mfma_f32_16x16x32_bf16 v[88:91], a[156:159], a[60:63], v[88:91]
  ds_read_b64_tr_b16 a[204:205], v11 offset:16384
  ds_read_b64_tr_b16 a[206:207], v11 offset:24576
  v_mfma_f32_16x16x32_bf16 v[92:95], a[172:175], a[60:63], v[60:63]
  v_exp_f32 v70, v70
  v_mfma_f32_16x16x32_bf16 v[92:95], a[168:171], a[44:47], v[92:95]
  v_cvt_pk_bf16_f32 v114, v68, v69
  v_mfma_f32_16x16x32_bf16 v[92:95], a[164:167], a[28:31], v[92:95]
  v_exp_f32 v71, v71
  v_mfma_f32_16x16x32_bf16 v[92:95], a[160:163], a[12:15], v[92:95]
  v_cvt_pk_bf16_f32 v115, v70, v71
  s_waitcnt lgkmcnt(8)
  v_mfma_f32_16x16x32_bf16 v[128:131], a[176:179], v[96:99], v[128:131]
  v_exp_f32 v72, v72
  v_mfma_f32_16x16x32_bf16 v[132:135], a[176:179], v[100:103], v[132:135]
  v_mfma_f32_16x16x32_bf16 v[148:151], a[180:183], v[100:103], v[148:151]
  v_exp_f32 v73, v73
  v_mfma_f32_16x16x32_bf16 v[144:147], a[180:183], v[96:99], v[144:147]
  s_waitcnt lgkmcnt(0)
  v_cvt_pk_bf16_f32 v116, v72, v73
  v_mfma_f32_16x16x32_bf16 v[160:163], a[184:187], v[96:99], v[160:163]
  v_exp_f32 v74, v74
  v_mfma_f32_16x16x32_bf16 v[164:167], a[184:187], v[100:103], v[164:167]
  s_waitcnt vmcnt(8)
  s_barrier
  v_mfma_f32_16x16x32_bf16 v[180:183], a[188:191], v[100:103], v[180:183]
  v_exp_f32 v75, v75
  v_mfma_f32_16x16x32_bf16 v[176:179], a[188:191], v[96:99], v[176:179]
  v_cvt_pk_bf16_f32 v117, v74, v75
  v_mfma_f32_16x16x32_bf16 v[192:195], a[192:195], v[96:99], v[192:195]
  ds_read_b128 a[144:147], v12 offset:32768
  ds_read_b128 a[148:151], v13 offset:32768
  v_mfma_f32_16x16x32_bf16 v[196:199], a[192:195], v[100:103], v[196:199]
  v_exp_f32 v76, v76
  v_mfma_f32_16x16x32_bf16 v[212:215], a[196:199], v[100:103], v[212:215]
  s_add_u32 m0, s63, 49152
  v_mfma_f32_16x16x32_bf16 v[208:211], a[196:199], v[96:99], v[208:211]
  v_exp_f32 v77, v77
  v_mfma_f32_16x16x32_bf16 v[224:227], a[200:203], v[96:99], v[224:227]
  v_cvt_pk_bf16_f32 v118, v76, v77
  v_mfma_f32_16x16x32_bf16 v[228:231], a[200:203], v[100:103], v[228:231]
  v_exp_f32 v78, v78
  v_mfma_f32_16x16x32_bf16 v[244:247], a[204:207], v[100:103], v[244:247]
  buffer_load_dwordx4 v24, s[12:15], s62 offen offset:0 lds
  v_mfma_f32_16x16x32_bf16 v[240:243], a[204:207], v[96:99], v[240:243]
  v_exp_f32 v79, v79
  v_mfma_f32_16x16x32_bf16 a[128:131], a[208:211], v[96:99], a[128:131]
  v_cvt_pk_bf16_f32 v119, v78, v79
  v_mfma_f32_16x16x32_bf16 a[132:135], a[208:211], v[100:103], a[132:135]
  ds_read_b128 a[152:155], v14 offset:32768
  ds_read_b128 a[156:159], v15 offset:32768
  v_mfma_f32_16x16x32_bf16 v[252:255], a[204:207], v[108:111], v[252:255]
  v_exp_f32 v80, v80
  v_mfma_f32_16x16x32_bf16 v[248:251], a[204:207], v[104:107], v[248:251]
  buffer_load_dwordx4 v25, s[12:15], s62 offen offset:1024 lds
  v_mfma_f32_16x16x32_bf16 v[232:235], a[200:203], v[104:107], v[232:235]
  v_exp_f32 v81, v81
  v_mfma_f32_16x16x32_bf16 v[236:239], a[200:203], v[108:111], v[236:239]
  v_cvt_pk_bf16_f32 v120, v80, v81
  v_mfma_f32_16x16x32_bf16 v[220:223], a[196:199], v[108:111], v[220:223]
  v_exp_f32 v82, v82
  v_mfma_f32_16x16x32_bf16 v[216:219], a[196:199], v[104:107], v[216:219]
  buffer_load_dwordx4 v26, s[16:19], s62 offen offset:2048 lds
  v_mfma_f32_16x16x32_bf16 v[200:203], a[192:195], v[104:107], v[200:203]
  v_exp_f32 v83, v83
  v_mfma_f32_16x16x32_bf16 v[204:207], a[192:195], v[108:111], v[204:207]
  v_cvt_pk_bf16_f32 v121, v82, v83
  v_mfma_f32_16x16x32_bf16 v[188:191], a[188:191], v[108:111], v[188:191]
  ds_read_b128 a[160:163], v12 offset:40960
  ds_read_b128 a[164:167], v13 offset:40960
  v_mfma_f32_16x16x32_bf16 v[184:187], a[188:191], v[104:107], v[184:187]
  v_exp_f32 v84, v84
  v_mfma_f32_16x16x32_bf16 v[168:171], a[184:187], v[104:107], v[168:171]
  buffer_load_dwordx4 v27, s[16:19], s62 offen offset:3072 lds
  v_mfma_f32_16x16x32_bf16 v[172:175], a[184:187], v[108:111], v[172:175]
  v_exp_f32 v85, v85
  v_mfma_f32_16x16x32_bf16 v[156:159], a[180:183], v[108:111], v[156:159]
  v_cvt_pk_bf16_f32 v122, v84, v85
  v_mfma_f32_16x16x32_bf16 v[152:155], a[180:183], v[104:107], v[152:155]
  v_exp_f32 v86, v86
  v_mfma_f32_16x16x32_bf16 v[136:139], a[176:179], v[104:107], v[136:139]
  ds_read_b128 a[168:171], v14 offset:40960
  ds_read_b128 a[172:175], v15 offset:40960
  v_mfma_f32_16x16x32_bf16 v[140:143], a[176:179], v[108:111], v[140:143]
  v_exp_f32 v87, v87
  v_mfma_f32_16x16x32_bf16 a[136:139], a[208:211], v[104:107], a[136:139]
  v_cvt_pk_bf16_f32 v123, v86, v87
  v_mfma_f32_16x16x32_bf16 a[140:143], a[208:211], v[108:111], a[140:143]
  s_add_u32 s62, s62, 8192
  s_waitcnt lgkmcnt(4)
  v_mfma_f32_16x16x32_bf16 v[64:67], a[144:147], a[0:3], v[48:51]
  v_exp_f32 v88, v88
  v_mfma_f32_16x16x32_bf16 v[64:67], a[148:151], a[16:19], v[64:67]
  ds_read_b64_tr_b16 a[176:177], v4 offset:32768
  ds_read_b64_tr_b16 a[178:179], v4 offset:40960
  v_mfma_f32_16x16x32_bf16 v[64:67], a[152:155], a[32:35], v[64:67]
  v_exp_f32 v89, v89
  v_mfma_f32_16x16x32_bf16 v[64:67], a[156:159], a[48:51], v[64:67]
  s_waitcnt lgkmcnt(2)
  ds_read_b64_tr_b16 a[180:181], v5 offset:32768
  ds_read_b64_tr_b16 a[182:183], v5 offset:40960
  v_mfma_f32_16x16x32_bf16 v[68:71], a[172:175], a[48:51], v[48:51]
  v_exp_f32 v90, v90
  v_mfma_f32_16x16x32_bf16 v[68:71], a[168:171], a[32:35], v[68:71]
  v_cvt_pk_bf16_f32 v124, v88, v89
  v_mfma_f32_16x16x32_bf16 v[68:71], a[164:167], a[16:19], v[68:71]
  v_exp_f32 v91, v91
  v_mfma_f32_16x16x32_bf16 v[68:71], a[160:163], a[0:3], v[68:71]
  v_cvt_pk_bf16_f32 v125, v90, v91
  v_mfma_f32_16x16x32_bf16 v[72:75], a[144:147], a[4:7], v[52:55]
  v_exp_f32 v92, v92
  v_mfma_f32_16x16x32_bf16 v[72:75], a[148:151], a[20:23], v[72:75]
  ds_read_b64_tr_b16 a[184:185], v6 offset:32768
  ds_read_b64_tr_b16 a[186:187], v6 offset:40960
  v_mfma_f32_16x16x32_bf16 v[72:75], a[152:155], a[36:39], v[72:75]
  v_exp_f32 v93, v93
  v_mfma_f32_16x16x32_bf16 v[72:75], a[156:159], a[52:55], v[72:75]
  ds_read_b64_tr_b16 a[188:189], v7 offset:32768
  ds_read_b64_tr_b16 a[190:191], v7 offset:40960
  v_mfma_f32_16x16x32_bf16 v[76:79], a[172:175], a[52:55], v[52:55]
  v_exp_f32 v94, v94
  v_mfma_f32_16x16x32_bf16 v[76:79], a[168:171], a[36:39], v[76:79]
  v_cvt_pk_bf16_f32 v126, v92, v93
  v_mfma_f32_16x16x32_bf16 v[76:79], a[164:167], a[20:23], v[76:79]
  v_exp_f32 v95, v95
  v_mfma_f32_16x16x32_bf16 v[76:79], a[160:163], a[4:7], v[76:79]
  v_cvt_pk_bf16_f32 v127, v94, v95
  v_mfma_f32_16x16x32_bf16 v[80:83], a[144:147], a[8:11], v[56:59]
  v_exp_f32 v64, v64
  v_mfma_f32_16x16x32_bf16 v[80:83], a[148:151], a[24:27], v[80:83]
  ds_read_b64_tr_b16 a[192:193], v8 offset:32768
  ds_read_b64_tr_b16 a[194:195], v8 offset:40960
  v_mfma_f32_16x16x32_bf16 v[80:83], a[152:155], a[40:43], v[80:83]
  v_exp_f32 v65, v65
  v_mfma_f32_16x16x32_bf16 v[80:83], a[156:159], a[56:59], v[80:83]
  ds_read_b64_tr_b16 a[196:197], v9 offset:32768
  ds_read_b64_tr_b16 a[198:199], v9 offset:40960
  v_mfma_f32_16x16x32_bf16 v[84:87], a[172:175], a[56:59], v[56:59]
  v_exp_f32 v66, v66
  v_mfma_f32_16x16x32_bf16 v[84:87], a[168:171], a[40:43], v[84:87]
  v_cvt_pk_bf16_f32 v96, v64, v65
  v_mfma_f32_16x16x32_bf16 v[84:87], a[164:167], a[24:27], v[84:87]
  v_exp_f32 v67, v67
  v_mfma_f32_16x16x32_bf16 v[84:87], a[160:163], a[8:11], v[84:87]
  v_cvt_pk_bf16_f32 v97, v66, v67
  v_mfma_f32_16x16x32_bf16 v[88:91], a[144:147], a[12:15], v[60:63]
  v_exp_f32 v68, v68
  v_mfma_f32_16x16x32_bf16 v[88:91], a[148:151], a[28:31], v[88:91]
  ds_read_b64_tr_b16 a[200:201], v10 offset:32768
  ds_read_b64_tr_b16 a[202:203], v10 offset:40960
  v_mfma_f32_16x16x32_bf16 v[88:91], a[152:155], a[44:47], v[88:91]
  v_exp_f32 v69, v69
  v_mfma_f32_16x16x32_bf16 v[88:91], a[156:159], a[60:63], v[88:91]
  ds_read_b64_tr_b16 a[204:205], v11 offset:32768
  ds_read_b64_tr_b16 a[206:207], v11 offset:40960
  v_mfma_f32_16x16x32_bf16 v[92:95], a[172:175], a[60:63], v[60:63]
  v_exp_f32 v70, v70
  v_mfma_f32_16x16x32_bf16 v[92:95], a[168:171], a[44:47], v[92:95]
  v_cvt_pk_bf16_f32 v98, v68, v69
  v_mfma_f32_16x16x32_bf16 v[92:95], a[164:167], a[28:31], v[92:95]
  v_exp_f32 v71, v71
  v_mfma_f32_16x16x32_bf16 v[92:95], a[160:163], a[12:15], v[92:95]
  v_cvt_pk_bf16_f32 v99, v70, v71
  s_waitcnt lgkmcnt(8)
  v_mfma_f32_16x16x32_bf16 v[128:131], a[176:179], v[112:115], v[128:131]
  v_exp_f32 v72, v72
  v_mfma_f32_16x16x32_bf16 v[132:135], a[176:179], v[116:119], v[132:135]
  v_mfma_f32_16x16x32_bf16 v[148:151], a[180:183], v[116:119], v[148:151]
  v_exp_f32 v73, v73
  v_mfma_f32_16x16x32_bf16 v[144:147], a[180:183], v[112:115], v[144:147]
  s_waitcnt lgkmcnt(0)
  v_cvt_pk_bf16_f32 v100, v72, v73
  v_mfma_f32_16x16x32_bf16 v[160:163], a[184:187], v[112:115], v[160:163]
  v_exp_f32 v74, v74
  v_mfma_f32_16x16x32_bf16 v[164:167], a[184:187], v[116:119], v[164:167]
  s_waitcnt vmcnt(8)
  s_barrier
  v_mfma_f32_16x16x32_bf16 v[180:183], a[188:191], v[116:119], v[180:183]
  v_exp_f32 v75, v75
  v_mfma_f32_16x16x32_bf16 v[176:179], a[188:191], v[112:115], v[176:179]
  v_cvt_pk_bf16_f32 v101, v74, v75
  v_mfma_f32_16x16x32_bf16 v[192:195], a[192:195], v[112:115], v[192:195]
  ds_read_b128 a[144:147], v12 offset:49152
  ds_read_b128 a[148:151], v13 offset:49152
  v_mfma_f32_16x16x32_bf16 v[196:199], a[192:195], v[116:119], v[196:199]
  v_exp_f32 v76, v76
  v_mfma_f32_16x16x32_bf16 v[212:215], a[196:199], v[116:119], v[212:215]
  s_add_u32 m0, s63, 65536
  v_mfma_f32_16x16x32_bf16 v[208:211], a[196:199], v[112:115], v[208:211]
  v_exp_f32 v77, v77
  v_mfma_f32_16x16x32_bf16 v[224:227], a[200:203], v[112:115], v[224:227]
  v_cvt_pk_bf16_f32 v102, v76, v77
  v_mfma_f32_16x16x32_bf16 v[228:231], a[200:203], v[116:119], v[228:231]
  v_exp_f32 v78, v78
  v_mfma_f32_16x16x32_bf16 v[244:247], a[204:207], v[116:119], v[244:247]
  buffer_load_dwordx4 v24, s[12:15], s62 offen offset:0 lds
  v_mfma_f32_16x16x32_bf16 v[240:243], a[204:207], v[112:115], v[240:243]
  v_exp_f32 v79, v79
  v_mfma_f32_16x16x32_bf16 a[128:131], a[208:211], v[112:115], a[128:131]
  v_cvt_pk_bf16_f32 v103, v78, v79
  v_mfma_f32_16x16x32_bf16 a[132:135], a[208:211], v[116:119], a[132:135]
  ds_read_b128 a[152:155], v14 offset:49152
  ds_read_b128 a[156:159], v15 offset:49152
  v_mfma_f32_16x16x32_bf16 v[252:255], a[204:207], v[124:127], v[252:255]
  v_exp_f32 v80, v80
  v_mfma_f32_16x16x32_bf16 v[248:251], a[204:207], v[120:123], v[248:251]
  buffer_load_dwordx4 v25, s[12:15], s62 offen offset:1024 lds
  v_mfma_f32_16x16x32_bf16 v[232:235], a[200:203], v[120:123], v[232:235]
  v_exp_f32 v81, v81
  v_mfma_f32_16x16x32_bf16 v[236:239], a[200:203], v[124:127], v[236:239]
  v_cvt_pk_bf16_f32 v104, v80, v81
  v_mfma_f32_16x16x32_bf16 v[220:223], a[196:199], v[124:127], v[220:223]
  v_exp_f32 v82, v82
  v_mfma_f32_16x16x32_bf16 v[216:219], a[196:199], v[120:123], v[216:219]
  buffer_load_dwordx4 v26, s[16:19], s62 offen offset:2048 lds
  v_mfma_f32_16x16x32_bf16 v[200:203], a[192:195], v[120:123], v[200:203]
  v_exp_f32 v83, v83
  v_mfma_f32_16x16x32_bf16 v[204:207], a[192:195], v[124:127], v[204:207]
  v_cvt_pk_bf16_f32 v105, v82, v83
  v_mfma_f32_16x16x32_bf16 v[188:191], a[188:191], v[124:127], v[188:191]
  ds_read_b128 a[160:163], v12 offset:57344
  ds_read_b128 a[164:167], v13 offset:57344
  v_mfma_f32_16x16x32_bf16 v[184:187], a[188:191], v[120:123], v[184:187]
  v_exp_f32 v84, v84
  v_mfma_f32_16x16x32_bf16 v[168:171], a[184:187], v[120:123], v[168:171]
  buffer_load_dwordx4 v27, s[16:19], s62 offen offset:3072 lds
  v_mfma_f32_16x16x32_bf16 v[172:175], a[184:187], v[124:127], v[172:175]
  v_exp_f32 v85, v85
  v_mfma_f32_16x16x32_bf16 v[156:159], a[180:183], v[124:127], v[156:159]
  v_cvt_pk_bf16_f32 v106, v84, v85
  v_mfma_f32_16x16x32_bf16 v[152:155], a[180:183], v[120:123], v[152:155]
  v_exp_f32 v86, v86
  v_mfma_f32_16x16x32_bf16 v[136:139], a[176:179], v[120:123], v[136:139]
  ds_read_b128 a[168:171], v14 offset:57344
  ds_read_b128 a[172:175], v15 offset:57344
  v_mfma_f32_16x16x32_bf16 v[140:143], a[176:179], v[124:127], v[140:143]
  v_exp_f32 v87, v87
  v_mfma_f32_16x16x32_bf16 a[136:139], a[208:211], v[120:123], a[136:139]
  v_cvt_pk_bf16_f32 v107, v86, v87
  v_mfma_f32_16x16x32_bf16 a[140:143], a[208:211], v[124:127], a[140:143]
  s_add_u32 s62, s62, 8192
  s_waitcnt lgkmcnt(4)
  v_mfma_f32_16x16x32_bf16 v[64:67], a[144:147], a[0:3], v[48:51]
  v_exp_f32 v88, v88
  v_mfma_f32_16x16x32_bf16 v[64:67], a[148:151], a[16:19], v[64:67]
  ds_read_b64_tr_b16 a[176:177], v4 offset:49152
  ds_read_b64_tr_b16 a[178:179], v4 offset:57344
  v_mfma_f32_16x16x32_bf16 v[64:67], a[152:155], a[32:35], v[64:67]
  v_exp_f32 v89, v89
  v_mfma_f32_16x16x32_bf16 v[64:67], a[156:159], a[48:51], v[64:67]
  s_waitcnt lgkmcnt(2)
  ds_read_b64_tr_b16 a[180:181], v5 offset:49152
  ds_read_b64_tr_b16 a[182:183], v5 offset:57344
  v_mfma_f32_16x16x32_bf16 v[68:71], a[172:175], a[48:51], v[48:51]
  v_exp_f32 v90, v90
  v_mfma_f32_16x16x32_bf16 v[68:71], a[168:171], a[32:35], v[68:71]
  v_cvt_pk_bf16_f32 v108, v88, v89
  v_mfma_f32_16x16x32_bf16 v[68:71], a[164:167], a[16:19], v[68:71]
  v_exp_f32 v91, v91
  v_mfma_f32_16x16x32_bf16 v[68:71], a[160:163], a[0:3], v[68:71]
  v_cvt_pk_bf16_f32 v109, v90, v91
  v_mfma_f32_16x16x32_bf16 v[72:75], a[144:147], a[4:7], v[52:55]
  v_exp_f32 v92, v92
  v_mfma_f32_16x16x32_bf16 v[72:75], a[148:151], a[20:23], v[72:75]
  ds_read_b64_tr_b16 a[184:185], v6 offset:49152
  ds_read_b64_tr_b16 a[186:187], v6 offset:57344
  v_mfma_f32_16x16x32_bf16 v[72:75], a[152:155], a[36:39], v[72:75]
  v_exp_f32 v93, v93
  v_mfma_f32_16x16x32_bf16 v[72:75], a[156:159], a[52:55], v[72:75]
  ds_read_b64_tr_b16 a[188:189], v7 offset:49152
  ds_read_b64_tr_b16 a[190:191], v7 offset:57344
  v_mfma_f32_16x16x32_bf16 v[76:79], a[172:175], a[52:55], v[52:55]
  v_exp_f32 v94, v94
  v_mfma_f32_16x16x32_bf16 v[76:79], a[168:171], a[36:39], v[76:79]
  v_cvt_pk_bf16_f32 v110, v92, v93
  v_mfma_f32_16x16x32_bf16 v[76:79], a[164:167], a[20:23], v[76:79]
  v_exp_f32 v95, v95
  v_mfma_f32_16x16x32_bf16 v[76:79], a[160:163], a[4:7], v[76:79]
  v_cvt_pk_bf16_f32 v111, v94, v95
  v_mfma_f32_16x16x32_bf16 v[80:83], a[144:147], a[8:11], v[56:59]
  v_exp_f32 v64, v64
  v_mfma_f32_16x16x32_bf16 v[80:83], a[148:151], a[24:27], v[80:83]
  ds_read_b64_tr_b16 a[192:193], v8 offset:49152
  ds_read_b64_tr_b16 a[194:195], v8 offset:57344
  v_mfma_f32_16x16x32_bf16 v[80:83], a[152:155], a[40:43], v[80:83]
  v_exp_f32 v65, v65
  v_mfma_f32_16x16x32_bf16 v[80:83], a[156:159], a[56:59], v[80:83]
  ds_read_b64_tr_b16 a[196:197], v9 offset:49152
  ds_read_b64_tr_b16 a[198:199], v9 offset:57344
  v_mfma_f32_16x16x32_bf16 v[84:87], a[172:175], a[56:59], v[56:59]
  v_exp_f32 v66, v66
  v_mfma_f32_16x16x32_bf16 v[84:87], a[168:171], a[40:43], v[84:87]
  v_cvt_pk_bf16_f32 v112, v64, v65
  v_mfma_f32_16x16x32_bf16 v[84:87], a[164:167], a[24:27], v[84:87]
  v_exp_f32 v67, v67
  v_mfma_f32_16x16x32_bf16 v[84:87], a[160:163], a[8:11], v[84:87]
  v_cvt_pk_bf16_f32 v113, v66, v67
  v_mfma_f32_16x16x32_bf16 v[88:91], a[144:147], a[12:15], v[60:63]
  v_exp_f32 v68, v68
  v_mfma_f32_16x16x32_bf16 v[88:91], a[148:151], a[28:31], v[88:91]
  ds_read_b64_tr_b16 a[200:201], v10 offset:49152
  ds_read_b64_tr_b16 a[202:203], v10 offset:57344
  v_mfma_f32_16x16x32_bf16 v[88:91], a[152:155], a[44:47], v[88:91]
  v_exp_f32 v69, v69
  v_mfma_f32_16x16x32_bf16 v[88:91], a[156:159], a[60:63], v[88:91]
  ds_read_b64_tr_b16 a[204:205], v11 offset:49152
  ds_read_b64_tr_b16 a[206:207], v11 offset:57344
  v_mfma_f32_16x16x32_bf16 v[92:95], a[172:175], a[60:63], v[60:63]
  v_exp_f32 v70, v70
  v_mfma_f32_16x16x32_bf16 v[92:95], a[168:171], a[44:47], v[92:95]
  v_cvt_pk_bf16_f32 v114, v68, v69
  v_mfma_f32_16x16x32_bf16 v[92:95], a[164:167], a[28:31], v[92:95]
  v_exp_f32 v71, v71
  v_mfma_f32_16x16x32_bf16 v[92:95], a[160:163], a[12:15], v[92:95]
  v_cvt_pk_bf16_f32 v115, v70, v71
  s_waitcnt lgkmcnt(8)
  v_mfma_f32_16x16x32_bf16 v[128:131], a[176:179], v[96:99], v[128:131]
  v_exp_f32 v72, v72
  v_mfma_f32_16x16x32_bf16 v[132:135], a[176:179], v[100:103], v[132:135]
  v_mfma_f32_16x16x32_bf16 v[148:151], a[180:183], v[100:103], v[148:151]
  v_exp_f32 v73, v73
  v_mfma_f32_16x16x32_bf16 v[144:147], a[180:183], v[96:99], v[144:147]
  s_waitcnt lgkmcnt(0)
  v_cvt_pk_bf16_f32 v116, v72, v73
  v_mfma_f32_16x16x32_bf16 v[160:163], a[184:187], v[96:99], v[160:163]
  v_exp_f32 v74, v74
  v_mfma_f32_16x16x32_bf16 v[164:167], a[184:187], v[100:103], v[164:167]
  s_waitcnt vmcnt(8)
  s_barrier
  v_mfma_f32_16x16x32_bf16 v[180:183], a[188:191], v[100:103], v[180:183]
  v_exp_f32 v75, v75
  v_mfma_f32_16x16x32_bf16 v[176:179], a[188:191], v[96:99], v[176:179]
  v_cvt_pk_bf16_f32 v117, v74, v75
  v_mfma_f32_16x16x32_bf16 v[192:195], a[192:195], v[96:99], v[192:195]
  ds_read_b128 a[144:147], v12 offset:0
  ds_read_b128 a[148:151], v13 offset:0
  v_mfma_f32_16x16x32_bf16 v[196:199], a[192:195], v[100:103], v[196:199]
  v_exp_f32 v76, v76
  v_mfma_f32_16x16x32_bf16 v[212:215], a[196:199], v[100:103], v[212:215]
  s_add_u32 m0, s63, 81920
  v_mfma_f32_16x16x32_bf16 v[208:211], a[196:199], v[96:99], v[208:211]
  v_exp_f32 v77, v77
  v_mfma_f32_16x16x32_bf16 v[224:227], a[200:203], v[96:99], v[224:227]
  v_cvt_pk_bf16_f32 v118, v76, v77
  v_mfma_f32_16x16x32_bf16 v[228:231], a[200:203], v[100:103], v[228:231]
  v_exp_f32 v78, v78
  v_mfma_f32_16x16x32_bf16 v[244:247], a[204:207], v[100:103], v[244:247]
  buffer_load_dwordx4 v24, s[12:15], s62 offen offset:0 lds
  v_mfma_f32_16x16x32_bf16 v[240:243], a[204:207], v[96:99], v[240:243]
  v_exp_f32 v79, v79
  v_mfma_f32_16x16x32_bf16 a[128:131], a[208:211], v[96:99], a[128:131]
  v_cvt_pk_bf16_f32 v119, v78, v79
  v_mfma_f32_16x16x32_bf16 a[132:135], a[208:211], v[100:103], a[132:135]
  ds_read_b128 a[152:155], v14 offset:0
  ds_read_b128 a[156:159], v15 offset:0
  v_mfma_f32_16x16x32_bf16 v[252:255], a[204:207], v[108:111], v[252:255]
  v_exp_f32 v80, v80
  v_mfma_f32_16x16x32_bf16 v[248:251], a[204:207], v[104:107], v[248:251]
  buffer_load_dwordx4 v25, s[12:15], s62 offen offset:1024 lds
  v_mfma_f32_16x16x32_bf16 v[232:235], a[200:203], v[104:107], v[232:235]
  v_exp_f32 v81, v81
  v_mfma_f32_16x16x32_bf16 v[236:239], a[200:203], v[108:111], v[236:239]
  v_cvt_pk_bf16_f32 v120, v80, v81
  v_mfma_f32_16x16x32_bf16 v[220:223], a[196:199], v[108:111], v[220:223]
  v_exp_f32 v82, v82
  v_mfma_f32_16x16x32_bf16 v[216:219], a[196:199], v[104:107], v[216:219]
  buffer_load_dwordx4 v26, s[16:19], s62 offen offset:2048 lds
  v_mfma_f32_16x16x32_bf16 v[200:203], a[192:195], v[104:107], v[200:203]
  v_exp_f32 v83, v83
  v_mfma_f32_16x16x32_bf16 v[204:207], a[192:195], v[108:111], v[204:207]
  v_cvt_pk_bf16_f32 v121, v82, v83
  v_mfma_f32_16x16x32_bf16 v[188:191], a[188:191], v[108:111], v[188:191]
  ds_read_b128 a[160:163], v12 offset:8192
  ds_read_b128 a[164:167], v13 offset:8192
  v_mfma_f32_16x16x32_bf16 v[184:187], a[188:191], v[104:107], v[184:187]
  v_exp_f32 v84, v84
  v_mfma_f32_16x16x32_bf16 v[168:171], a[184:187], v[104:107], v[168:171]
  buffer_load_dwordx4 v27, s[16:19], s62 offen offset:3072 lds
  v_mfma_f32_16x16x32_bf16 v[172:175], a[184:187], v[108:111], v[172:175]
  v_exp_f32 v85, v85
  v_mfma_f32_16x16x32_bf16 v[156:159], a[180:183], v[108:111], v[156:159]
  v_cvt_pk_bf16_f32 v122, v84, v85
  v_mfma_f32_16x16x32_bf16 v[152:155], a[180:183], v[104:107], v[152:155]
  v_exp_f32 v86, v86
  v_mfma_f32_16x16x32_bf16 v[136:139], a[176:179], v[104:107], v[136:139]
  ds_read_b128 a[168:171], v14 offset:8192
  ds_read_b128 a[172:175], v15 offset:8192
  v_mfma_f32_16x16x32_bf16 v[140:143], a[176:179], v[108:111], v[140:143]
  v_exp_f32 v87, v87
  v_mfma_f32_16x16x32_bf16 a[136:139], a[208:211], v[104:107], a[136:139]
  v_cvt_pk_bf16_f32 v123, v86, v87
  v_mfma_f32_16x16x32_bf16 a[140:143], a[208:211], v[108:111], a[140:143]
  s_add_u32 s62, s62, 8192
  s_sub_u32 s101, s101, 1
  s_cmp_lg_u32 s101, 0
  s_cbranch_scc1 L_attn_loop
  s_waitcnt lgkmcnt(4)
  v_mfma_f32_16x16x32_bf16 v[64:67], a[144:147], a[0:3], v[48:51]
  v_exp_f32 v88, v88
  v_mfma_f32_16x16x32_bf16 v[64:67], a[148:151], a[16:19], v[64:67]
  ds_read_b64_tr_b16 a[176:177], v4 offset:0
  ds_read_b64_tr_b16 a[178:179], v4 offset:8192
  v_mfma_f32_16x16x32_bf16 v[64:67], a[152:155], a[32:35], v[64:67]
  v_exp_f32 v89, v89
  v_mfma_f32_16x16x32_bf16 v[64:67], a[156:159], a[48:51], v[64:67]
  s_waitcnt lgkmcnt(2)
  ds_read_b64_tr_b16 a[180:181], v5 offset:0
  ds_read_b64_tr_b16 a[182:183], v5 offset:8192
  v_mfma_f32_16x16x32_bf16 v[68:71], a[172:175], a[48:51], v[48:51]
  v_exp_f32 v90, v90
  v_mfma_f32_16x16x32_bf16 v[68:71], a[168:171], a[32:35], v[68:71]
  v_cvt_pk_bf16_f32 v124, v88, v89
  v_mfma_f32_16x16x32_bf16 v[68:71], a[164:167], a[16:19], v[68:71]
  v_exp_f32 v91, v91
  v_mfma_f32_16x16x32_bf16 v[68:71], a[160:163], a[0:3], v[68:71]
  v_cvt_pk_bf16_f32 v125, v90, v91
  v_mfma_f32_16x16x32_bf16 v[72:75], a[144:147], a[4:7], v[52:55]
  v_exp_f32 v92, v92
  v_mfma_f32_16x16x32_bf16 v[72:75], a[148:151], a[20:23], v[72:75]
  ds_read_b64_tr_b16 a[184:185], v6 offset:0
  ds_read_b64_tr_b16 a[186:187], v6 offset:8192
  v_mfma_f32_16x16x32_bf16 v[72:75], a[152:155], a[36:39], v[72:75]
  v_exp_f32 v93, v93
  v_mfma_f32_16x16x32_bf16 v[72:75], a[156:159], a[52:55], v[72:75]
  ds_read_b64_tr_b16 a[188:189], v7 offset:0
  ds_read_b64_tr_b16 a[190:191], v7 offset:8192
  v_mfma_f32_16x16x32_bf16 v[76:79], a[172:175], a[52:55], v[52:55]
  v_exp_f32 v94, v94
  v_mfma_f32_16x16x32_bf16 v[76:79], a[168:171], a[36:39], v[76:79]
  v_cvt_pk_bf16_f32 v126, v92, v93
  v_mfma_f32_16x16x32_bf16 v[76:79], a[164:167], a[20:23], v[76:79]
  v_exp_f32 v95, v95
  v_mfma_f32_16x16x32_bf16 v[76:79], a[160:163], a[4:7], v[76:79]
  v_cvt_pk_bf16_f32 v127, v94, v95
  v_mfma_f32_16x16x32_bf16 v[80:83], a[144:147], a[8:11], v[56:59]
  v_exp_f32 v64, v64
  v_mfma_f32_16x16x32_bf16 v[80:83], a[148:151], a[24:27], v[80:83]
  ds_read_b64_tr_b16 a[192:193], v8 offset:0
  ds_read_b64_tr_b16 a[194:195], v8 offset:8192
  v_mfma_f32_16x16x32_bf16 v[80:83], a[152:155], a[40:43], v[80:83]
  v_exp_f32 v65, v65
  v_mfma_f32_16x16x32_bf16 v[80:83], a[156:159], a[56:59], v[80:83]
  ds_read_b64_tr_b16 a[196:197], v9 offset:0
  ds_read_b64_tr_b16 a[198:199], v9 offset:8192
  v_mfma_f32_16x16x32_bf16 v[84:87], a[172:175], a[56:59], v[56:59]
  v_exp_f32 v66, v66
  v_mfma_f32_16x16x32_bf16 v[84:87], a[168:171], a[40:43], v[84:87]
  v_cvt_pk_bf16_f32 v96, v64, v65
  v_mfma_f32_16x16x32_bf16 v[84:87], a[164:167], a[24:27], v[84:87]
  v_exp_f32 v67, v67
  v_mfma_f32_16x16x32_bf16 v[84:87], a[160:163], a[8:11], v[84:87]
  v_cvt_pk_bf16_f32 v97, v66, v67
  v_mfma_f32_16x16x32_bf16 v[88:91], a[144:147], a[12:15], v[60:63]
  v_exp_f32 v68, v68
  v_mfma_f32_16x16x32_bf16 v[88:91], a[148:151], a[28:31], v[88:91]
  ds_read_b64_tr_b16 a[200:201], v10 offset:0
  ds_read_b64_tr_b16 a[202:203], v10 offset:8192
  v_mfma_f32_16x16x32_bf16 v[88:91], a[152:155], a[44:47], v[88:91]
  v_exp_f32 v69, v69
  v_mfma_f32_16x16x32_bf16 v[88:91], a[156:159], a[60:63], v[88:91]
  ds_read_b64_tr_b16 a[204:205], v11 offset:0
  ds_read_b64_tr_b16 a[206:207], v11 offset:8192
  v_mfma_f32_16x16x32_bf16 v[92:95], a[172:175], a[60:63], v[60:63]
  v_exp_f32 v70, v70
  v_mfma_f32_16x16x32_bf16 v[92:95], a[168:171], a[44:47], v[92:95]
  v_cvt_pk_bf16_f32 v98, v68, v69
  v_mfma_f32_16x16x32_bf16 v[92:95], a[164:167], a[28:31], v[92:95]
  v_exp_f32 v71, v71
  v_mfma_f32_16x16x32_bf16 v[92:95], a[160:163], a[12:15], v[92:95]
  v_cvt_pk_bf16_f32 v99, v70, v71
  s_waitcnt lgkmcnt(8)
  v_mfma_f32_16x16x32_bf16 v[128:131], a[176:179], v[112:115], v[128:131]
  v_exp_f32 v72, v72
  v_mfma_f32_16x16x32_bf16 v[132:135], a[176:179], v[116:119], v[132:135]
  v_mfma_f32_16x16x32_bf16 v[148:151], a[180:183], v[116:119], v[148:151]
  v_exp_f32 v73, v73
  v_mfma_f32_16x16x32_bf16 v[144:147], a[180:183], v[112:115], v[144:147]
  s_waitcnt lgkmcnt(0)
  v_cvt_pk_bf16_f32 v100, v72, v73
  v_mfma_f32_16x16x32_bf16 v[160:163], a[184:187], v[112:115], v[160:163]
  v_exp_f32 v74, v74
  v_mfma_f32_16x16x32_bf16 v[164:167], a[184:187], v[116:119], v[164:167]
  s_waitcnt vmcnt(8)
  s_barrier
  v_mfma_f32_16x16x32_bf16 v[180:183], a[188:191], v[116:119], v[180:183]
  v_exp_f32 v75, v75
  v_mul_u32_u24 v31, 3584, v1
  s_lshl_b32 s56, s70, 3
  v_mfma_f32_16x16x32_bf16 v[176:179], a[188:191], v[112:115], v[176:179]
  v_cvt_pk_bf16_f32 v101, v74, v75
  v_mfma_f32_16x16x32_bf16 v[192:195], a[192:195], v[112:115], v[192:195]
  ds_read_b128 a[144:147], v12 offset:16384
  ds_read_b128 a[148:151], v13 offset:16384
  v_mfma_f32_16x16x32_bf16 v[196:199], a[192:195], v[116:119], v[196:199]
  v_exp_f32 v76, v76
  v_mfma_f32_16x16x32_bf16 v[212:215], a[196:199], v[116:119], v[212:215]
  s_add_u32 m0, s63, 32768
  v_mfma_f32_16x16x32_bf16 v[208:211], a[196:199], v[112:115], v[208:211]
  v_exp_f32 v77, v77
  v_mfma_f32_16x16x32_bf16 v[224:227], a[200:203], v[112:115], v[224:227]
  v_cvt_pk_bf16_f32 v102, v76, v77
  v_mov_b32 v46, s56
  v_mfma_f32_16x16x32_bf16 v[228:231], a[200:203], v[116:119], v[228:231]
  v_exp_f32 v78, v78
  v_mfma_f32_16x16x32_bf16 v[244:247], a[204:207], v[116:119], v[244:247]
  buffer_load_dwordx4 v24, s[12:15], s62 offen offset:0 lds
  v_mfma_f32_16x16x32_bf16 v[240:243], a[204:207], v[112:115], v[240:243]
  v_exp_f32 v79, v79
  v_mfma_f32_16x16x32_bf16 a[128:131], a[208:211], v[112:115], a[128:131]
  v_cvt_pk_bf16_f32 v103, v78, v79
  v_mfma_f32_16x16x32_bf16 a[132:135], a[208:211], v[116:119], a[132:135]
  ds_read_b128 a[152:155], v14 offset:16384
  ds_read_b128 a[156:159], v15 offset:16384
  s_mul_i32 s99, s97, 229376
  v_mfma_f32_16x16x32_bf16 v[252:255], a[204:207], v[124:127], v[252:255]
  v_exp_f32 v80, v80
  s_lshl_b32 s56, s94, 3
  v_mfma_f32_16x16x32_bf16 v[248:251], a[204:207], v[120:123], v[248:251]
  buffer_load_dwordx4 v25, s[12:15], s62 offen offset:1024 lds
  v_mfma_f32_16x16x32_bf16 v[232:235], a[200:203], v[120:123], v[232:235]
  v_exp_f32 v81, v81
  v_mfma_f32_16x16x32_bf16 v[236:239], a[200:203], v[124:127], v[236:239]
  v_cvt_pk_bf16_f32 v104, v80, v81
  v_mfma_f32_16x16x32_bf16 v[220:223], a[196:199], v[124:127], v[220:223]
  v_exp_f32 v82, v82
  v_mfma_f32_16x16x32_bf16 v[216:219], a[196:199], v[120:123], v[216:219]
  buffer_load_dwordx4 v26, s[16:19], s62 offen offset:2048 lds
  v_mfma_f32_16x16x32_bf16 v[200:203], a[192:195], v[120:123], v[200:203]
  v_exp_f32 v83, v83
  v_writelane_b32 v46, s56, 0
  v_mfma_f32_16x16x32_bf16 v[204:207], a[192:195], v[124:127], v[204:207]
  v_cvt_pk_bf16_f32 v105, v82, v83
  v_mfma_f32_16x16x32_bf16 v[188:191], a[188:191], v[124:127], v[188:191]
  ds_read_b128 a[160:163], v12 offset:24576
  ds_read_b128 a[164:167], v13 offset:24576
  v_mfma_f32_16x16x32_bf16 v[184:187], a[188:191], v[120:123], v[184:187]
  v_exp_f32 v84, v84
  v_mfma_f32_16x16x32_bf16 v[168:171], a[184:187], v[120:123], v[168:171]
  buffer_load_dwordx4 v27, s[16:19], s62 offen offset:3072 lds
  v_mfma_f32_16x16x32_bf16 v[172:175], a[184:187], v[124:127], v[172:175]
  v_exp_f32 v85, v85
  v_mfma_f32_16x16x32_bf16 v[156:159], a[180:183], v[124:127], v[156:159]
  v_cvt_pk_bf16_f32 v106, v84, v85
  buffer_load_dword a255, v31, s[36:39], s99 offen
  buffer_load_dword v47, v46, s[48:51], 0 offen sc1
  v_mfma_f32_16x16x32_bf16 v[152:155], a[180:183], v[120:123], v[152:155]
  v_exp_f32 v86, v86
  v_mfma_f32_16x16x32_bf16 v[136:139], a[176:179], v[120:123], v[136:139]
  ds_read_b128 a[168:171], v14 offset:24576
  ds_read_b128 a[172:175], v15 offset:24576
  v_mfma_f32_16x16x32_bf16 v[140:143], a[176:179], v[124:127], v[140:143]
  v_exp_f32 v87, v87
  s_add_u32 s99, s99, 229376
  v_mfma_f32_16x16x32_bf16 a[136:139], a[208:211], v[120:123], a[136:139]
  v_cvt_pk_bf16_f32 v107, v86, v87
  v_mfma_f32_16x16x32_bf16 a[140:143], a[208:211], v[124:127], a[140:143]
  s_add_u32 s62, s62, 8192
  s_waitcnt lgkmcnt(4)
  v_mfma_f32_16x16x32_bf16 v[64:67], a[144:147], a[0:3], v[48:51]
  v_exp_f32 v88, v88
  v_mfma_f32_16x16x32_bf16 v[64:67], a[148:151], a[16:19], v[64:67]
  ds_read_b64_tr_b16 a[176:177], v4 offset:16384
  ds_read_b64_tr_b16 a[178:179], v4 offset:24576
  v_mfma_f32_16x16x32_bf16 v[64:67], a[152:155], a[32:35], v[64:67]
  v_exp_f32 v89, v89
  v_mfma_f32_16x16x32_bf16 v[64:67], a[156:159], a[48:51], v[64:67]
  s_waitcnt lgkmcnt(2)
  ds_read_b64_tr_b16 a[180:181], v5 offset:16384
  ds_read_b64_tr_b16 a[182:183], v5 offset:24576
  v_mfma_f32_16x16x32_bf16 v[68:71], a[172:175], a[48:51], v[48:51]
  v_exp_f32 v90, v90
  v_mfma_f32_16x16x32_bf16 v[68:71], a[168:171], a[32:35], v[68:71]
  v_cvt_pk_bf16_f32 v108, v88, v89
  v_mfma_f32_16x16x32_bf16 v[68:71], a[164:167], a[16:19], v[68:71]
  v_exp_f32 v91, v91
  v_mfma_f32_16x16x32_bf16 v[68:71], a[160:163], a[0:3], v[68:71]
  v_cvt_pk_bf16_f32 v109, v90, v91
  v_mfma_f32_16x16x32_bf16 v[72:75], a[144:147], a[4:7], v[52:55]
  v_exp_f32 v92, v92
  v_mfma_f32_16x16x32_bf16 v[72:75], a[148:151], a[20:23], v[72:75]
  ds_read_b64_tr_b16 a[184:185], v6 offset:16384
  ds_read_b64_tr_b16 a[186:187], v6 offset:24576
  v_mfma_f32_16x16x32_bf16 v[72:75], a[152:155], a[36:39], v[72:75]
  v_exp_f32 v93, v93
  v_mfma_f32_16x16x32_bf16 v[72:75], a[156:159], a[52:55], v[72:75]
  ds_read_b64_tr_b16 a[188:189], v7 offset:16384
  ds_read_b64_tr_b16 a[190:191], v7 offset:24576
  v_mfma_f32_16x16x32_bf16 v[76:79], a[172:175], a[52:55], v[52:55]
  v_exp_f32 v94, v94
  v_mfma_f32_16x16x32_bf16 v[76:79], a[168:171], a[36:39], v[76:79]
  v_cvt_pk_bf16_f32 v110, v92, v93
  v_mfma_f32_16x16x32_bf16 v[76:79], a[164:167], a[20:23], v[76:79]
  v_exp_f32 v95, v95
  v_mfma_f32_16x16x32_bf16 v[76:79], a[160:163], a[4:7], v[76:79]
  v_cvt_pk_bf16_f32 v111, v94, v95
  v_mfma_f32_16x16x32_bf16 v[80:83], a[144:147], a[8:11], v[56:59]
  v_exp_f32 v64, v64
  v_mfma_f32_16x16x32_bf16 v[80:83], a[148:151], a[24:27], v[80:83]
  ds_read_b64_tr_b16 a[192:193], v8 offset:16384
  ds_read_b64_tr_b16 a[194:195], v8 offset:24576
  v_mfma_f32_16x16x32_bf16 v[80:83], a[152:155], a[40:43], v[80:83]
  v_exp_f32 v65, v65
  v_mfma_f32_16x16x32_bf16 v[80:83], a[156:159], a[56:59], v[80:83]
  ds_read_b64_tr_b16 a[196:197], v9 offset:16384
  ds_read_b64_tr_b16 a[198:199], v9 offset:24576
  v_mfma_f32_16x16x32_bf16 v[84:87], a[172:175], a[56:59], v[56:59]
  v_exp_f32 v66, v66
  v_mfma_f32_16x16x32_bf16 v[84:87], a[168:171], a[40:43], v[84:87]
  v_cvt_pk_bf16_f32 v112, v64, v65
  v_mfma_f32_16x16x32_bf16 v[84:87], a[164:167], a[24:27], v[84:87]
  v_exp_f32 v67, v67
  v_mfma_f32_16x16x32_bf16 v[84:87], a[160:163], a[8:11], v[84:87]
  v_cvt_pk_bf16_f32 v113, v66, v67
  v_mfma_f32_16x16x32_bf16 v[88:91], a[144:147], a[12:15], v[60:63]
  v_exp_f32 v68, v68
  v_mfma_f32_16x16x32_bf16 v[88:91], a[148:151], a[28:31], v[88:91]
  ds_read_b64_tr_b16 a[200:201], v10 offset:16384
  ds_read_b64_tr_b16 a[202:203], v10 offset:24576
  v_mfma_f32_16x16x32_bf16 v[88:91], a[152:155], a[44:47], v[88:91]
  v_exp_f32 v69, v69
  v_mfma_f32_16x16x32_bf16 v[88:91], a[156:159], a[60:63], v[88:91]
  ds_read_b64_tr_b16 a[204:205], v11 offset:16384
  ds_read_b64_tr_b16 a[206:207], v11 offset:24576
  v_mfma_f32_16x16x32_bf16 v[92:95], a[172:175], a[60:63], v[60:63]
  v_exp_f32 v70, v70
  v_mfma_f32_16x16x32_bf16 v[92:95], a[168:171], a[44:47], v[92:95]
  v_cvt_pk_bf16_f32 v114, v68, v69
  v_mfma_f32_16x16x32_bf16 v[92:95], a[164:167], a[28:31], v[92:95]
  v_exp_f32 v71, v71
  v_mfma_f32_16x16x32_bf16 v[92:95], a[160:163], a[12:15], v[92:95]
  v_cvt_pk_bf16_f32 v115, v70, v71
  s_waitcnt lgkmcnt(8)
  v_mfma_f32_16x16x32_bf16 v[128:131], a[176:179], v[96:99], v[128:131]
  v_exp_f32 v72, v72
  v_mfma_f32_16x16x32_bf16 v[132:135], a[176:179], v[100:103], v[132:135]
  v_mfma_f32_16x16x32_bf16 v[148:151], a[180:183], v[100:103], v[148:151]
  v_exp_f32 v73, v73
  v_mfma_f32_16x16x32_bf16 v[144:147], a[180:183], v[96:99], v[144:147]
  s_waitcnt lgkmcnt(0)
  v_cvt_pk_bf16_f32 v116, v72, v73
  v_mfma_f32_16x16x32_bf16 v[160:163], a[184:187], v[96:99], v[160:163]
  v_exp_f32 v74, v74
  v_mfma_f32_16x16x32_bf16 v[164:167], a[184:187], v[100:103], v[164:167]
  s_waitcnt vmcnt(10)
  s_barrier
  v_mfma_f32_16x16x32_bf16 v[180:183], a[188:191], v[100:103], v[180:183]
  v_exp_f32 v75, v75
  v_mfma_f32_16x16x32_bf16 v[176:179], a[188:191], v[96:99], v[176:179]
  v_cvt_pk_bf16_f32 v117, v74, v75
  v_mfma_f32_16x16x32_bf16 v[192:195], a[192:195], v[96:99], v[192:195]
  ds_read_b128 a[144:147], v12 offset:32768
  ds_read_b128 a[148:151], v13 offset:32768
  v_mfma_f32_16x16x32_bf16 v[196:199], a[192:195], v[100:103], v[196:199]
  v_exp_f32 v76, v76
  v_mfma_f32_16x16x32_bf16 v[212:215], a[196:199], v[100:103], v[212:215]
  s_add_u32 m0, s63, 49152
  v_mfma_f32_16x16x32_bf16 v[208:211], a[196:199], v[96:99], v[208:211]
  v_exp_f32 v77, v77
  v_mfma_f32_16x16x32_bf16 v[224:227], a[200:203], v[96:99], v[224:227]
  v_cvt_pk_bf16_f32 v118, v76, v77
  v_mfma_f32_16x16x32_bf16 v[228:231], a[200:203], v[100:103], v[228:231]
  v_exp_f32 v78, v78
  v_mfma_f32_16x16x32_bf16 v[244:247], a[204:207], v[100:103], v[244:247]
  buffer_load_dwordx4 v24, s[12:15], s62 offen offset:0 lds
  v_mfma_f32_16x16x32_bf16 v[240:243], a[204:207], v[96:99], v[240:243]
  v_exp_f32 v79, v79
  v_mfma_f32_16x16x32_bf16 a[128:131], a[208:211], v[96:99], a[128:131]
  v_cvt_pk_bf16_f32 v119, v78, v79
  v_mfma_f32_16x16x32_bf16 a[132:135], a[208:211], v[100:103], a[132:135]
  ds_read_b128 a[152:155], v14 offset:32768
  ds_read_b128 a[156:159], v15 offset:32768
  v_mfma_f32_16x16x32_bf16 v[252:255], a[204:207], v[108:111], v[252:255]
  v_exp_f32 v80, v80
  v_mfma_f32_16x16x32_bf16 v[248:251], a[204:207], v[104:107], v[248:251]
  buffer_load_dwordx4 v25, s[12:15], s62 offen offset:1024 lds
  v_mfma_f32_16x16x32_bf16 v[232:235], a[200:203], v[104:107], v[232:235]
  v_exp_f32 v81, v81
  v_mfma_f32_16x16x32_bf16 v[236:239], a[200:203], v[108:111], v[236:239]
  v_cvt_pk_bf16_f32 v120, v80, v81
  v_mfma_f32_16x16x32_bf16 v[220:223], a[196:199], v[108:111], v[220:223]
  v_exp_f32 v82, v82
  v_mfma_f32_16x16x32_bf16 v[216:219], a[196:199], v[104:107], v[216:219]
  buffer_load_dwordx4 v26, s[16:19], s62 offen offset:2048 lds
  v_mfma_f32_16x16x32_bf16 v[200:203], a[192:195], v[104:107], v[200:203]
  v_exp_f32 v83, v83
  v_mfma_f32_16x16x32_bf16 v[204:207], a[192:195], v[108:111], v[204:207]
  v_cvt_pk_bf16_f32 v121, v82, v83
  v_mfma_f32_16x16x32_bf16 v[188:191], a[188:191], v[108:111], v[188:191]
  ds_read_b128 a[160:163], v12 offset:40960
  ds_read_b128 a[164:167], v13 offset:40960
  v_mfma_f32_16x16x32_bf16 v[184:187], a[188:191], v[104:107], v[184:187]
  v_exp_f32 v84, v84
  v_mfma_f32_16x16x32_bf16 v[168:171], a[184:187], v[104:107], v[168:171]
  buffer_load_dwordx4 v27, s[16:19], s62 offen offset:3072 lds
  v_mfma_f32_16x16x32_bf16 v[172:175], a[184:187], v[108:111], v[172:175]
  v_exp_f32 v85, v85
  v_mfma_f32_16x16x32_bf16 v[156:159], a[180:183], v[108:111], v[156:159]
  v_cvt_pk_bf16_f32 v122, v84, v85
  v_mfma_f32_16x16x32_bf16 v[152:155], a[180:183], v[104:107], v[152:155]
  v_exp_f32 v86, v86
  v_mfma_f32_16x16x32_bf16 v[136:139], a[176:179], v[104:107], v[136:139]
  ds_read_b128 a[168:171], v14 offset:40960
  ds_read_b128 a[172:175], v15 offset:40960
  v_mfma_f32_16x16x32_bf16 v[140:143], a[176:179], v[108:111], v[140:143]
  v_exp_f32 v87, v87
  v_mfma_f32_16x16x32_bf16 a[136:139], a[208:211], v[104:107], a[136:139]
  v_cvt_pk_bf16_f32 v123, v86, v87
  v_mfma_f32_16x16x32_bf16 a[140:143], a[208:211], v[108:111], a[140:143]
  s_add_u32 s62, s62, 8192
  s_waitcnt lgkmcnt(4)
  v_mfma_f32_16x16x32_bf16 v[64:67], a[144:147], a[0:3], v[48:51]
  v_exp_f32 v88, v88
  v_mfma_f32_16x16x32_bf16 v[64:67], a[148:151], a[16:19], v[64:67]
  ds_read_b64_tr_b16 a[176:177], v4 offset:32768
  ds_read_b64_tr_b16 a[178:179], v4 offset:40960
  v_mfma_f32_16x16x32_bf16 v[64:67], a[152:155], a[32:35], v[64:67]
  v_exp_f32 v89, v89
  v_mfma_f32_16x16x32_bf16 v[64:67], a[156:159], a[48:51], v[64:67]
  s_waitcnt lgkmcnt(2)
  ds_read_b64_tr_b16 a[180:181], v5 offset:32768
  ds_read_b64_tr_b16 a[182:183], v5 offset:40960
  v_mfma_f32_16x16x32_bf16 v[68:71], a[172:175], a[48:51], v[48:51]
  v_exp_f32 v90, v90
  v_mfma_f32_16x16x32_bf16 v[68:71], a[168:171], a[32:35], v[68:71]
  v_cvt_pk_bf16_f32 v124, v88, v89
  v_mfma_f32_16x16x32_bf16 v[68:71], a[164:167], a[16:19], v[68:71]
  v_exp_f32 v91, v91
  v_mfma_f32_16x16x32_bf16 v[68:71], a[160:163], a[0:3], v[68:71]
  v_cvt_pk_bf16_f32 v125, v90, v91
  v_mfma_f32_16x16x32_bf16 v[72:75], a[144:147], a[4:7], v[52:55]
  v_exp_f32 v92, v92
  v_mfma_f32_16x16x32_bf16 v[72:75], a[148:151], a[20:23], v[72:75]
  ds_read_b64_tr_b16 a[184:185], v6 offset:32768
  ds_read_b64_tr_b16 a[186:187], v6 offset:40960
  v_mfma_f32_16x16x32_bf16 v[72:75], a[152:155], a[36:39], v[72:75]
  v_exp_f32 v93, v93
  v_mfma_f32_16x16x32_bf16 v[72:75], a[156:159], a[52:55], v[72:75]
  ds_read_b64_tr_b16 a[188:189], v7 offset:32768
  ds_read_b64_tr_b16 a[190:191], v7 offset:40960
  v_mfma_f32_16x16x32_bf16 v[76:79], a[172:175], a[52:55], v[52:55]
  v_exp_f32 v94, v94
  v_mfma_f32_16x16x32_bf16 v[76:79], a[168:171], a[36:39], v[76:79]
  v_cvt_pk_bf16_f32 v126, v92, v93
  v_mfma_f32_16x16x32_bf16 v[76:79], a[164:167], a[20:23], v[76:79]
  v_exp_f32 v95, v95
  v_mfma_f32_16x16x32_bf16 v[76:79], a[160:163], a[4:7], v[76:79]
  v_cvt_pk_bf16_f32 v127, v94, v95
  v_mfma_f32_16x16x32_bf16 v[80:83], a[144:147], a[8:11], v[56:59]
  v_exp_f32 v64, v64
  v_mfma_f32_16x16x32_bf16 v[80:83], a[148:151], a[24:27], v[80:83]
  ds_read_b64_tr_b16 a[192:193], v8 offset:32768
  ds_read_b64_tr_b16 a[194:195], v8 offset:40960
  v_mfma_f32_16x16x32_bf16 v[80:83], a[152:155], a[40:43], v[80:83]
  v_exp_f32 v65, v65
  v_mfma_f32_16x16x32_bf16 v[80:83], a[156:159], a[56:59], v[80:83]
  ds_read_b64_tr_b16 a[196:197], v9 offset:32768
  ds_read_b64_tr_b16 a[198:199], v9 offset:40960
  v_mfma_f32_16x16x32_bf16 v[84:87], a[172:175], a[56:59], v[56:59]
  v_exp_f32 v66, v66
  v_mfma_f32_16x16x32_bf16 v[84:87], a[168:171], a[40:43], v[84:87]
  v_cvt_pk_bf16_f32 v96, v64, v65
  v_mfma_f32_16x16x32_bf16 v[84:87], a[164:167], a[24:27], v[84:87]
  v_exp_f32 v67, v67
  v_mfma_f32_16x16x32_bf16 v[84:87], a[160:163], a[8:11], v[84:87]
  v_cvt_pk_bf16_f32 v97, v66, v67
  v_mfma_f32_16x16x32_bf16 v[88:91], a[144:147], a[12:15], v[60:63]
  v_exp_f32 v68, v68
  v_mfma_f32_16x16x32_bf16 v[88:91], a[148:151], a[28:31], v[88:91]
  ds_read_b64_tr_b16 a[200:201], v10 offset:32768
  ds_read_b64_tr_b16 a[202:203], v10 offset:40960
  v_mfma_f32_16x16x32_bf16 v[88:91], a[152:155], a[44:47], v[88:91]
  v_exp_f32 v69, v69
  v_mfma_f32_16x16x32_bf16 v[88:91], a[156:159], a[60:63], v[88:91]
  ds_read_b64_tr_b16 a[204:205], v11 offset:32768
  ds_read_b64_tr_b16 a[206:207], v11 offset:40960
  v_mfma_f32_16x16x32_bf16 v[92:95], a[172:175], a[60:63], v[60:63]
  v_exp_f32 v70, v70
  v_mfma_f32_16x16x32_bf16 v[92:95], a[168:171], a[44:47], v[92:95]
  v_cvt_pk_bf16_f32 v98, v68, v69
  v_mfma_f32_16x16x32_bf16 v[92:95], a[164:167], a[28:31], v[92:95]
  v_exp_f32 v71, v71
  v_mfma_f32_16x16x32_bf16 v[92:95], a[160:163], a[12:15], v[92:95]
  v_cvt_pk_bf16_f32 v99, v70, v71
  s_waitcnt lgkmcnt(8)
  v_mfma_f32_16x16x32_bf16 v[128:131], a[176:179], v[112:115], v[128:131]
  v_exp_f32 v72, v72
  v_mfma_f32_16x16x32_bf16 v[132:135], a[176:179], v[116:119], v[132:135]
  v_mfma_f32_16x16x32_bf16 v[148:151], a[180:183], v[116:119], v[148:151]
  v_exp_f32 v73, v73
  v_mfma_f32_16x16x32_bf16 v[144:147], a[180:183], v[112:115], v[144:147]
  s_waitcnt lgkmcnt(0)
  v_cvt_pk_bf16_f32 v100, v72, v73
  v_mfma_f32_16x16x32_bf16 v[160:163], a[184:187], v[112:115], v[160:163]
  v_exp_f32 v74, v74
  v_mfma_f32_16x16x32_bf16 v[164:167], a[184:187], v[116:119], v[164:167]
  s_waitcnt vmcnt(10)
  s_barrier
  v_mfma_f32_16x16x32_bf16 v[180:183], a[188:191], v[116:119], v[180:183]
  v_exp_f32 v75, v75
  v_mfma_f32_16x16x32_bf16 v[176:179], a[188:191], v[112:115], v[176:179]
  v_cvt_pk_bf16_f32 v101, v74, v75
  v_mfma_f32_16x16x32_bf16 v[192:195], a[192:195], v[112:115], v[192:195]
  ds_read_b128 a[144:147], v12 offset:49152
  ds_read_b128 a[148:151], v13 offset:49152
  v_mfma_f32_16x16x32_bf16 v[196:199], a[192:195], v[116:119], v[196:199]
  v_exp_f32 v76, v76
  v_mfma_f32_16x16x32_bf16 v[212:215], a[196:199], v[116:119], v[212:215]
  s_add_u32 m0, s63, 65536
  v_mfma_f32_16x16x32_bf16 v[208:211], a[196:199], v[112:115], v[208:211]
  v_exp_f32 v77, v77
  v_mfma_f32_16x16x32_bf16 v[224:227], a[200:203], v[112:115], v[224:227]
  v_cvt_pk_bf16_f32 v102, v76, v77
  v_mfma_f32_16x16x32_bf16 v[228:231], a[200:203], v[116:119], v[228:231]
  v_exp_f32 v78, v78
  v_mfma_f32_16x16x32_bf16 v[244:247], a[204:207], v[116:119], v[244:247]
  buffer_load_dwordx4 v26, s[16:19], s62 offen offset:2048 lds
  v_mfma_f32_16x16x32_bf16 v[240:243], a[204:207], v[112:115], v[240:243]
  v_exp_f32 v79, v79
  v_mfma_f32_16x16x32_bf16 a[128:131], a[208:211], v[112:115], a[128:131]
  v_cvt_pk_bf16_f32 v103, v78, v79
  v_mfma_f32_16x16x32_bf16 a[132:135], a[208:211], v[116:119], a[132:135]
  ds_read_b128 a[152:155], v14 offset:49152
  ds_read_b128 a[156:159], v15 offset:49152
  v_mfma_f32_16x16x32_bf16 v[252:255], a[204:207], v[124:127], v[252:255]
  v_exp_f32 v80, v80
  v_mfma_f32_16x16x32_bf16 v[248:251], a[204:207], v[120:123], v[248:251]
  buffer_load_dwordx4 v27, s[16:19], s62 offen offset:3072 lds
  v_mfma_f32_16x16x32_bf16 v[232:235], a[200:203], v[120:123], v[232:235]
  v_exp_f32 v81, v81
  v_mfma_f32_16x16x32_bf16 v[236:239], a[200:203], v[124:127], v[236:239]
  v_cvt_pk_bf16_f32 v104, v80, v81
  v_mfma_f32_16x16x32_bf16 v[220:223], a[196:199], v[124:127], v[220:223]
  v_exp_f32 v82, v82
  v_mfma_f32_16x16x32_bf16 v[216:219], a[196:199], v[120:123], v[216:219]
  s_add_u32 s62, s62, 8192
  v_mfma_f32_16x16x32_bf16 v[200:203], a[192:195], v[120:123], v[200:203]
  v_exp_f32 v83, v83
  v_mfma_f32_16x16x32_bf16 v[204:207], a[192:195], v[124:127], v[204:207]
  v_cvt_pk_bf16_f32 v105, v82, v83
  v_mfma_f32_16x16x32_bf16 v[188:191], a[188:191], v[124:127], v[188:191]
  ds_read_b128 a[160:163], v12 offset:57344
  ds_read_b128 a[164:167], v13 offset:57344
  v_mfma_f32_16x16x32_bf16 v[184:187], a[188:191], v[120:123], v[184:187]
  v_exp_f32 v84, v84
  v_mfma_f32_16x16x32_bf16 v[168:171], a[184:187], v[120:123], v[168:171]
  v_mfma_f32_16x16x32_bf16 v[172:175], a[184:187], v[124:127], v[172:175]
  v_exp_f32 v85, v85
  v_mfma_f32_16x16x32_bf16 v[156:159], a[180:183], v[124:127], v[156:159]
  v_cvt_pk_bf16_f32 v106, v84, v85
  s_waitcnt vmcnt(6)
  v_bfe_u32 v47, v47, 8, 8
  v_cmp_gt_u32 vcc, 8, v47
  s_cbranch_vccz L_rdy_9
  s_mov_b32 s101, 0
L_spin_10:
  buffer_load_dword v47, v46, s[48:51], 0 offen sc1
  s_waitcnt vmcnt(0)
  s_add_u32 s101, s101, 1
  s_cmp_gt_u32 s101, 0x40000
  s_cbranch_scc1 L_ok_11
  v_bfe_u32 v47, v47, 8, 8
  v_cmp_gt_u32 vcc, 8, v47
  s_cbranch_vccnz L_spin_10
L_ok_11:
L_rdy_9:
  s_add_u32 s98, s79, 0
  v_mfma_f32_16x16x32_bf16 v[152:155], a[180:183], v[120:123], v[152:155]
  v_exp_f32 v86, v86
  buffer_load_dwordx4 a[64:67], v0, s[52:55], s98 offen offset:0 sc1
  v_mfma_f32_16x16x32_bf16 v[136:139], a[176:179], v[120:123], v[136:139]
  ds_read_b128 a[168:171], v14 offset:57344
  ds_read_b128 a[172:175], v15 offset:57344
  buffer_load_dwordx4 a[68:71], v0, s[52:55], s98 offen offset:1024 sc1
  buffer_load_dwordx4 a[72:75], v0, s[52:55], s98 offen offset:2048 sc1
  v_mfma_f32_16x16x32_bf16 v[140:143], a[176:179], v[124:127], v[140:143]
  v_exp_f32 v87, v87
  buffer_load_dwordx4 a[76:79], v0, s[52:55], s98 offen offset:3072 sc1
  v_mfma_f32_16x16x32_bf16 a[136:139], a[208:211], v[120:123], a[136:139]
  v_cvt_pk_bf16_f32 v107, v86, v87
  s_add_u32 s98, s79, 4096
  buffer_load_dwordx4 a[80:83], v0, s[52:55], s98 offen offset:0 sc1
  v_mfma_f32_16x16x32_bf16 a[140:143], a[208:211], v[124:127], a[140:143]
  buffer_load_dwordx4 a[84:87], v0, s[52:55], s98 offen offset:1024 sc1
  s_waitcnt lgkmcnt(4)
  v_mfma_f32_16x16x32_bf16 v[64:67], a[144:147], a[0:3], v[48:51]
  v_exp_f32 v88, v88
  v_mfma_f32_16x16x32_bf16 v[64:67], a[148:151], a[16:19], v[64:67]
  ds_read_b64_tr_b16 a[176:177], v4 offset:49152
  ds_read_b64_tr_b16 a[178:179], v4 offset:57344
  v_mfma_f32_16x16x32_bf16 v[64:67], a[152:155], a[32:35], v[64:67]
  v_exp_f32 v89, v89
  v_mfma_f32_16x16x32_bf16 v[64:67], a[156:159], a[48:51], v[64:67]
  s_waitcnt lgkmcnt(2)
  ds_read_b64_tr_b16 a[180:181], v5 offset:49152
  ds_read_b64_tr_b16 a[182:183], v5 offset:57344
  v_mfma_f32_16x16x32_bf16 v[68:71], a[172:175], a[48:51], v[48:51]
  v_exp_f32 v90, v90
  v_mfma_f32_16x16x32_bf16 v[68:71], a[168:171], a[32:35], v[68:71]
  v_cvt_pk_bf16_f32 v108, v88, v89
  v_mfma_f32_16x16x32_bf16 v[68:71], a[164:167], a[16:19], v[68:71]
  v_exp_f32 v91, v91
  v_mfma_f32_16x16x32_bf16 v[68:71], a[160:163], a[0:3], v[68:71]
  v_cvt_pk_bf16_f32 v109, v90, v91
  v_mfma_f32_16x16x32_bf16 v[72:75], a[144:147], a[4:7], v[52:55]
  v_exp_f32 v92, v92
  v_mfma_f32_16x16x32_bf16 v[72:75], a[148:151], a[20:23], v[72:75]
  ds_read_b64_tr_b16 a[184:185], v6 offset:49152
  ds_read_b64_tr_b16 a[186:187], v6 offset:57344
  v_mfma_f32_16x16x32_bf16 v[72:75], a[152:155], a[36:39], v[72:75]
  v_exp_f32 v93, v93
  v_mfma_f32_16x16x32_bf16 v[72:75], a[156:159], a[52:55], v[72:75]
  ds_read_b64_tr_b16 a[188:189], v7 offset:49152
  ds_read_b64_tr_b16 a[190:191], v7 offset:57344
  v_mfma_f32_16x16x32_bf16 v[76:79], a[172:175], a[52:55], v[52:55]
  v_exp_f32 v94, v94
  v_mfma_f32_16x16x32_bf16 v[76:79], a[168:171], a[36:39], v[76:79]
  v_cvt_pk_bf16_f32 v110, v92, v93
  v_mfma_f32_16x16x32_bf16 v[76:79], a[164:167], a[20:23], v[76:79]
  v_exp_f32 v95, v95
  v_mfma_f32_16x16x32_bf16 v[76:79], a[160:163], a[4:7], v[76:79]
  v_cvt_pk_bf16_f32 v111, v94, v95
  v_mfma_f32_16x16x32_bf16 v[80:83], a[144:147], a[8:11], v[56:59]
  v_exp_f32 v64, v64
  v_mfma_f32_16x16x32_bf16 v[80:83], a[148:151], a[24:27], v[80:83]
  ds_read_b64_tr_b16 a[192:193], v8 offset:49152
  ds_read_b64_tr_b16 a[194:195], v8 offset:57344
  v_mfma_f32_16x16x32_bf16 v[80:83], a[152:155], a[40:43], v[80:83]
  v_exp_f32 v65, v65
  v_mfma_f32_16x16x32_bf16 v[80:83], a[156:159], a[56:59], v[80:83]
  ds_read_b64_tr_b16 a[196:197], v9 offset:49152
  ds_read_b64_tr_b16 a[198:199], v9 offset:57344
  v_mfma_f32_16x16x32_bf16 v[84:87], a[172:175], a[56:59], v[56:59]
  v_exp_f32 v66, v66
  v_mfma_f32_16x16x32_bf16 v[84:87], a[168:171], a[40:43], v[84:87]
  v_cvt_pk_bf16_f32 v112, v64, v65
  v_mfma_f32_16x16x32_bf16 v[84:87], a[164:167], a[24:27], v[84:87]
  v_exp_f32 v67, v67
  v_mfma_f32_16x16x32_bf16 v[84:87], a[160:163], a[8:11], v[84:87]
  v_cvt_pk_bf16_f32 v113, v66, v67
  v_mfma_f32_16x16x32_bf16 v[88:91], a[144:147], a[12:15], v[60:63]
  v_exp_f32 v68, v68
  v_mfma_f32_16x16x32_bf16 v[88:91], a[148:151], a[28:31], v[88:91]
  ds_read_b64_tr_b16 a[200:201], v10 offset:49152
  ds_read_b64_tr_b16 a[202:203], v10 offset:57344
  v_mfma_f32_16x16x32_bf16 v[88:91], a[152:155], a[44:47], v[88:91]
  v_exp_f32 v69, v69
  v_mfma_f32_16x16x32_bf16 v[88:91], a[156:159], a[60:63], v[88:91]
  ds_read_b64_tr_b16 a[204:205], v11 offset:49152
  ds_read_b64_tr_b16 a[206:207], v11 offset:57344
  v_mfma_f32_16x16x32_bf16 v[92:95], a[172:175], a[60:63], v[60:63]
  v_exp_f32 v70, v70
  v_mfma_f32_16x16x32_bf16 v[92:95], a[168:171], a[44:47], v[92:95]
  v_cvt_pk_bf16_f32 v114, v68, v69
  v_mfma_f32_16x16x32_bf16 v[92:95], a[164:167], a[28:31], v[92:95]
  v_exp_f32 v71, v71
  v_mfma_f32_16x16x32_bf16 v[92:95], a[160:163], a[12:15], v[92:95]
  v_cvt_pk_bf16_f32 v115, v70, v71
  s_waitcnt lgkmcnt(8)
  v_mfma_f32_16x16x32_bf16 v[128:131], a[176:179], v[96:99], v[128:131]
  v_exp_f32 v72, v72
  v_mfma_f32_16x16x32_bf16 v[132:135], a[176:179], v[100:103], v[132:135]
  v_mfma_f32_16x16x32_bf16 v[148:151], a[180:183], v[100:103], v[148:151]
  v_exp_f32 v73, v73
  v_mfma_f32_16x16x32_bf16 v[144:147], a[180:183], v[96:99], v[144:147]
  s_waitcnt lgkmcnt(0)
  v_cvt_pk_bf16_f32 v116, v72, v73
  v_mfma_f32_16x16x32_bf16 v[160:163], a[184:187], v[96:99], v[160:163]
  v_exp_f32 v74, v74
  v_mfma_f32_16x16x32_bf16 v[164:167], a[184:187], v[100:103], v[164:167]
  s_waitcnt vmcnt(14)
  s_barrier
  v_mfma_f32_16x16x32_bf16 v[180:183], a[188:191], v[100:103], v[180:183]
  v_exp_f32 v75, v75
  v_lshrrev_b32 v30, 1, v1
  v_mfma_f32_16x16x32_bf16 v[176:179], a[188:191], v[96:99], v[176:179]
  v_cvt_pk_bf16_f32 v117, v74, v75
  v_mfma_f32_16x16x32_bf16 v[192:195], a[192:195], v[96:99], v[192:195]
  ds_read_b128 a[144:147], v12 offset:0
  ds_read_b128 a[148:151], v13 offset:0
  v_mfma_f32_16x16x32_bf16 v[196:199], a[192:195], v[100:103], v[196:199]
  v_exp_f32 v76, v76
  v_mfma_f32_16x16x32_bf16 v[212:215], a[196:199], v[100:103], v[212:215]
  v_lshlrev_b32 v30, 10, v30
  s_add_u32 s98, s79, 4096
  buffer_load_dwordx4 a[88:91], v0, s[52:55], s98 offen offset:2048 sc1
  v_mfma_f32_16x16x32_bf16 v[208:211], a[196:199], v[96:99], v[208:211]
  v_exp_f32 v77, v77
  v_mfma_f32_16x16x32_bf16 v[224:227], a[200:203], v[96:99], v[224:227]
  v_cvt_pk_bf16_f32 v118, v76, v77
  v_mfma_f32_16x16x32_bf16 v[228:231], a[200:203], v[100:103], v[228:231]
  v_exp_f32 v78, v78
  v_mfma_f32_16x16x32_bf16 v[244:247], a[204:207], v[100:103], v[244:247]
  buffer_load_dwordx4 a[92:95], v0, s[52:55], s98 offen offset:3072 sc1
  s_add_u32 s98, s79, 8192
  v_mfma_f32_16x16x32_bf16 v[240:243], a[204:207], v[96:99], v[240:243]
  v_exp_f32 v79, v79
  v_and_b32 v31, 1, v1
  v_mfma_f32_16x16x32_bf16 a[128:131], a[208:211], v[96:99], a[128:131]
  v_cvt_pk_bf16_f32 v119, v78, v79
  v_mfma_f32_16x16x32_bf16 a[132:135], a[208:211], v[100:103], a[132:135]
  ds_read_b128 a[152:155], v14 offset:0
  ds_read_b128 a[156:159], v15 offset:0
  v_mfma_f32_16x16x32_bf16 v[252:255], a[204:207], v[108:111], v[252:255]
  v_exp_f32 v80, v80
  v_mfma_f32_16x16x32_bf16 v[248:251], a[204:207], v[104:107], v[248:251]
  v_lshl_add_u32 v31, v31, 7, v30
  buffer_load_dwordx4 a[96:99], v0, s[52:55], s98 offen offset:0 sc1
  buffer_load_dwordx4 a[100:103], v0, s[52:55], s98 offen offset:1024 sc1
  v_mfma_f32_16x16x32_bf16 v[232:235], a[200:203], v[104:107], v[232:235]
  v_exp_f32 v81, v81
  v_mfma_f32_16x16x32_bf16 v[236:239], a[200:203], v[108:111], v[236:239]
  v_cvt_pk_bf16_f32 v120, v80, v81
  v_mfma_f32_16x16x32_bf16 v[220:223], a[196:199], v[108:111], v[220:223]
  v_exp_f32 v82, v82
  v_mfma_f32_16x16x32_bf16 v[216:219], a[196:199], v[104:107], v[216:219]
  buffer_load_dwordx4 a[104:107], v0, s[52:55], s98 offen offset:2048 sc1
  buffer_load_dwordx4 a[108:111], v0, s[52:55], s98 offen offset:3072 sc1
  v_mfma_f32_16x16x32_bf16 v[200:203], a[192:195], v[104:107], v[200:203]
  v_exp_f32 v83, v83
  s_mul_i32 s99, s96, 32768
  v_mfma_f32_16x16x32_bf16 v[204:207], a[192:195], v[108:111], v[204:207]
  v_cvt_pk_bf16_f32 v121, v82, v83
  v_mfma_f32_16x16x32_bf16 v[188:191], a[188:191], v[108:111], v[188:191]
  ds_read_b128 a[160:163], v12 offset:8192
  ds_read_b128 a[164:167], v13 offset:8192
  v_mfma_f32_16x16x32_bf16 v[184:187], a[188:191], v[104:107], v[184:187]
  v_exp_f32 v84, v84
  v_mfma_f32_16x16x32_bf16 v[168:171], a[184:187], v[104:107], v[168:171]
  v_mfma_f32_16x16x32_bf16 v[172:175], a[184:187], v[108:111], v[172:175]
  v_exp_f32 v85, v85
  v_mfma_f32_16x16x32_bf16 v[156:159], a[180:183], v[108:111], v[156:159]
  v_cvt_pk_bf16_f32 v122, v84, v85
  buffer_load_dword a255, v31, s[24:27], s99 offen
  v_mfma_f32_16x16x32_bf16 v[152:155], a[180:183], v[104:107], v[152:155]
  v_exp_f32 v86, v86
  v_mfma_f32_16x16x32_bf16 v[136:139], a[176:179], v[104:107], v[136:139]
  ds_read_b128 a[168:171], v14 offset:8192
  ds_read_b128 a[172:175], v15 offset:8192
  v_mfma_f32_16x16x32_bf16 v[140:143], a[176:179], v[108:111], v[140:143]
  v_exp_f32 v87, v87
  s_add_u32 s99, s99, 32768
  s_cmp_lt_u32 s3, 3
  s_cbranch_scc1 L_ct_12
  s_lshr_b32 s99, s2, 3
  s_mul_i32 s99, s99, 8
  v_add_u32 v30, s99, v1
  v_lshlrev_b32 v30, 7, v30
  v_min_u32 v30, L_slow-L_attn_end, v30
  v_add_u32 v30, L_attn_end-L_pc2, v30
  v_mov_b32 v31, s73
  v_add_co_u32 v30, vcc, s72, v30
  s_nop 1
  v_addc_co_u32 v31, vcc, 0, v31, vcc
  s_mov_b64 exec, 255
  global_load_dword a255, v[30:31], off
  s_mov_b64 exec, -1
L_ct_12:
  v_mfma_f32_16x16x32_bf16 a[136:139], a[208:211], v[104:107], a[136:139]
  v_cvt_pk_bf16_f32 v123, v86, v87
  v_mfma_f32_16x16x32_bf16 a[140:143], a[208:211], v[108:111], a[140:143]
  s_waitcnt lgkmcnt(4)
  v_mfma_f32_16x16x32_bf16 v[64:67], a[144:147], a[0:3], v[48:51]
  v_exp_f32 v88, v88
  v_mfma_f32_16x16x32_bf16 v[64:67], a[148:151], a[16:19], v[64:67]
  ds_read_b64_tr_b16 a[176:177], v4 offset:0
  ds_read_b64_tr_b16 a[178:179], v4 offset:8192
  v_mfma_f32_16x16x32_bf16 v[64:67], a[152:155], a[32:35], v[64:67]
  v_exp_f32 v89, v89
  v_mfma_f32_16x16x32_bf16 v[64:67], a[156:159], a[48:51], v[64:67]
  s_waitcnt lgkmcnt(2)
  ds_read_b64_tr_b16 a[180:181], v5 offset:0
  ds_read_b64_tr_b16 a[182:183], v5 offset:8192
  v_mfma_f32_16x16x32_bf16 v[68:71], a[172:175], a[48:51], v[48:51]
  v_exp_f32 v90, v90
  v_mfma_f32_16x16x32_bf16 v[68:71], a[168:171], a[32:35], v[68:71]
  v_cvt_pk_bf16_f32 v124, v88, v89
  v_mfma_f32_16x16x32_bf16 v[68:71], a[164:167], a[16:19], v[68:71]
  v_exp_f32 v91, v91
  v_mfma_f32_16x16x32_bf16 v[68:71], a[160:163], a[0:3], v[68:71]
  v_cvt_pk_bf16_f32 v125, v90, v91
  v_mfma_f32_16x16x32_bf16 v[72:75], a[144:147], a[4:7], v[52:55]
  v_exp_f32 v92, v92
  v_mfma_f32_16x16x32_bf16 v[72:75], a[148:151], a[20:23], v[72:75]
  ds_read_b64_tr_b16 a[184:185], v6 offset:0
  ds_read_b64_tr_b16 a[186:187], v6 offset:8192
  v_mfma_f32_16x16x32_bf16 v[72:75], a[152:155], a[36:39], v[72:75]
  v_exp_f32 v93, v93
  v_mfma_f32_16x16x32_bf16 v[72:75], a[156:159], a[52:55], v[72:75]
  ds_read_b64_tr_b16 a[188:189], v7 offset:0
  ds_read_b64_tr_b16 a[190:191], v7 offset:8192
  v_mfma_f32_16x16x32_bf16 v[76:79], a[172:175], a[52:55], v[52:55]
  v_exp_f32 v94, v94
  v_mfma_f32_16x16x32_bf16 v[76:79], a[168:171], a[36:39], v[76:79]
  v_cvt_pk_bf16_f32 v126, v92, v93
  v_mfma_f32_16x16x32_bf16 v[76:79], a[164:167], a[20:23], v[76:79]
  v_exp_f32 v95, v95
  v_mfma_f32_16x16x32_bf16 v[76:79], a[160:163], a[4:7], v[76:79]
  v_cvt_pk_bf16_f32 v127, v94, v95
  v_mfma_f32_16x16x32_bf16 v[80:83], a[144:147], a[8:11], v[56:59]
  v_exp_f32 v64, v64
  v_mfma_f32_16x16x32_bf16 v[80:83], a[148:151], a[24:27], v[80:83]
  ds_read_b64_tr_b16 a[192:193], v8 offset:0
  ds_read_b64_tr_b16 a[194:195], v8 offset:8192
  v_mfma_f32_16x16x32_bf16 v[80:83], a[152:155], a[40:43], v[80:83]
  v_exp_f32 v65, v65
  v_mfma_f32_16x16x32_bf16 v[80:83], a[156:159], a[56:59], v[80:83]
  ds_read_b64_tr_b16 a[196:197], v9 offset:0
  ds_read_b64_tr_b16 a[198:199], v9 offset:8192
  v_mfma_f32_16x16x32_bf16 v[84:87], a[172:175], a[56:59], v[56:59]
  v_exp_f32 v66, v66
  v_mfma_f32_16x16x32_bf16 v[84:87], a[168:171], a[40:43], v[84:87]
  v_cvt_pk_bf16_f32 v96, v64, v65
  v_mfma_f32_16x16x32_bf16 v[84:87], a[164:167], a[24:27], v[84:87]
  v_exp_f32 v67, v67
  v_mfma_f32_16x16x32_bf16 v[84:87], a[160:163], a[8:11], v[84:87]
  v_cvt_pk_bf16_f32 v97, v66, v67
  v_mfma_f32_16x16x32_bf16 v[88:91], a[144:147], a[12:15], v[60:63]
  v_exp_f32 v68, v68
  v_mfma_f32_16x16x32_bf16 v[88:91], a[148:151], a[28:31], v[88:91]
  ds_read_b64_tr_b16 a[200:201], v10 offset:0
  ds_read_b64_tr_b16 a[202:203], v10 offset:8192
  v_mfma_f32_16x16x32_bf16 v[88:91], a[152:155], a[44:47], v[88:91]
  v_exp_f32 v69, v69
  v_mfma_f32_16x16x32_bf16 v[88:91], a[156:159], a[60:63], v[88:91]
  ds_read_b64_tr_b16 a[204:205], v11 offset:0
  ds_read_b64_tr_b16 a[206:207], v11 offset:8192
  v_mfma_f32_16x16x32_bf16 v[92:95], a[172:175], a[60:63], v[60:63]
  v_exp_f32 v70, v70
  v_mfma_f32_16x16x32_bf16 v[92:95], a[168:171], a[44:47], v[92:95]
  v_cvt_pk_bf16_f32 v98, v68, v69
  v_mfma_f32_16x16x32_bf16 v[92:95], a[164:167], a[28:31], v[92:95]
  v_exp_f32 v71, v71
  v_mfma_f32_16x16x32_bf16 v[92:95], a[160:163], a[12:15], v[92:95]
  v_cvt_pk_bf16_f32 v99, v70, v71
  s_waitcnt lgkmcnt(8)
  v_mfma_f32_16x16x32_bf16 v[128:131], a[176:179], v[112:115], v[128:131]
  v_exp_f32 v72, v72
  v_mfma_f32_16x16x32_bf16 v[132:135], a[176:179], v[116:119], v[132:135]
  v_mfma_f32_16x16x32_bf16 v[148:151], a[180:183], v[116:119], v[148:151]
  v_exp_f32 v73, v73
  v_mfma_f32_16x16x32_bf16 v[144:147], a[180:183], v[112:115], v[144:147]
  s_waitcnt lgkmcnt(0)
  v_cvt_pk_bf16_f32 v100, v72, v73
  v_mfma_f32_16x16x32_bf16 v[160:163], a[184:187], v[112:115], v[160:163]
  v_exp_f32 v74, v74
  v_mfma_f32_16x16x32_bf16 v[164:167], a[184:187], v[116:119], v[164:167]
  s_waitcnt vmcnt(15)
  s_barrier
  v_mfma_f32_16x16x32_bf16 v[180:183], a[188:191], v[116:119], v[180:183]
  v_exp_f32 v75, v75
  v_mfma_f32_16x16x32_bf16 v[176:179], a[188:191], v[112:115], v[176:179]
  v_cvt_pk_bf16_f32 v101, v74, v75
  v_mfma_f32_16x16x32_bf16 v[192:195], a[192:195], v[112:115], v[192:195]
  ds_read_b128 a[144:147], v12 offset:16384
  ds_read_b128 a[148:151], v13 offset:16384
  v_mfma_f32_16x16x32_bf16 v[196:199], a[192:195], v[116:119], v[196:199]
  v_exp_f32 v76, v76
  v_mfma_f32_16x16x32_bf16 v[212:215], a[196:199], v[116:119], v[212:215]
  s_add_u32 s98, s79, 12288
  buffer_load_dwordx4 a[112:115], v0, s[52:55], s98 offen offset:0 sc1
  v_mfma_f32_16x16x32_bf16 v[208:211], a[196:199], v[112:115], v[208:211]
  v_exp_f32 v77, v77
  v_mfma_f32_16x16x32_bf16 v[224:227], a[200:203], v[112:115], v[224:227]
  v_cvt_pk_bf16_f32 v102, v76, v77
  v_mfma_f32_16x16x32_bf16 v[228:231], a[200:203], v[116:119], v[228:231]
  v_exp_f32 v78, v78
  v_mfma_f32_16x16x32_bf16 v[244:247], a[204:207], v[116:119], v[244:247]
  buffer_load_dwordx4 a[116:119], v0, s[52:55], s98 offen offset:1024 sc1
  buffer_load_dwordx4 a[120:123], v0, s[52:55], s98 offen offset:2048 sc1
  v_mfma_f32_16x16x32_bf16 v[240:243], a[204:207], v[112:115], v[240:243]
  v_exp_f32 v79, v79
  v_mfma_f32_16x16x32_bf16 a[128:131], a[208:211], v[112:115], a[128:131]
  v_cvt_pk_bf16_f32 v103, v78, v79
  v_mfma_f32_16x16x32_bf16 a[132:135], a[208:211], v[116:119], a[132:135]
  ds_read_b128 a[152:155], v14 offset:16384
  ds_read_b128 a[156:159], v15 offset:16384
  v_mfma_f32_16x16x32_bf16 v[252:255], a[204:207], v[124:127], v[252:255]
  v_exp_f32 v80, v80
  v_mfma_f32_16x16x32_bf16 v[248:251], a[204:207], v[120:123], v[248:251]
  buffer_load_dwordx4 a[124:127], v0, s[52:55], s98 offen offset:3072 sc1
  buffer_load_dwordx4 v[32:35], v0, s[52:55], s80 offen sc1
  v_mfma_f32_16x16x32_bf16 v[232:235], a[200:203], v[120:123], v[232:235]
  v_exp_f32 v81, v81
  v_mfma_f32_16x16x32_bf16 v[236:239], a[200:203], v[124:127], v[236:239]
  v_cvt_pk_bf16_f32 v104, v80, v81
  v_mfma_f32_16x16x32_bf16 v[220:223], a[196:199], v[124:127], v[220:223]
  v_exp_f32 v82, v82
  v_mfma_f32_16x16x32_bf16 v[216:219], a[196:199], v[120:123], v[216:219]
  s_add_u32 s98, s80, 16384
  buffer_load_dwordx4 v[36:39], v0, s[52:55], s98 offen sc1
  v_mfma_f32_16x16x32_bf16 v[200:203], a[192:195], v[120:123], v[200:203]
  v_exp_f32 v83, v83
  v_mfma_f32_16x16x32_bf16 v[204:207], a[192:195], v[124:127], v[204:207]
  v_cvt_pk_bf16_f32 v105, v82, v83
  v_mfma_f32_16x16x32_bf16 v[188:191], a[188:191], v[124:127], v[188:191]
  ds_read_b128 a[160:163], v12 offset:24576
  ds_read_b128 a[164:167], v13 offset:24576
  v_mfma_f32_16x16x32_bf16 v[184:187], a[188:191], v[120:123], v[184:187]
  v_exp_f32 v84, v84
  v_mfma_f32_16x16x32_bf16 v[168:171], a[184:187], v[120:123], v[168:171]
  v_mfma_f32_16x16x32_bf16 v[172:175], a[184:187], v[124:127], v[172:175]
  v_exp_f32 v85, v85
  v_mfma_f32_16x16x32_bf16 v[156:159], a[180:183], v[124:127], v[156:159]
  v_cvt_pk_bf16_f32 v106, v84, v85
  v_mfma_f32_16x16x32_bf16 v[152:155], a[180:183], v[120:123], v[152:155]
  v_exp_f32 v86, v86
  v_mfma_f32_16x16x32_bf16 v[136:139], a[176:179], v[120:123], v[136:139]
  ds_read_b128 a[168:171], v14 offset:24576
  ds_read_b128 a[172:175], v15 offset:24576
  v_mfma_f32_16x16x32_bf16 v[140:143], a[176:179], v[124:127], v[140:143]
  v_exp_f32 v87, v87
  v_mfma_f32_16x16x32_bf16 a[136:139], a[208:211], v[120:123], a[136:139]
  v_cvt_pk_bf16_f32 v107, v86, v87
  v_mfma_f32_16x16x32_bf16 a[140:143], a[208:211], v[124:127], a[140:143]
  s_waitcnt lgkmcnt(4)
  v_mfma_f32_16x16x32_bf16 v[64:67], a[144:147], a[0:3], v[48:51]
  v_exp_f32 v88, v88
  v_mfma_f32_16x16x32_bf16 v[64:67], a[148:151], a[16:19], v[64:67]
  ds_read_b64_tr_b16 a[176:177], v4 offset:16384
  ds_read_b64_tr_b16 a[178:179], v4 offset:24576
  v_mfma_f32_16x16x32_bf16 v[64:67], a[152:155], a[32:35], v[64:67]
  v_exp_f32 v89, v89
  v_mfma_f32_16x16x32_bf16 v[64:67], a[156:159], a[48:51], v[64:67]
  s_waitcnt lgkmcnt(2)
  ds_read_b64_tr_b16 a[180:181], v5 offset:16384
  ds_read_b64_tr_b16 a[182:183], v5 offset:24576
  v_mfma_f32_16x16x32_bf16 v[68:71], a[172:175], a[48:51], v[48:51]
  v_exp_f32 v90, v90
  v_mfma_f32_16x16x32_bf16 v[68:71], a[168:171], a[32:35], v[68:71]
  v_cvt_pk_bf16_f32 v108, v88, v89
  v_mfma_f32_16x16x32_bf16 v[68:71], a[164:167], a[16:19], v[68:71]
  v_exp_f32 v91, v91
  v_mfma_f32_16x16x32_bf16 v[68:71], a[160:163], a[0:3], v[68:71]
  v_cvt_pk_bf16_f32 v109, v90, v91
  v_mfma_f32_16x16x32_bf16 v[72:75], a[144:147], a[4:7], v[52:55]
  v_exp_f32 v92, v92
  v_mfma_f32_16x16x32_bf16 v[72:75], a[148:151], a[20:23], v[72:75]
  ds_read_b64_tr_b16 a[184:185], v6 offset:16384
  ds_read_b64_tr_b16 a[186:187], v6 offset:24576
  v_mfma_f32_16x16x32_bf16 v[72:75], a[152:155], a[36:39], v[72:75]
  v_exp_f32 v93, v93
  v_mfma_f32_16x16x32_bf16 v[72:75], a[156:159], a[52:55], v[72:75]
  ds_read_b64_tr_b16 a[188:189], v7 offset:16384
  ds_read_b64_tr_b16 a[190:191], v7 offset:24576
  v_mfma_f32_16x16x32_bf16 v[76:79], a[172:175], a[52:55], v[52:55]
  v_exp_f32 v94, v94
  v_mfma_f32_16x16x32_bf16 v[76:79], a[168:171], a[36:39], v[76:79]
  v_cvt_pk_bf16_f32 v110, v92, v93
  v_mfma_f32_16x16x32_bf16 v[76:79], a[164:167], a[20:23], v[76:79]
  v_exp_f32 v95, v95
  v_mfma_f32_16x16x32_bf16 v[76:79], a[160:163], a[4:7], v[76:79]
  v_cvt_pk_bf16_f32 v111, v94, v95
  v_mfma_f32_16x16x32_bf16 v[80:83], a[144:147], a[8:11], v[56:59]
  v_exp_f32 v64, v64
  v_mfma_f32_16x16x32_bf16 v[80:83], a[148:151], a[24:27], v[80:83]
  ds_read_b64_tr_b16 a[192:193], v8 offset:16384
  ds_read_b64_tr_b16 a[194:195], v8 offset:24576
  v_mfma_f32_16x16x32_bf16 v[80:83], a[152:155], a[40:43], v[80:83]
  v_exp_f32 v65, v65
  v_mfma_f32_16x16x32_bf16 v[80:83], a[156:159], a[56:59], v[80:83]
  ds_read_b64_tr_b16 a[196:197], v9 offset:16384
  ds_read_b64_tr_b16 a[198:199], v9 offset:24576
  v_mfma_f32_16x16x32_bf16 v[84:87], a[172:175], a[56:59], v[56:59]
  v_exp_f32 v66, v66
  v_mfma_f32_16x16x32_bf16 v[84:87], a[168:171], a[40:43], v[84:87]
  v_cvt_pk_bf16_f32 v112, v64, v65
  v_mfma_f32_16x16x32_bf16 v[84:87], a[164:167], a[24:27], v[84:87]
  v_exp_f32 v67, v67
  v_mfma_f32_16x16x32_bf16 v[84:87], a[160:163], a[8:11], v[84:87]
  v_cvt_pk_bf16_f32 v113, v66, v67
  v_mfma_f32_16x16x32_bf16 v[88:91], a[144:147], a[12:15], v[60:63]
  v_exp_f32 v68, v68
  v_mfma_f32_16x16x32_bf16 v[88:91], a[148:151], a[28:31], v[88:91]
  ds_read_b64_tr_b16 a[200:201], v10 offset:16384
  ds_read_b64_tr_b16 a[202:203], v10 offset:24576
  v_mfma_f32_16x16x32_bf16 v[88:91], a[152:155], a[44:47], v[88:91]
  v_exp_f32 v69, v69
  v_mfma_f32_16x16x32_bf16 v[88:91], a[156:159], a[60:63], v[88:91]
  ds_read_b64_tr_b16 a[204:205], v11 offset:16384
  ds_read_b64_tr_b16 a[206:207], v11 offset:24576
  v_mfma_f32_16x16x32_bf16 v[92:95], a[172:175], a[60:63], v[60:63]
  v_exp_f32 v70, v70
  v_mfma_f32_16x16x32_bf16 v[92:95], a[168:171], a[44:47], v[92:95]
  v_cvt_pk_bf16_f32 v114, v68, v69
  v_mfma_f32_16x16x32_bf16 v[92:95], a[164:167], a[28:31], v[92:95]
  v_exp_f32 v71, v71
  v_mfma_f32_16x16x32_bf16 v[92:95], a[160:163], a[12:15], v[92:95]
  v_cvt_pk_bf16_f32 v115, v70, v71
  s_waitcnt lgkmcnt(8)
  v_mfma_f32_16x16x32_bf16 v[128:131], a[176:179], v[96:99], v[128:131]
  v_exp_f32 v72, v72
  v_mfma_f32_16x16x32_bf16 v[132:135], a[176:179], v[100:103], v[132:135]
  v_mfma_f32_16x16x32_bf16 v[148:151], a[180:183], v[100:103], v[148:151]
  v_exp_f32 v73, v73
  v_mfma_f32_16x16x32_bf16 v[144:147], a[180:183], v[96:99], v[144:147]
  s_waitcnt lgkmcnt(0)
  v_cvt_pk_bf16_f32 v116, v72, v73
  v_mfma_f32_16x16x32_bf16 v[160:163], a[184:187], v[96:99], v[160:163]
  v_exp_f32 v74, v74
  v_mfma_f32_16x16x32_bf16 v[164:167], a[184:187], v[100:103], v[164:167]
  s_waitcnt vmcnt(19)
  s_barrier
  v_mfma_f32_16x16x32_bf16 v[180:183], a[188:191], v[100:103], v[180:183]
  v_exp_f32 v75, v75
  v_mfma_f32_16x16x32_bf16 v[176:179], a[188:191], v[96:99], v[176:179]
  v_cvt_pk_bf16_f32 v117, v74, v75
  v_mfma_f32_16x16x32_bf16 v[192:195], a[192:195], v[96:99], v[192:195]
  s_add_u32 m0, s61, 32768
  s_nop 0
  buffer_load_dwordx4 v20, s[36:39], s60 offen offset:0  lds
  v_mfma_f32_16x16x32_bf16 v[196:199], a[192:195], v[100:103], v[196:199]
  v_exp_f32 v76, v76
  v_mfma_f32_16x16x32_bf16 v[212:215], a[196:199], v[100:103], v[212:215]
  buffer_load_dwordx4 v21, s[36:39], s60 offen offset:1024  lds
  buffer_load_dwordx4 v22, s[36:39], s60 offen offset:2048  lds
  v_mfma_f32_16x16x32_bf16 v[208:211], a[196:199], v[96:99], v[208:211]
  v_exp_f32 v77, v77
  v_mfma_f32_16x16x32_bf16 v[224:227], a[200:203], v[96:99], v[224:227]
  v_cvt_pk_bf16_f32 v118, v76, v77
  v_mfma_f32_16x16x32_bf16 v[228:231], a[200:203], v[100:103], v[228:231]
  v_exp_f32 v78, v78
  v_mfma_f32_16x16x32_bf16 v[244:247], a[204:207], v[100:103], v[244:247]
  buffer_load_dwordx4 v23, s[36:39], s60 offen offset:3072  lds
  s_add_u32 s60, s60, 114688
  v_mfma_f32_16x16x32_bf16 v[240:243], a[204:207], v[96:99], v[240:243]
  v_exp_f32 v79, v79
  v_mfma_f32_16x16x32_bf16 a[128:131], a[208:211], v[96:99], a[128:131]
  v_cvt_pk_bf16_f32 v119, v78, v79
  v_mfma_f32_16x16x32_bf16 a[132:135], a[208:211], v[100:103], a[132:135]
  s_add_u32 m0, s61, 36864
  s_nop 0
  buffer_load_dwordx4 v20, s[36:39], s60 offen offset:0  lds
  v_mfma_f32_16x16x32_bf16 v[252:255], a[204:207], v[108:111], v[252:255]
  v_exp_f32 v80, v80
  v_mfma_f32_16x16x32_bf16 v[248:251], a[204:207], v[104:107], v[248:251]
  buffer_load_dwordx4 v21, s[36:39], s60 offen offset:1024  lds
  buffer_load_dwordx4 v22, s[36:39], s60 offen offset:2048  lds
  v_mfma_f32_16x16x32_bf16 v[232:235], a[200:203], v[104:107], v[232:235]
  v_exp_f32 v81, v81
  v_mfma_f32_16x16x32_bf16 v[236:239], a[200:203], v[108:111], v[236:239]
  v_cvt_pk_bf16_f32 v120, v80, v81
  v_mfma_f32_16x16x32_bf16 v[220:223], a[196:199], v[108:111], v[220:223]
  v_exp_f32 v82, v82
  v_mfma_f32_16x16x32_bf16 v[216:219], a[196:199], v[104:107], v[216:219]
  buffer_load_dwordx4 v23, s[36:39], s60 offen offset:3072  lds
  s_add_u32 s60, s60, 114688
  v_mfma_f32_16x16x32_bf16 v[200:203], a[192:195], v[104:107], v[200:203]
  v_exp_f32 v83, v83
  v_mfma_f32_16x16x32_bf16 v[204:207], a[192:195], v[108:111], v[204:207]
  v_cvt_pk_bf16_f32 v121, v82, v83
  v_mfma_f32_16x16x32_bf16 v[188:191], a[188:191], v[108:111], v[188:191]
  v_mfma_f32_16x16x32_bf16 v[184:187], a[188:191], v[104:107], v[184:187]
  v_exp_f32 v84, v84
  v_mfma_f32_16x16x32_bf16 v[168:171], a[184:187], v[104:107], v[168:171]
  v_mfma_f32_16x16x32_bf16 v[172:175], a[184:187], v[108:111], v[172:175]
  v_exp_f32 v85, v85
  v_mfma_f32_16x16x32_bf16 v[156:159], a[180:183], v[108:111], v[156:159]
  v_cvt_pk_bf16_f32 v122, v84, v85
  v_mfma_f32_16x16x32_bf16 v[152:155], a[180:183], v[104:107], v[152:155]
  v_exp_f32 v86, v86
  v_mfma_f32_16x16x32_bf16 v[136:139], a[176:179], v[104:107], v[136:139]
  v_mfma_f32_16x16x32_bf16 v[140:143], a[176:179], v[108:111], v[140:143]
  v_exp_f32 v87, v87
  v_mfma_f32_16x16x32_bf16 a[136:139], a[208:211], v[104:107], a[136:139]
  v_cvt_pk_bf16_f32 v123, v86, v87
  v_mfma_f32_16x16x32_bf16 a[140:143], a[208:211], v[108:111], a[140:143]
  s_waitcnt vmcnt(23)
  v_mfma_f32_16x16x32_bf16 v[48:51], a[208:211], a[64:67], 0
  v_exp_f32 v88, v88
  v_mfma_f32_16x16x32_bf16 v[52:55], a[64:67], a[64:67], 0
  ds_read_b64_tr_b16 a[176:177], v4 offset:32768
  ds_read_b64_tr_b16 a[178:179], v4 offset:40960
  v_mfma_f32_16x16x32_bf16 v[48:51], a[208:211], a[68:71], v[48:51]
  v_exp_f32 v89, v89
  v_mfma_f32_16x16x32_bf16 v[52:55], a[68:71], a[68:71], v[52:55]
  ds_read_b64_tr_b16 a[180:181], v5 offset:32768
  ds_read_b64_tr_b16 a[182:183], v5 offset:40960
  v_mfma_f32_16x16x32_bf16 v[48:51], a[208:211], a[72:75], v[48:51]
  v_exp_f32 v90, v90
  v_mfma_f32_16x16x32_bf16 v[52:55], a[72:75], a[72:75], v[52:55]
  v_cvt_pk_bf16_f32 v124, v88, v89
  v_mfma_f32_16x16x32_bf16 v[48:51], a[208:211], a[76:79], v[48:51]
  v_exp_f32 v91, v91
  v_mfma_f32_16x16x32_bf16 v[52:55], a[76:79], a[76:79], v[52:55]
  s_waitcnt vmcnt(19)
  v_cvt_pk_bf16_f32 v125, v90, v91
  v_mfma_f32_16x16x32_bf16 v[48:51], a[208:211], a[80:83], v[48:51]
  v_exp_f32 v92, v92
  v_mfma_f32_16x16x32_bf16 v[52:55], a[80:83], a[80:83], v[52:55]
  ds_read_b64_tr_b16 a[184:185], v6 offset:32768
  ds_read_b64_tr_b16 a[186:187], v6 offset:40960
  v_mfma_f32_16x16x32_bf16 v[48:51], a[208:211], a[84:87], v[48:51]
  v_exp_f32 v93, v93
  v_mfma_f32_16x16x32_bf16 v[52:55], a[84:87], a[84:87], v[52:55]
  ds_read_b64_tr_b16 a[188:189], v7 offset:32768
  ds_read_b64_tr_b16 a[190:191], v7 offset:40960
  v_mfma_f32_16x16x32_bf16 v[48:51], a[208:211], a[88:91], v[48:51]
  v_exp_f32 v94, v94
  v_mfma_f32_16x16x32_bf16 v[52:55], a[88:91], a[88:91], v[52:55]
  v_cvt_pk_bf16_f32 v126, v92, v93
  v_mfma_f32_16x16x32_bf16 v[48:51], a[208:211], a[92:95], v[48:51]
  v_exp_f32 v95, v95
  v_mfma_f32_16x16x32_bf16 v[52:55], a[92:95], a[92:95], v[52:55]
  s_waitcnt vmcnt(15)
  v_cvt_pk_bf16_f32 v127, v94, v95
  v_mfma_f32_16x16x32_bf16 v[48:51], a[208:211], a[96:99], v[48:51]
  v_mfma_f32_16x16x32_bf16 v[52:55], a[96:99], a[96:99], v[52:55]
  ds_read_b64_tr_b16 a[192:193], v8 offset:32768
  ds_read_b64_tr_b16 a[194:195], v8 offset:40960
  v_mfma_f32_16x16x32_bf16 v[48:51], a[208:211], a[100:103], v[48:51]
  v_mfma_f32_16x16x32_bf16 v[52:55], a[100:103], a[100:103], v[52:55]
  ds_read_b64_tr_b16 a[196:197], v9 offset:32768
  ds_read_b64_tr_b16 a[198:199], v9 offset:40960
  v_mfma_f32_16x16x32_bf16 v[48:51], a[208:211], a[104:107], v[48:51]
  v_mfma_f32_16x16x32_bf16 v[52:55], a[104:107], a[104:107], v[52:55]
  v_mfma_f32_16x16x32_bf16 v[48:51], a[208:211], a[108:111], v[48:51]
  v_mfma_f32_16x16x32_bf16 v[52:55], a[108:111], a[108:111], v[52:55]
  s_waitcnt vmcnt(10)
  v_mfma_f32_16x16x32_bf16 v[48:51], a[208:211], a[112:115], v[48:51]
  v_mfma_f32_16x16x32_bf16 v[52:55], a[112:115], a[112:115], v[52:55]
  ds_read_b64_tr_b16 a[200:201], v10 offset:32768
  ds_read_b64_tr_b16 a[202:203], v10 offset:40960
  v_mfma_f32_16x16x32_bf16 v[48:51], a[208:211], a[116:119], v[48:51]
  v_mfma_f32_16x16x32_bf16 v[52:55], a[116:119], a[116:119], v[52:55]
  ds_read_b64_tr_b16 a[204:205], v11 offset:32768
  ds_read_b64_tr_b16 a[206:207], v11 offset:40960
  v_mfma_f32_16x16x32_bf16 v[48:51], a[208:211], a[120:123], v[48:51]
  v_mfma_f32_16x16x32_bf16 v[52:55], a[120:123], a[120:123], v[52:55]
  v_mfma_f32_16x16x32_bf16 v[48:51], a[208:211], a[124:127], v[48:51]
  v_mfma_f32_16x16x32_bf16 v[52:55], a[124:127], a[124:127], v[52:55]
  v_mfma_f32_16x16x32_bf16 a[128:131], a[208:211], v[112:115], a[128:131]
  v_mfma_f32_16x16x32_bf16 a[132:135], a[208:211], v[116:119], a[132:135]
  v_mfma_f32_16x16x32_bf16 a[136:139], a[208:211], v[120:123], a[136:139]
  v_mfma_f32_16x16x32_bf16 a[140:143], a[208:211], v[124:127], a[140:143]
  s_waitcnt lgkmcnt(8)
  v_mfma_f32_16x16x32_bf16 v[128:131], a[176:179], v[112:115], v[128:131]
  v_mfma_f32_16x16x32_bf16 v[144:147], a[180:183], v[112:115], v[144:147]
  v_mfma_f32_16x16x32_bf16 v[160:163], a[184:187], v[112:115], v[160:163]
  v_mfma_f32_16x16x32_bf16 v[176:179], a[188:191], v[112:115], v[176:179]
  s_waitcnt lgkmcnt(0)
  v_mfma_f32_16x16x32_bf16 v[192:195], a[192:195], v[112:115], v[192:195]
  v_accvgpr_read_b32 v60, a128
  v_accvgpr_read_b32 v61, a132
  v_accvgpr_read_b32 v62, a136
  v_mfma_f32_16x16x32_bf16 v[208:211], a[196:199], v[112:115], v[208:211]
  v_accvgpr_read_b32 v63, a140
  v_max3_f32 v30, v60, v61, v62
  v_mfma_f32_16x16x32_bf16 v[224:227], a[200:203], v[112:115], v[224:227]
  s_mov_b32 s56, 1317011456
  v_max_f32 v30, v30, v63
  v_mfma_f32_16x16x32_bf16 v[240:243], a[204:207], v[112:115], v[240:243]
  v_cmp_u_f32 s[58:59], v60, v61
  v_cmp_u_f32 vcc, v62, v63
  v_mfma_f32_16x16x32_bf16 v[244:247], a[204:207], v[116:119], v[244:247]
  s_lshl_b32 s57, s3, 2
  s_or_b64 s[58:59], s[58:59], vcc
  v_mfma_f32_16x16x32_bf16 v[228:231], a[200:203], v[116:119], v[228:231]
  v_cmp_lt_f32 vcc, s56, v30
  s_add_u32 s57, s57, 98048
  v_mfma_f32_16x16x32_bf16 v[212:215], a[196:199], v[116:119], v[212:215]
  s_or_b64 vcc, vcc, s[58:59]
  s_cmp_lg_u64 vcc, 0
  s_cselect_b32 s56, 1, 0
  v_mfma_f32_16x16x32_bf16 v[196:199], a[192:195], v[116:119], v[196:199]
  v_mov_b32 v40, s57
  v_mov_b32 v30, s56
  v_mfma_f32_16x16x32_bf16 v[180:183], a[188:191], v[116:119], v[180:183]
  ds_write_b32 v40, v30
  v_and_b32 v40, 3, v1
  v_mfma_f32_16x16x32_bf16 v[164:167], a[184:187], v[116:119], v[164:167]
  v_lshlrev_b32 v40, 2, v40
  v_add_u32 v40, 98048, v40
  v_mfma_f32_16x16x32_bf16 v[148:151], a[180:183], v[116:119], v[148:151]
  v_rcp_f32 v56, v60
  v_rcp_f32 v57, v61
  v_mfma_f32_16x16x32_bf16 v[132:135], a[176:179], v[116:119], v[132:135]
  v_rcp_f32 v58, v62
  v_rcp_f32 v59, v63
  v_mfma_f32_16x16x32_bf16 v[136:139], a[176:179], v[120:123], v[136:139]
  v_mfma_f32_16x16x32_bf16 v[152:155], a[180:183], v[120:123], v[152:155]
  s_waitcnt lgkmcnt(0)
  s_barrier
  ds_read_b32 v30, v40
  v_mfma_f32_16x16x32_bf16 v[168:171], a[184:187], v[120:123], v[168:171]
  s_add_u32 m0, s61, 65536
  v_mfma_f32_16x16x32_bf16 v[184:187], a[188:191], v[120:123], v[184:187]
  buffer_load_dwordx4 v20, s[36:39], s60 offen offset:0  lds
  v_mfma_f32_16x16x32_bf16 v[200:203], a[192:195], v[120:123], v[200:203]
  buffer_load_dwordx4 v21, s[36:39], s60 offen offset:1024  lds
  v_mfma_f32_16x16x32_bf16 v[216:219], a[196:199], v[120:123], v[216:219]
  buffer_load_dwordx4 v22, s[36:39], s60 offen offset:2048  lds
  v_mfma_f32_16x16x32_bf16 v[232:235], a[200:203], v[120:123], v[232:235]
  buffer_load_dwordx4 v23, s[36:39], s60 offen offset:3072  lds
  v_mfma_f32_16x16x32_bf16 v[248:251], a[204:207], v[120:123], v[248:251]
  s_add_u32 s60, s60, 114688
  v_mfma_f32_16x16x32_bf16 v[252:255], a[204:207], v[124:127], v[252:255]
  s_waitcnt lgkmcnt(0)
  v_cmp_ne_u32 vcc, 0, v30
  s_cmp_eq_u32 s100, 0
  s_cselect_b64 s[58:59], -1, 0
  v_mfma_f32_16x16x32_bf16 v[236:239], a[200:203], v[124:127], v[236:239]
  s_add_u32 m0, s61, 69632
  v_mfma_f32_16x16x32_bf16 v[220:223], a[196:199], v[124:127], v[220:223]
  buffer_load_dwordx4 v20, s[36:39], s60 offen offset:0  lds
  s_and_b64 s[58:59], vcc, s[58:59]
  v_mfma_f32_16x16x32_bf16 v[204:207], a[192:195], v[124:127], v[204:207]
  buffer_load_dwordx4 v21, s[36:39], s60 offen offset:1024  lds
  v_mfma_f32_16x16x32_bf16 v[188:191], a[188:191], v[124:127], v[188:191]
  buffer_load_dwordx4 v22, s[36:39], s60 offen offset:2048  lds
  v_mfma_f32_16x16x32_bf16 v[172:175], a[184:187], v[124:127], v[172:175]
  buffer_load_dwordx4 v23, s[36:39], s60 offen offset:3072  lds
  v_mfma_f32_16x16x32_bf16 v[156:159], a[180:183], v[124:127], v[156:159]
  s_add_u32 s60, s60, 114688
  v_mfma_f32_16x16x32_bf16 v[140:143], a[176:179], v[124:127], v[140:143]
L_attn_end:
  s_cmp_lg_u64 s[58:59], 0
  s_cbranch_scc1 L_slow
  v_pk_mul_f32 v[128:129], v[128:129], v[56:57] op_sel_hi:[1,0]
  s_add_u32 m0, s61, 0
  s_nop 0
  buffer_load_dwordx4 v20, s[36:39], s60 offen offset:0  lds
  v_pk_mul_f32 v[130:131], v[130:131], v[56:57] op_sel_hi:[1,0]
  v_pk_mul_f32 v[144:145], v[144:145], v[56:57] op_sel_hi:[1,0]
  v_pk_mul_f32 v[146:147], v[146:147], v[56:57] op_sel_hi:[1,0]
  v_cvt_pk_bf16_f32 v64, v128, v129
  v_cvt_pk_bf16_f32 v65, v130, v131
  v_cvt_pk_bf16_f32 v66, v144, v145
  v_cvt_pk_bf16_f32 v67, v146, v147
  v_pk_mul_f32 v[132:133], v[132:133], v[56:57] op_sel:[0,1] op_sel_hi:[1,1]
  v_pk_mul_f32 v[134:135], v[134:135], v[56:57] op_sel:[0,1] op_sel_hi:[1,1]
  v_pk_mul_f32 v[148:149], v[148:149], v[56:57] op_sel:[0,1] op_sel_hi:[1,1]
  v_pk_mul_f32 v[150:151], v[150:151], v[56:57] op_sel:[0,1] op_sel_hi:[1,1]
  v_cvt_pk_bf16_f32 v68, v132, v133
  v_cvt_pk_bf16_f32 v69, v134, v135
  v_cvt_pk_bf16_f32 v70, v148, v149
  buffer_load_dwordx4 v21, s[36:39], s60 offen offset:1024  lds
  v_cvt_pk_bf16_f32 v71, v150, v151
  v_pk_mul_f32 v[136:137], v[136:137], v[58:59] op_sel_hi:[1,0]
  v_pk_mul_f32 v[138:139], v[138:139], v[58:59] op_sel_hi:[1,0]
  v_pk_mul_f32 v[152:153], v[152:153], v[58:59] op_sel_hi:[1,0]
  v_pk_mul_f32 v[154:155], v[154:155], v[58:59] op_sel_hi:[1,0]
  v_cvt_pk_bf16_f32 v72, v136, v137
  v_cvt_pk_bf16_f32 v73, v138, v139
  v_cvt_pk_bf16_f32 v74, v152, v153
  v_cvt_pk_bf16_f32 v75, v154, v155
  v_pk_mul_f32 v[140:141], v[140:141], v[58:59] op_sel:[0,1] op_sel_hi:[1,1]
  v_pk_mul_f32 v[142:143], v[142:143], v[58:59] op_sel:[0,1] op_sel_hi:[1,1]
  v_pk_mul_f32 v[156:157], v[156:157], v[58:59] op_sel:[0,1] op_sel_hi:[1,1]
  v_pk_mul_f32 v[158:159], v[158:159], v[58:59] op_sel:[0,1] op_sel_hi:[1,1]
  v_cvt_pk_bf16_f32 v76, v140, v141
  v_cvt_pk_bf16_f32 v77, v142, v143
  buffer_load_dwordx4 v22, s[36:39], s60 offen offset:2048  lds
  v_cvt_pk_bf16_f32 v78, v156, v157
  v_cvt_pk_bf16_f32 v79, v158, v159
  v_pk_mul_f32 v[160:161], v[160:161], v[56:57] op_sel_hi:[1,0]
  v_pk_mul_f32 v[162:163], v[162:163], v[56:57] op_sel_hi:[1,0]
  v_pk_mul_f32 v[176:177], v[176:177], v[56:57] op_sel_hi:[1,0]
  v_pk_mul_f32 v[178:179], v[178:179], v[56:57] op_sel_hi:[1,0]
  v_cvt_pk_bf16_f32 v80, v160, v161
  v_cvt_pk_bf16_f32 v81, v162, v163
  v_cvt_pk_bf16_f32 v82, v176, v177
  v_cvt_pk_bf16_f32 v83, v178, v179
  v_pk_mul_f32 v[164:165], v[164:165], v[56:57] op_sel:[0,1] op_sel_hi:[1,1]
  v_pk_mul_f32 v[166:167], v[166:167], v[56:57] op_sel:[0,1] op_sel_hi:[1,1]
  v_pk_mul_f32 v[180:181], v[180:181], v[56:57] op_sel:[0,1] op_sel_hi:[1,1]
  v_pk_mul_f32 v[182:183], v[182:183], v[56:57] op_sel:[0,1] op_sel_hi:[1,1]
  buffer_load_dwordx4 v23, s[36:39], s60 offen offset:3072  lds
  v_cvt_pk_bf16_f32 v84, v164, v165
  v_cvt_pk_bf16_f32 v85, v166, v167
  v_cvt_pk_bf16_f32 v86, v180, v181
  v_cvt_pk_bf16_f32 v87, v182, v183
  v_pk_mul_f32 v[168:169], v[168:169], v[58:59] op_sel_hi:[1,0]
  v_pk_mul_f32 v[170:171], v[170:171], v[58:59] op_sel_hi:[1,0]
  v_pk_mul_f32 v[184:185], v[184:185], v[58:59] op_sel_hi:[1,0]
  v_pk_mul_f32 v[186:187], v[186:187], v[58:59] op_sel_hi:[1,0]
  v_cvt_pk_bf16_f32 v88, v168, v169
  v_cvt_pk_bf16_f32 v89, v170, v171
  v_cvt_pk_bf16_f32 v90, v184, v185
  v_cvt_pk_bf16_f32 v91, v186, v187
  v_pk_mul_f32 v[172:173], v[172:173], v[58:59] op_sel:[0,1] op_sel_hi:[1,1]
  v_pk_mul_f32 v[174:175], v[174:175], v[58:59] op_sel:[0,1] op_sel_hi:[1,1]
  v_pk_mul_f32 v[188:189], v[188:189], v[58:59] op_sel:[0,1] op_sel_hi:[1,1]
  s_add_u32 s60, s60, 114688
  s_add_u32 m0, s61, 4096
  s_nop 0
  buffer_load_dwordx4 v20, s[36:39], s60 offen offset:0  lds
  v_pk_mul_f32 v[190:191], v[190:191], v[58:59] op_sel:[0,1] op_sel_hi:[1,1]
  v_cvt_pk_bf16_f32 v92, v172, v173
  v_cvt_pk_bf16_f32 v93, v174, v175
  v_cvt_pk_bf16_f32 v94, v188, v189
  v_cvt_pk_bf16_f32 v95, v190, v191
  v_pk_mul_f32 v[192:193], v[192:193], v[56:57] op_sel_hi:[1,0]
  v_pk_mul_f32 v[194:195], v[194:195], v[56:57] op_sel_hi:[1,0]
  v_pk_mul_f32 v[208:209], v[208:209], v[56:57] op_sel_hi:[1,0]
  v_pk_mul_f32 v[210:211], v[210:211], v[56:57] op_sel_hi:[1,0]
  v_cvt_pk_bf16_f32 v96, v192, v193
  v_cvt_pk_bf16_f32 v97, v194, v195
  v_cvt_pk_bf16_f32 v98, v208, v209
  v_cvt_pk_bf16_f32 v99, v210, v211
  v_pk_mul_f32 v[196:197], v[196:197], v[56:57] op_sel:[0,1] op_sel_hi:[1,1]
  buffer_load_dwordx4 v21, s[36:39], s60 offen offset:1024  lds
  v_pk_mul_f32 v[198:199], v[198:199], v[56:57] op_sel:[0,1] op_sel_hi:[1,1]
  v_pk_mul_f32 v[212:213], v[212:213], v[56:57] op_sel:[0,1] op_sel_hi:[1,1]
  v_pk_mul_f32 v[214:215], v[214:215], v[56:57] op_sel:[0,1] op_sel_hi:[1,1]
  v_cvt_pk_bf16_f32 v100, v196, v197
  v_cvt_pk_bf16_f32 v101, v198, v199
  v_cvt_pk_bf16_f32 v102, v212, v213
  v_cvt_pk_bf16_f32 v103, v214, v215
  v_pk_mul_f32 v[200:201], v[200:201], v[58:59] op_sel_hi:[1,0]
  v_pk_mul_f32 v[202:203], v[202:203], v[58:59] op_sel_hi:[1,0]
  v_pk_mul_f32 v[216:217], v[216:217], v[58:59] op_sel_hi:[1,0]
  v_pk_mul_f32 v[218:219], v[218:219], v[58:59] op_sel_hi:[1,0]
  v_cvt_pk_bf16_f32 v104, v200, v201
  v_cvt_pk_bf16_f32 v105, v202, v203
  v_cvt_pk_bf16_f32 v106, v216, v217
  v_cvt_pk_bf16_f32 v107, v218, v219
  buffer_load_dwordx4 v22, s[36:39], s60 offen offset:2048  lds
  v_pk_mul_f32 v[204:205], v[204:205], v[58:59] op_sel:[0,1] op_sel_hi:[1,1]
  v_pk_mul_f32 v[206:207], v[206:207], v[58:59] op_sel:[0,1] op_sel_hi:[1,1]
  v_pk_mul_f32 v[220:221], v[220:221], v[58:59] op_sel:[0,1] op_sel_hi:[1,1]
  v_pk_mul_f32 v[222:223], v[222:223], v[58:59] op_sel:[0,1] op_sel_hi:[1,1]
  v_cvt_pk_bf16_f32 v108, v204, v205
  v_cvt_pk_bf16_f32 v109, v206, v207
  v_cvt_pk_bf16_f32 v110, v220, v221
  v_cvt_pk_bf16_f32 v111, v222, v223
  v_pk_mul_f32 v[224:225], v[224:225], v[56:57] op_sel_hi:[1,0]
  v_pk_mul_f32 v[226:227], v[226:227], v[56:57] op_sel_hi:[1,0]
  v_pk_mul_f32 v[240:241], v[240:241], v[56:57] op_sel_hi:[1,0]
  v_pk_mul_f32 v[242:243], v[242:243], v[56:57] op_sel_hi:[1,0]
  v_cvt_pk_bf16_f32 v112, v224, v225
  v_cvt_pk_bf16_f32 v113, v226, v227
  v_cvt_pk_bf16_f32 v114, v240, v241
  v_cvt_pk_bf16_f32 v115, v242, v243
  v_pk_mul_f32 v[228:229], v[228:229], v[56:57] op_sel:[0,1] op_sel_hi:[1,1]
  v_pk_mul_f32 v[230:231], v[230:231], v[56:57] op_sel:[0,1] op_sel_hi:[1,1]
  v_pk_mul_f32 v[244:245], v[244:245], v[56:57] op_sel:[0,1] op_sel_hi:[1,1]
  v_pk_mul_f32 v[246:247], v[246:247], v[56:57] op_sel:[0,1] op_sel_hi:[1,1]
  v_cvt_pk_bf16_f32 v116, v228, v229
  v_cvt_pk_bf16_f32 v117, v230, v231
  v_cvt_pk_bf16_f32 v118, v244, v245
  v_cvt_pk_bf16_f32 v119, v246, v247
  v_pk_mul_f32 v[232:233], v[232:233], v[58:59] op_sel_hi:[1,0]
  v_pk_mul_f32 v[234:235], v[234:235], v[58:59] op_sel_hi:[1,0]
  v_pk_mul_f32 v[248:249], v[248:249], v[58:59] op_sel_hi:[1,0]
  v_pk_mul_f32 v[250:251], v[250:251], v[58:59] op_sel_hi:[1,0]
  v_cvt_pk_bf16_f32 v120, v232, v233
  v_cvt_pk_bf16_f32 v121, v234, v235
  v_cvt_pk_bf16_f32 v122, v248, v249
  v_cvt_pk_bf16_f32 v123, v250, v251
  v_pk_mul_f32 v[236:237], v[236:237], v[58:59] op_sel:[0,1] op_sel_hi:[1,1]
  v_pk_mul_f32 v[238:239], v[238:239], v[58:59] op_sel:[0,1] op_sel_hi:[1,1]
  v_pk_mul_f32 v[252:253], v[252:253], v[58:59] op_sel:[0,1] op_sel_hi:[1,1]
  v_pk_mul_f32 v[254:255], v[254:255], v[58:59] op_sel:[0,1] op_sel_hi:[1,1]
  v_cvt_pk_bf16_f32 v124, v236, v237
  v_cvt_pk_bf16_f32 v125, v238, v239
  v_cvt_pk_bf16_f32 v126, v252, v253
  v_cvt_pk_bf16_f32 v127, v254, v255
  v_add_u32 v3, s75, v2
  v_lshrrev_b32 v30, 4, v1
  v_bfe_u32 v31, v1, 2, 2
  v_lshl_add_u32 v40, v30, 2, v31
  v_lshlrev_b32 v4, 7, v40
  v_bfe_u32 v40, v40, 1, 2
  v_lshl_add_u32 v4, v40, 5, v4
  v_and_b32 v31, 3, v1
  v_lshl_add_u32 v4, v31, 3, v4
  v_add_u32 v4, s61, v4
  v_xor_b32 v5, 32, v4
  v_xor_b32 v6, 64, v4
  v_xor_b32 v7, 96, v4
  v_add_u32 v12, 0x10000, v4
  v_add_u32 v13, 0x10000, v5
  v_add_u32 v14, 0x10000, v6
  v_add_u32 v15, 0x10000, v7
  v_and_b32 v30, 3, v1
  v_cmp_eq_u32 s[56:57], 1, v30
  v_cmp_eq_u32 s[58:59], 2, v30
  v_cmp_eq_u32 vcc, 3, v30
  v_lshrrev_b32 v30, 4, v1
  v_bfe_u32 v31, v1, 2, 2
  v_mul_f32 v56, 3137339392, v48
  v_mul_f32 v57, 3137339392, v49
  v_mul_f32 v58, 3137339392, v50
  v_mul_f32 v59, 3137339392, v51
  s_nop 1
  v_mfma_f32_16x16x32_bf16 v[128:131], a[214:217], a[64:67], v[56:59]
  v_cndmask_b32 v52, v52, v53, s[56:57]
  v_mfma_f32_16x16x32_bf16 v[132:135], a[212:215], a[64:67], v[56:59]
  v_cndmask_b32 v52, v52, v54, s[58:59]
  v_mfma_f32_16x16x32_bf16 v[136:139], a[214:217], a[68:71], v[56:59]
  v_cndmask_b32 v52, v52, v55, vcc
  v_mfma_f32_16x16x32_bf16 v[140:143], a[212:215], a[68:71], v[56:59]
  v_mfma_f32_16x16x32_bf16 v[144:147], a[214:217], a[72:75], v[56:59]
  s_nop 0
  v_cvt_pk_bf16_f32 v160, v128, v129
  v_cvt_pk_bf16_f32 v161, v130, v131
  v_cmp_eq_u32 vcc, v30, v31
  v_mfma_f32_16x16x32_bf16 v[148:151], a[212:215], a[72:75], v[56:59]
  v_cvt_pk_bf16_f32 v162, v132, v133
  v_cvt_pk_bf16_f32 v163, v134, v135
  ds_write_b128 v3, v[160:163] offset:0
  v_mul_f32 v49, v56, v56
  v_mfma_f32_16x16x32_bf16 v[152:155], a[214:217], a[76:79], v[56:59]
  v_cvt_pk_bf16_f32 v164, v136, v137
  v_cvt_pk_bf16_f32 v165, v138, v139
  v_and_b32 v30, 15, v1
  v_mfma_f32_16x16x32_bf16 v[156:159], a[212:215], a[76:79], v[56:59]
  v_cvt_pk_bf16_f32 v166, v140, v141
  v_cvt_pk_bf16_f32 v167, v142, v143
  ds_write_b128 v3, v[164:167] offset:1024
  v_mfma_f32_16x16x32_bf16 v[128:131], a[214:217], a[80:83], v[56:59]
  v_cvt_pk_bf16_f32 v168, v144, v145
  v_cvt_pk_bf16_f32 v169, v146, v147
  v_cndmask_b32 v52, 0, v52, vcc
  v_mfma_f32_16x16x32_bf16 v[132:135], a[212:215], a[80:83], v[56:59]
  v_cvt_pk_bf16_f32 v170, v148, v149
  v_cvt_pk_bf16_f32 v171, v150, v151
  ds_write_b128 v3, v[168:171] offset:2048
  v_mov_b32 v53, v52
  v_mfma_f32_16x16x32_bf16 v[136:139], a[214:217], a[84:87], v[56:59]
  v_cvt_pk_bf16_f32 v172, v152, v153
  v_cvt_pk_bf16_f32 v173, v154, v155
  v_permlane32_swap_b32 v52, v53
  v_mfma_f32_16x16x32_bf16 v[140:143], a[212:215], a[84:87], v[56:59]
  v_cvt_pk_bf16_f32 v174, v156, v157
  v_cvt_pk_bf16_f32 v175, v158, v159
  ds_write_b128 v3, v[172:175] offset:3072
  v_mfma_f32_16x16x32_bf16 v[144:147], a[214:217], a[88:91], v[56:59]
  v_cvt_pk_bf16_f32 v160, v128, v129
  v_cvt_pk_bf16_f32 v161, v130, v131
  v_add_f32 v52, v52, v53
  v_mfma_f32_16x16x32_bf16 v[148:151], a[212:215], a[88:91], v[56:59]
  v_cvt_pk_bf16_f32 v162, v132, v133
  v_cvt_pk_bf16_f32 v163, v134, v135
  ds_write_b128 v3, v[160:163] offset:4096
  v_mov_b32 v53, v52
  v_mfma_f32_16x16x32_bf16 v[152:155], a[214:217], a[92:95], v[56:59]
  v_cvt_pk_bf16_f32 v164, v136, v137
  v_cvt_pk_bf16_f32 v165, v138, v139
  v_permlane16_swap_b32 v52, v53
  v_mfma_f32_16x16x32_bf16 v[156:159], a[212:215], a[92:95], v[56:59]
  v_cvt_pk_bf16_f32 v166, v140, v141
  v_cvt_pk_bf16_f32 v167, v142, v143
  ds_write_b128 v3, v[164:167] offset:5120
  v_mfma_f32_16x16x32_bf16 v[128:131], a[214:217], a[96:99], v[56:59]
  v_cvt_pk_bf16_f32 v168, v144, v145
  v_cvt_pk_bf16_f32 v169, v146, v147
  v_add_f32 v52, v52, v53
  v_mfma_f32_16x16x32_bf16 v[132:135], a[212:215], a[96:99], v[56:59]
  v_cvt_pk_bf16_f32 v170, v148, v149
  v_cvt_pk_bf16_f32 v171, v150, v151
  ds_write_b128 v3, v[168:171] offset:6144
  v_fma_f32 v52, v52, s67, -v49
  v_mfma_f32_16x16x32_bf16 v[136:139], a[214:217], a[100:103], v[56:59]
  v_cvt_pk_bf16_f32 v172, v152, v153
  v_cvt_pk_bf16_f32 v173, v154, v155
  v_max_f32 v52, 0, v52
  v_mfma_f32_16x16x32_bf16 v[140:143], a[212:215], a[100:103], v[56:59]
  v_cvt_pk_bf16_f32 v174, v156, v157
  v_cvt_pk_bf16_f32 v175, v158, v159
  ds_write_b128 v3, v[172:175] offset:7168
  v_mfma_f32_16x16x32_bf16 v[144:147], a[214:217], a[104:107], v[56:59]
  v_cvt_pk_bf16_f32 v160, v128, v129
  v_cvt_pk_bf16_f32 v161, v130, v131
  v_add_f32 v53, 925353388, v52
  v_mfma_f32_16x16x32_bf16 v[148:151], a[212:215], a[104:107], v[56:59]
  v_cvt_pk_bf16_f32 v162, v132, v133
  v_cvt_pk_bf16_f32 v163, v134, v135
  ds_write_b128 v3, v[160:163] offset:8192
  v_rsq_f32 v48, v53
  v_mfma_f32_16x16x32_bf16 v[152:155], a[214:217], a[108:111], v[56:59]
  v_cvt_pk_bf16_f32 v164, v136, v137
  v_cvt_pk_bf16_f32 v165, v138, v139
  s_lshl_b32 s56, s3, 6
  v_mfma_f32_16x16x32_bf16 v[156:159], a[212:215], a[108:111], v[56:59]
  v_cvt_pk_bf16_f32 v166, v140, v141
  v_cvt_pk_bf16_f32 v167, v142, v143
  ds_write_b128 v3, v[164:167] offset:9216
  v_mfma_f32_16x16x32_bf16 v[128:131], a[214:217], a[112:115], v[56:59]
  v_cvt_pk_bf16_f32 v168, v144, v145
  v_cvt_pk_bf16_f32 v169, v146, v147
  s_add_u32 s56, s56, 97280
  v_mfma_f32_16x16x32_bf16 v[132:135], a[212:215], a[112:115], v[56:59]
  v_cvt_pk_bf16_f32 v170, v148, v149
  v_cvt_pk_bf16_f32 v171, v150, v151
  ds_write_b128 v3, v[168:171] offset:10240
  v_lshl_add_u32 v30, v30, 2, s56
  v_mfma_f32_16x16x32_bf16 v[136:139], a[214:217], a[116:119], v[56:59]
  v_cvt_pk_bf16_f32 v172, v152, v153
  v_cvt_pk_bf16_f32 v173, v154, v155
  ds_write_b32 v30, v48
  v_mfma_f32_16x16x32_bf16 v[140:143], a[212:215], a[116:119], v[56:59]
  v_cvt_pk_bf16_f32 v174, v156, v157
  v_cvt_pk_bf16_f32 v175, v158, v159
  ds_write_b128 v3, v[172:175] offset:11264
  v_mfma_f32_16x16x32_bf16 v[144:147], a[214:217], a[120:123], v[56:59]
  v_cvt_pk_bf16_f32 v160, v128, v129
  v_cvt_pk_bf16_f32 v161, v130, v131
  v_mfma_f32_16x16x32_bf16 v[148:151], a[212:215], a[120:123], v[56:59]
  v_cvt_pk_bf16_f32 v162, v132, v133
  v_cvt_pk_bf16_f32 v163, v134, v135
  ds_write_b128 v3, v[160:163] offset:12288
  v_mfma_f32_16x16x32_bf16 v[152:155], a[214:217], a[124:127], v[56:59]
  v_cvt_pk_bf16_f32 v164, v136, v137
  v_cvt_pk_bf16_f32 v165, v138, v139
  v_mfma_f32_16x16x32_bf16 v[156:159], a[212:215], a[124:127], v[56:59]
  v_cvt_pk_bf16_f32 v166, v140, v141
  v_cvt_pk_bf16_f32 v167, v142, v143
  ds_write_b128 v3, v[164:167] offset:13312
  v_cvt_pk_bf16_f32 v168, v144, v145
  v_cvt_pk_bf16_f32 v169, v146, v147
  v_cvt_pk_bf16_f32 v170, v148, v149
  v_cvt_pk_bf16_f32 v171, v150, v151
  ds_write_b128 v3, v[168:171] offset:14336
  v_cvt_pk_bf16_f32 v172, v152, v153
  v_cvt_pk_bf16_f32 v173, v154, v155
  v_cvt_pk_bf16_f32 v174, v156, v157
  v_cvt_pk_bf16_f32 v175, v158, v159
  ds_write_b128 v3, v[172:175] offset:15360
  s_waitcnt vmcnt(15)
  ds_read_b64_tr_b16 a[0:1], v4 offset:32768
  ds_read_b64_tr_b16 a[2:3], v4 offset:34816
  ds_read_b64_tr_b16 a[4:5], v5 offset:32768
  ds_read_b64_tr_b16 a[6:7], v5 offset:34816
  ds_read_b64_tr_b16 a[8:9], v6 offset:32768
  ds_read_b64_tr_b16 a[10:11], v6 offset:34816
  ds_read_b64_tr_b16 a[12:13], v7 offset:32768
  ds_read_b64_tr_b16 a[14:15], v7 offset:34816
  ds_read_b64_tr_b16 a[16:17], v4 offset:36864
  ds_read_b64_tr_b16 a[18:19], v4 offset:38912
  ds_read_b64_tr_b16 a[20:21], v5 offset:36864
  ds_read_b64_tr_b16 a[22:23], v5 offset:38912
  ds_read_b64_tr_b16 a[24:25], v6 offset:36864
  ds_read_b64_tr_b16 a[26:27], v6 offset:38912
  ds_read_b64_tr_b16 a[28:29], v7 offset:36864
  ds_read_b64_tr_b16 a[30:31], v7 offset:38912
  v_and_b32 v30, 15, v1
  v_lshlrev_b32 v30, 2, v30
  v_add_u32 v30, 97280, v30
  s_waitcnt lgkmcnt(0)
  s_barrier
  ds_read_b128 a[64:67], v2 offset:0
  ds_read_b128 a[68:71], v2 offset:16384
  ds_read_b128 a[72:75], v2 offset:32768
  ds_read_b128 a[76:79], v2 offset:49152
  ds_read_b128 a[80:83], v2 offset:1024
  ds_read_b128 a[84:87], v2 offset:17408
  ds_read_b128 a[88:91], v2 offset:33792
  ds_read_b128 a[92:95], v2 offset:50176
  ds_read_b32 v51, v30 offset:0
  ds_read_b32 v55, v30 offset:64
  ds_read_b32 v59, v30 offset:128
  ds_read_b32 v63, v30 offset:192
  s_waitcnt lgkmcnt(8)
  v_mfma_f32_16x16x32_bf16 v[128:131], a[0:3], a[64:67], 0
  v_mfma_f32_16x16x32_bf16 v[144:147], a[4:7], a[64:67], 0
  s_waitcnt lgkmcnt(0)
  s_barrier
  buffer_load_dwordx4 v23, s[36:39], s60 offen offset:3072  lds
  s_add_u32 s60, s60, 114688
  v_mfma_f32_16x16x32_bf16 v[148:151], a[4:7], a[68:71], 0
  s_add_u32 m0, s61, 32768
  v_mfma_f32_16x16x32_bf16 v[132:135], a[0:3], a[68:71], 0
  buffer_load_dwordx4 v20, s[36:39], s60 offen offset:0  lds
  v_mfma_f32_16x16x32_bf16 v[136:139], a[0:3], a[72:75], 0
  v_mfma_f32_16x16x32_bf16 v[152:155], a[4:7], a[72:75], 0
  v_mfma_f32_16x16x32_bf16 v[156:159], a[4:7], a[76:79], 0
  buffer_load_dwordx4 v21, s[36:39], s60 offen offset:1024  lds
  v_mfma_f32_16x16x32_bf16 v[140:143], a[0:3], a[76:79], 0
  s_waitcnt vmcnt(10)
  v_mfma_f32_16x16x32_bf16 v[168:171], a[8:11], a[72:75], 0
  ds_read_b128 a[96:99], v2 offset:2048
  ds_read_b128 a[100:103], v2 offset:18432
  v_mfma_f32_16x16x32_bf16 v[184:187], a[12:15], a[72:75], 0
  ds_read_b64_tr_b16 a[32:33], v12 offset:0
  ds_read_b64_tr_b16 a[34:35], v12 offset:2048
  v_mfma_f32_16x16x32_bf16 v[188:191], a[12:15], a[76:79], 0
  buffer_load_dwordx4 v22, s[36:39], s60 offen offset:2048  lds
  v_mfma_f32_16x16x32_bf16 v[172:175], a[8:11], a[76:79], 0
  ds_read_b128 a[104:107], v2 offset:34816
  ds_read_b128 a[108:111], v2 offset:51200
  v_mfma_f32_16x16x32_bf16 v[160:163], a[8:11], a[64:67], 0
  ds_read_b64_tr_b16 a[36:37], v13 offset:0
  ds_read_b64_tr_b16 a[38:39], v13 offset:2048
  v_mfma_f32_16x16x32_bf16 v[176:179], a[12:15], a[64:67], 0
  ds_read_b64_tr_b16 a[40:41], v14 offset:0
  ds_read_b64_tr_b16 a[42:43], v14 offset:2048
  v_mfma_f32_16x16x32_bf16 v[180:183], a[12:15], a[68:71], 0
  buffer_load_dwordx4 v23, s[36:39], s60 offen offset:3072  lds
  v_mfma_f32_16x16x32_bf16 v[164:167], a[8:11], a[68:71], 0
  ds_read_b64_tr_b16 a[44:45], v15 offset:0
  ds_read_b64_tr_b16 a[46:47], v15 offset:2048
  v_mfma_f32_16x16x32_bf16 v[128:131], a[16:19], a[80:83], v[128:131]
  s_add_u32 s60, s60, 114688
  v_mfma_f32_16x16x32_bf16 v[144:147], a[20:23], a[80:83], v[144:147]
  s_add_u32 m0, s61, 36864
  v_mfma_f32_16x16x32_bf16 v[148:151], a[20:23], a[84:87], v[148:151]
  buffer_load_dwordx4 v20, s[36:39], s60 offen offset:0  lds
  v_mfma_f32_16x16x32_bf16 v[132:135], a[16:19], a[84:87], v[132:135]
  ds_read_b128 a[112:115], v2 offset:3072
  ds_read_b128 a[116:119], v2 offset:19456
  v_mfma_f32_16x16x32_bf16 v[136:139], a[16:19], a[88:91], v[136:139]
  ds_read_b64_tr_b16 a[48:49], v12 offset:4096
  ds_read_b64_tr_b16 a[50:51], v12 offset:6144
  v_mfma_f32_16x16x32_bf16 v[152:155], a[20:23], a[88:91], v[152:155]
  ds_read_b128 a[120:123], v2 offset:35840
  ds_read_b128 a[124:127], v2 offset:52224
  v_mfma_f32_16x16x32_bf16 v[156:159], a[20:23], a[92:95], v[156:159]
  buffer_load_dwordx4 v21, s[36:39], s60 offen offset:1024  lds
  v_mfma_f32_16x16x32_bf16 v[140:143], a[16:19], a[92:95], v[140:143]
  ds_read_b64_tr_b16 a[52:53], v13 offset:4096
  ds_read_b64_tr_b16 a[54:55], v13 offset:6144
  v_mfma_f32_16x16x32_bf16 v[168:171], a[24:27], a[88:91], v[168:171]
  ds_read_b64_tr_b16 a[56:57], v14 offset:4096
  ds_read_b64_tr_b16 a[58:59], v14 offset:6144
  v_mfma_f32_16x16x32_bf16 v[184:187], a[28:31], a[88:91], v[184:187]
  ds_read_b64_tr_b16 a[60:61], v15 offset:4096
  ds_read_b64_tr_b16 a[62:63], v15 offset:6144
  v_mfma_f32_16x16x32_bf16 v[188:191], a[28:31], a[92:95], v[188:191]
  buffer_load_dwordx4 v22, s[36:39], s60 offen offset:2048  lds
  v_mfma_f32_16x16x32_bf16 v[172:175], a[24:27], a[92:95], v[172:175]
  v_mfma_f32_16x16x32_bf16 v[160:163], a[24:27], a[80:83], v[160:163]
  v_mfma_f32_16x16x32_bf16 v[176:179], a[28:31], a[80:83], v[176:179]
  v_mfma_f32_16x16x32_bf16 v[180:183], a[28:31], a[84:87], v[180:183]
  buffer_load_dwordx4 v23, s[36:39], s60 offen offset:3072  lds
  v_mfma_f32_16x16x32_bf16 v[164:167], a[24:27], a[84:87], v[164:167]
  s_add_u32 s60, s60, 114688
  s_waitcnt lgkmcnt(12)
  v_mfma_f32_16x16x32_bf16 v[128:131], a[32:35], a[96:99], v[128:131]
  v_mfma_f32_16x16x32_bf16 v[144:147], a[36:39], a[96:99], v[144:147]
  s_waitcnt lgkmcnt(0)
  v_mfma_f32_16x16x32_bf16 v[148:151], a[36:39], a[100:103], v[148:151]
  s_add_u32 m0, s61, 65536
  v_mfma_f32_16x16x32_bf16 v[132:135], a[32:35], a[100:103], v[132:135]
  buffer_load_dwordx4 v20, s[36:39], s60 offen offset:0  lds
  v_mfma_f32_16x16x32_bf16 v[136:139], a[32:35], a[104:107], v[136:139]
  v_mfma_f32_16x16x32_bf16 v[152:155], a[36:39], a[104:107], v[152:155]
  v_mfma_f32_16x16x32_bf16 v[156:159], a[36:39], a[108:111], v[156:159]
  buffer_load_dwordx4 v21, s[36:39], s60 offen offset:1024  lds
  v_mfma_f32_16x16x32_bf16 v[140:143], a[32:35], a[108:111], v[140:143]
  s_waitcnt vmcnt(10)
  v_mfma_f32_16x16x32_bf16 v[168:171], a[40:43], a[104:107], v[168:171]
  ds_read_b128 a[64:67], v2 offset:4096
  ds_read_b128 a[68:71], v2 offset:20480
  v_mfma_f32_16x16x32_bf16 v[184:187], a[44:47], a[104:107], v[184:187]
  ds_read_b64_tr_b16 a[0:1], v4 offset:0
  ds_read_b64_tr_b16 a[2:3], v4 offset:2048
  v_mfma_f32_16x16x32_bf16 v[188:191], a[44:47], a[108:111], v[188:191]
  buffer_load_dwordx4 v22, s[36:39], s60 offen offset:2048  lds
  v_lshrrev_b32 v30, 4, v1
  v_mfma_f32_16x16x32_bf16 v[172:175], a[40:43], a[108:111], v[172:175]
  ds_read_b128 a[72:75], v2 offset:36864
  ds_read_b128 a[76:79], v2 offset:53248
  v_mfma_f32_16x16x32_bf16 v[160:163], a[40:43], a[96:99], v[160:163]
  ds_read_b64_tr_b16 a[4:5], v5 offset:0
  ds_read_b64_tr_b16 a[6:7], v5 offset:2048
  v_lshlrev_b32 v31, 5, v30
  v_mfma_f32_16x16x32_bf16 v[176:179], a[44:47], a[96:99], v[176:179]
  ds_read_b64_tr_b16 a[8:9], v6 offset:0
  ds_read_b64_tr_b16 a[10:11], v6 offset:2048
  v_mfma_f32_16x16x32_bf16 v[180:183], a[44:47], a[100:103], v[180:183]
  buffer_load_dwordx4 v23, s[36:39], s60 offen offset:3072  lds
  v_and_b32 v40, 0xf0, v0
  v_mfma_f32_16x16x32_bf16 v[164:167], a[40:43], a[100:103], v[164:167]
  ds_read_b64_tr_b16 a[12:13], v7 offset:0
  ds_read_b64_tr_b16 a[14:15], v7 offset:2048
  v_mfma_f32_16x16x32_bf16 v[128:131], a[48:51], a[112:115], v[128:131]
  s_add_u32 s60, s60, 114688
  v_xor_b32 v31, v31, v40
  v_mfma_f32_16x16x32_bf16 v[144:147], a[52:55], a[112:115], v[144:147]
  s_add_u32 m0, s61, 69632
  v_mfma_f32_16x16x32_bf16 v[148:151], a[52:55], a[116:119], v[148:151]
  buffer_load_dwordx4 v20, s[36:39], s60 offen offset:0  lds
  v_mul_u32_u24 v30, 1024, v30
  v_mfma_f32_16x16x32_bf16 v[132:135], a[48:51], a[116:119], v[132:135]
  ds_read_b128 a[80:83], v2 offset:5120
  ds_read_b128 a[84:87], v2 offset:21504
  v_mfma_f32_16x16x32_bf16 v[136:139], a[48:51], a[120:123], v[136:139]
  ds_read_b64_tr_b16 a[16:17], v4 offset:4096
  ds_read_b64_tr_b16 a[18:19], v4 offset:6144
  v_add_u32 v24, v30, v31
  v_mfma_f32_16x16x32_bf16 v[152:155], a[52:55], a[120:123], v[152:155]
  ds_read_b128 a[88:91], v2 offset:37888
  ds_read_b128 a[92:95], v2 offset:54272
  v_mfma_f32_16x16x32_bf16 v[156:159], a[52:55], a[124:127], v[156:159]
  buffer_load_dwordx4 v21, s[36:39], s60 offen offset:1024  lds
  v_xor_b32 v31, 0x80, v31
  v_mfma_f32_16x16x32_bf16 v[140:143], a[48:51], a[124:127], v[140:143]
  ds_read_b64_tr_b16 a[20:21], v5 offset:4096
  ds_read_b64_tr_b16 a[22:23], v5 offset:6144
  v_mfma_f32_16x16x32_bf16 v[168:171], a[56:59], a[120:123], v[168:171]
  ds_read_b64_tr_b16 a[24:25], v6 offset:4096
  ds_read_b64_tr_b16 a[26:27], v6 offset:6144
  v_add_u32 v30, v30, v31
  v_mfma_f32_16x16x32_bf16 v[184:187], a[60:63], a[120:123], v[184:187]
  ds_read_b64_tr_b16 a[28:29], v7 offset:4096
  ds_read_b64_tr_b16 a[30:31], v7 offset:6144
  v_mfma_f32_16x16x32_bf16 v[188:191], a[60:63], a[124:127], v[188:191]
  buffer_load_dwordx4 v22, s[36:39], s60 offen offset:2048  lds
  v_add_u32 v25, 3072, v30
  v_mfma_f32_16x16x32_bf16 v[172:175], a[56:59], a[124:127], v[172:175]
  v_mfma_f32_16x16x32_bf16 v[160:163], a[56:59], a[112:115], v[160:163]
  v_add_u32 v26, 6144, v24
  v_mfma_f32_16x16x32_bf16 v[176:179], a[60:63], a[112:115], v[176:179]
  v_mfma_f32_16x16x32_bf16 v[180:183], a[60:63], a[116:119], v[180:183]
  buffer_load_dwordx4 v23, s[36:39], s60 offen offset:3072  lds
  v_add_u32 v27, 9216, v30
  v_mfma_f32_16x16x32_bf16 v[164:167], a[56:59], a[116:119], v[164:167]
  s_add_u32 s60, s60, 114688
  s_waitcnt lgkmcnt(12)
  v_mfma_f32_16x16x32_bf16 v[128:131], a[0:3], a[64:67], v[128:131]
  v_mfma_f32_16x16x32_bf16 v[144:147], a[4:7], a[64:67], v[144:147]
  s_waitcnt lgkmcnt(0)
  v_mfma_f32_16x16x32_bf16 v[148:151], a[4:7], a[68:71], v[148:151]
  s_add_u32 m0, s61, 0
  v_mfma_f32_16x16x32_bf16 v[132:135], a[0:3], a[68:71], v[132:135]
  buffer_load_dwordx4 v20, s[36:39], s60 offen offset:0  lds
  v_mfma_f32_16x16x32_bf16 v[136:139], a[0:3], a[72:75], v[136:139]
  v_mfma_f32_16x16x32_bf16 v[152:155], a[4:7], a[72:75], v[152:155]
  v_mfma_f32_16x16x32_bf16 v[156:159], a[4:7], a[76:79], v[156:159]
  buffer_load_dwordx4 v21, s[36:39], s60 offen offset:1024  lds
  v_mfma_f32_16x16x32_bf16 v[140:143], a[0:3], a[76:79], v[140:143]
  s_waitcnt vmcnt(10)
  v_mfma_f32_16x16x32_bf16 v[168:171], a[8:11], a[72:75], v[168:171]
  ds_read_b128 a[96:99], v2 offset:6144
  ds_read_b128 a[100:103], v2 offset:22528
  v_mfma_f32_16x16x32_bf16 v[184:187], a[12:15], a[72:75], v[184:187]
  ds_read_b64_tr_b16 a[32:33], v4 offset:32768
  ds_read_b64_tr_b16 a[34:35], v4 offset:34816
  v_mfma_f32_16x16x32_bf16 v[188:191], a[12:15], a[76:79], v[188:191]
  buffer_load_dwordx4 v22, s[36:39], s60 offen offset:2048  lds
  v_mul_f32 v48, v51, v51
  v_mfma_f32_16x16x32_bf16 v[172:175], a[8:11], a[76:79], v[172:175]
  ds_read_b128 a[104:107], v2 offset:38912
  ds_read_b128 a[108:111], v2 offset:55296
  v_mul_f32 v49, 3222493025, v51
  v_mfma_f32_16x16x32_bf16 v[160:163], a[8:11], a[64:67], v[160:163]
  ds_read_b64_tr_b16 a[36:37], v5 offset:32768
  ds_read_b64_tr_b16 a[38:39], v5 offset:34816
  v_rcp_f32 v50, v51
  v_mfma_f32_16x16x32_bf16 v[176:179], a[12:15], a[64:67], v[176:179]
  ds_read_b64_tr_b16 a[40:41], v6 offset:32768
  ds_read_b64_tr_b16 a[42:43], v6 offset:34816
  v_mul_f32 v48, v48, v49
  v_mfma_f32_16x16x32_bf16 v[180:183], a[12:15], a[68:71], v[180:183]
  buffer_load_dwordx4 v23, s[36:39], s60 offen offset:3072  lds
  v_mul_f32 v48, 1027024659, v48
  v_mfma_f32_16x16x32_bf16 v[164:167], a[8:11], a[68:71], v[164:167]
  ds_read_b64_tr_b16 a[44:45], v7 offset:32768
  ds_read_b64_tr_b16 a[46:47], v7 offset:34816
  v_mul_f32 v52, v55, v55
  v_mfma_f32_16x16x32_bf16 v[128:131], a[16:19], a[80:83], v[128:131]
  s_add_u32 s60, s60, 114688
  v_mul_f32 v53, 3222493025, v55
  v_mfma_f32_16x16x32_bf16 v[144:147], a[20:23], a[80:83], v[144:147]
  s_add_u32 m0, s61, 4096
  v_rcp_f32 v54, v55
  v_mfma_f32_16x16x32_bf16 v[148:151], a[20:23], a[84:87], v[148:151]
  buffer_load_dwordx4 v20, s[36:39], s60 offen offset:0  lds
  v_mul_f32 v52, v52, v53
  v_mfma_f32_16x16x32_bf16 v[132:135], a[16:19], a[84:87], v[132:135]
  ds_read_b128 a[112:115], v2 offset:7168
  ds_read_b128 a[116:119], v2 offset:23552
  v_mul_f32 v52, 1027024659, v52
  v_mfma_f32_16x16x32_bf16 v[136:139], a[16:19], a[88:91], v[136:139]
  ds_read_b64_tr_b16 a[48:49], v4 offset:36864
  ds_read_b64_tr_b16 a[50:51], v4 offset:38912
  v_mfma_f32_16x16x32_bf16 v[152:155], a[20:23], a[88:91], v[152:155]
  ds_read_b128 a[120:123], v2 offset:39936
  ds_read_b128 a[124:127], v2 offset:56320
  v_mul_f32 v56, v59, v59
  v_mfma_f32_16x16x32_bf16 v[156:159], a[20:23], a[92:95], v[156:159]
  buffer_load_dwordx4 v21, s[36:39], s60 offen offset:1024  lds
  v_mul_f32 v57, 3222493025, v59
  v_mfma_f32_16x16x32_bf16 v[140:143], a[16:19], a[92:95], v[140:143]
  ds_read_b64_tr_b16 a[52:53], v5 offset:36864
  ds_read_b64_tr_b16 a[54:55], v5 offset:38912
  v_rcp_f32 v58, v59
  v_mfma_f32_16x16x32_bf16 v[168:171], a[24:27], a[88:91], v[168:171]
  ds_read_b64_tr_b16 a[56:57], v6 offset:36864
  ds_read_b64_tr_b16 a[58:59], v6 offset:38912
  v_mul_f32 v56, v56, v57
  v_mfma_f32_16x16x32_bf16 v[184:187], a[28:31], a[88:91], v[184:187]
  ds_read_b64_tr_b16 a[60:61], v7 offset:36864
  ds_read_b64_tr_b16 a[62:63], v7 offset:38912
  v_mul_f32 v56, 1027024659, v56
  v_mfma_f32_16x16x32_bf16 v[188:191], a[28:31], a[92:95], v[188:191]
  buffer_load_dwordx4 v22, s[36:39], s60 offen offset:2048  lds
  v_mul_f32 v60, v63, v63
  v_mfma_f32_16x16x32_bf16 v[172:175], a[24:27], a[92:95], v[172:175]
  v_mul_f32 v61, 3222493025, v63
  v_mfma_f32_16x16x32_bf16 v[160:163], a[24:27], a[80:83], v[160:163]
  v_rcp_f32 v62, v63
  v_mfma_f32_16x16x32_bf16 v[176:179], a[28:31], a[80:83], v[176:179]
  v_mul_f32 v60, v60, v61
  v_mfma_f32_16x16x32_bf16 v[180:183], a[28:31], a[84:87], v[180:183]
  buffer_load_dwordx4 v23, s[36:39], s60 offen offset:3072  lds
  v_mul_f32 v60, 1027024659, v60
  v_mfma_f32_16x16x32_bf16 v[164:167], a[24:27], a[84:87], v[164:167]
  s_add_u32 s60, s60, 114688
  s_waitcnt lgkmcnt(12)
  v_mfma_f32_16x16x32_bf16 v[128:131], a[32:35], a[96:99], v[128:131]
  v_mfma_f32_16x16x32_bf16 v[144:147], a[36:39], a[96:99], v[144:147]
  s_waitcnt lgkmcnt(0)
  v_mfma_f32_16x16x32_bf16 v[148:151], a[36:39], a[100:103], v[148:151]
  s_add_u32 m0, s61, 32768
  v_mfma_f32_16x16x32_bf16 v[132:135], a[32:35], a[100:103], v[132:135]
  buffer_load_dwordx4 v20, s[36:39], s60 offen offset:0  lds
  v_mfma_f32_16x16x32_bf16 v[136:139], a[32:35], a[104:107], v[136:139]
  v_mfma_f32_16x16x32_bf16 v[152:155], a[36:39], a[104:107], v[152:155]
  v_mfma_f32_16x16x32_bf16 v[156:159], a[36:39], a[108:111], v[156:159]
  buffer_load_dwordx4 v21, s[36:39], s60 offen offset:1024  lds
  v_mfma_f32_16x16x32_bf16 v[140:143], a[32:35], a[108:111], v[140:143]
  s_waitcnt vmcnt(10)
  v_mfma_f32_16x16x32_bf16 v[168:171], a[40:43], a[104:107], v[168:171]
  ds_read_b128 a[64:67], v2 offset:8192
  ds_read_b128 a[68:71], v2 offset:24576
  v_mfma_f32_16x16x32_bf16 v[184:187], a[44:47], a[104:107], v[184:187]
  ds_read_b64_tr_b16 a[0:1], v12 offset:0
  ds_read_b64_tr_b16 a[2:3], v12 offset:2048
  v_mfma_f32_16x16x32_bf16 v[188:191], a[44:47], a[108:111], v[188:191]
  buffer_load_dwordx4 v22, s[36:39], s60 offen offset:2048  lds
  v_mfma_f32_16x16x32_bf16 v[172:175], a[40:43], a[108:111], v[172:175]
  ds_read_b128 a[72:75], v2 offset:40960
  ds_read_b128 a[76:79], v2 offset:57344
  v_mfma_f32_16x16x32_bf16 v[160:163], a[40:43], a[96:99], v[160:163]
  ds_read_b64_tr_b16 a[4:5], v13 offset:0
  ds_read_b64_tr_b16 a[6:7], v13 offset:2048
  v_mfma_f32_16x16x32_bf16 v[176:179], a[44:47], a[96:99], v[176:179]
  ds_read_b64_tr_b16 a[8:9], v14 offset:0
  ds_read_b64_tr_b16 a[10:11], v14 offset:2048
  v_mfma_f32_16x16x32_bf16 v[180:183], a[44:47], a[100:103], v[180:183]
  buffer_load_dwordx4 v23, s[36:39], s60 offen offset:3072  lds
  v_mfma_f32_16x16x32_bf16 v[164:167], a[40:43], a[100:103], v[164:167]
  ds_read_b64_tr_b16 a[12:13], v15 offset:0
  ds_read_b64_tr_b16 a[14:15], v15 offset:2048
  v_mfma_f32_16x16x32_bf16 v[128:131], a[48:51], a[112:115], v[128:131]
  s_add_u32 s60, s60, 114688
  v_mfma_f32_16x16x32_bf16 v[144:147], a[52:55], a[112:115], v[144:147]
  s_add_u32 m0, s61, 36864
  v_mfma_f32_16x16x32_bf16 v[148:151], a[52:55], a[116:119], v[148:151]
  buffer_load_dwordx4 v20, s[36:39], s60 offen offset:0  lds
  v_mfma_f32_16x16x32_bf16 v[132:135], a[48:51], a[116:119], v[132:135]
  ds_read_b128 a[80:83], v2 offset:9216
  ds_read_b128 a[84:87], v2 offset:25600
  v_mfma_f32_16x16x32_bf16 v[136:139], a[48:51], a[120:123], v[136:139]
  ds_read_b64_tr_b16 a[16:17], v12 offset:4096
  ds_read_b64_tr_b16 a[18:19], v12 offset:6144
  v_mfma_f32_16x16x32_bf16 v[152:155], a[52:55], a[120:123], v[152:155]
  ds_read_b128 a[88:91], v2 offset:41984
  ds_read_b128 a[92:95], v2 offset:58368
  v_mfma_f32_16x16x32_bf16 v[156:159], a[52:55], a[124:127], v[156:159]
  buffer_load_dwordx4 v21, s[36:39], s60 offen offset:1024  lds
  v_mfma_f32_16x16x32_bf16 v[140:143], a[48:51], a[124:127], v[140:143]
  ds_read_b64_tr_b16 a[20:21], v13 offset:4096
  ds_read_b64_tr_b16 a[22:23], v13 offset:6144
  v_mfma_f32_16x16x32_bf16 v[168:171], a[56:59], a[120:123], v[168:171]
  ds_read_b64_tr_b16 a[24:25], v14 offset:4096
  ds_read_b64_tr_b16 a[26:27], v14 offset:6144
  v_mfma_f32_16x16x32_bf16 v[184:187], a[60:63], a[120:123], v[184:187]
  ds_read_b64_tr_b16 a[28:29], v15 offset:4096
  ds_read_b64_tr_b16 a[30:31], v15 offset:6144
  v_mfma_f32_16x16x32_bf16 v[188:191], a[60:63], a[124:127], v[188:191]
  buffer_load_dwordx4 v22, s[36:39], s60 offen offset:2048  lds
  v_mfma_f32_16x16x32_bf16 v[172:175], a[56:59], a[124:127], v[172:175]
  v_mfma_f32_16x16x32_bf16 v[160:163], a[56:59], a[112:115], v[160:163]
  v_mfma_f32_16x16x32_bf16 v[176:179], a[60:63], a[112:115], v[176:179]
  v_mfma_f32_16x16x32_bf16 v[180:183], a[60:63], a[116:119], v[180:183]
  buffer_load_dwordx4 v23, s[36:39], s60 offen offset:3072  lds
  v_mfma_f32_16x16x32_bf16 v[164:167], a[56:59], a[116:119], v[164:167]
  s_add_u32 s60, s60, 114688
  s_waitcnt lgkmcnt(12)
  v_mfma_f32_16x16x32_bf16 v[128:131], a[0:3], a[64:67], v[128:131]
  v_mfma_f32_16x16x32_bf16 v[144:147], a[4:7], a[64:67], v[144:147]
  s_waitcnt lgkmcnt(0)
  v_mfma_f32_16x16x32_bf16 v[148:151], a[4:7], a[68:71], v[148:151]
  s_add_u32 m0, s61, 65536
  v_mfma_f32_16x16x32_bf16 v[132:135], a[0:3], a[68:71], v[132:135]
  buffer_load_dwordx4 v20, s[36:39], s60 offen offset:0  lds
  v_mfma_f32_16x16x32_bf16 v[136:139], a[0:3], a[72:75], v[136:139]
  v_mfma_f32_16x16x32_bf16 v[152:155], a[4:7], a[72:75], v[152:155]
  v_mfma_f32_16x16x32_bf16 v[156:159], a[4:7], a[76:79], v[156:159]
  buffer_load_dwordx4 v21, s[36:39], s60 offen offset:1024  lds
  v_mfma_f32_16x16x32_bf16 v[140:143], a[0:3], a[76:79], v[140:143]
  s_waitcnt vmcnt(10)
  v_mfma_f32_16x16x32_bf16 v[168:171], a[8:11], a[72:75], v[168:171]
  ds_read_b128 a[96:99], v2 offset:10240
  ds_read_b128 a[100:103], v2 offset:26624
  v_mfma_f32_16x16x32_bf16 v[184:187], a[12:15], a[72:75], v[184:187]
  ds_read_b64_tr_b16 a[32:33], v4 offset:0
  ds_read_b64_tr_b16 a[34:35], v4 offset:2048
  v_mfma_f32_16x16x32_bf16 v[188:191], a[12:15], a[76:79], v[188:191]
  buffer_load_dwordx4 v22, s[36:39], s60 offen offset:2048  lds
  v_mfma_f32_16x16x32_bf16 v[172:175], a[8:11], a[76:79], v[172:175]
  ds_read_b128 a[104:107], v2 offset:43008
  ds_read_b128 a[108:111], v2 offset:59392
  v_mfma_f32_16x16x32_bf16 v[160:163], a[8:11], a[64:67], v[160:163]
  ds_read_b64_tr_b16 a[36:37], v5 offset:0
  ds_read_b64_tr_b16 a[38:39], v5 offset:2048
  v_mfma_f32_16x16x32_bf16 v[176:179], a[12:15], a[64:67], v[176:179]
  ds_read_b64_tr_b16 a[40:41], v6 offset:0
  ds_read_b64_tr_b16 a[42:43], v6 offset:2048
  v_mfma_f32_16x16x32_bf16 v[180:183], a[12:15], a[68:71], v[180:183]
  buffer_load_dwordx4 v23, s[36:39], s60 offen offset:3072  lds
  v_mfma_f32_16x16x32_bf16 v[164:167], a[8:11], a[68:71], v[164:167]
  ds_read_b64_tr_b16 a[44:45], v7 offset:0
  ds_read_b64_tr_b16 a[46:47], v7 offset:2048
  v_mfma_f32_16x16x32_bf16 v[128:131], a[16:19], a[80:83], v[128:131]
  s_add_u32 s60, s60, 114688
  v_mfma_f32_16x16x32_bf16 v[144:147], a[20:23], a[80:83], v[144:147]
  s_add_u32 m0, s61, 69632
  v_mfma_f32_16x16x32_bf16 v[148:151], a[20:23], a[84:87], v[148:151]
  buffer_load_dwordx4 v20, s[36:39], s60 offen offset:0  lds
  v_mfma_f32_16x16x32_bf16 v[132:135], a[16:19], a[84:87], v[132:135]
  ds_read_b128 a[112:115], v2 offset:11264
  ds_read_b128 a[116:119], v2 offset:27648
  v_mfma_f32_16x16x32_bf16 v[136:139], a[16:19], a[88:91], v[136:139]
  ds_read_b64_tr_b16 a[48:49], v4 offset:4096
  ds_read_b64_tr_b16 a[50:51], v4 offset:6144
  v_mfma_f32_16x16x32_bf16 v[152:155], a[20:23], a[88:91], v[152:155]
  ds_read_b128 a[120:123], v2 offset:44032
  ds_read_b128 a[124:127], v2 offset:60416
  v_mfma_f32_16x16x32_bf16 v[156:159], a[20:23], a[92:95], v[156:159]
  buffer_load_dwordx4 v21, s[36:39], s60 offen offset:1024  lds
  v_mfma_f32_16x16x32_bf16 v[140:143], a[16:19], a[92:95], v[140:143]
  ds_read_b64_tr_b16 a[52:53], v5 offset:4096
  ds_read_b64_tr_b16 a[54:55], v5 offset:6144
  v_mfma_f32_16x16x32_bf16 v[168:171], a[24:27], a[88:91], v[168:171]
  ds_read_b64_tr_b16 a[56:57], v6 offset:4096
  ds_read_b64_tr_b16 a[58:59], v6 offset:6144
  v_mfma_f32_16x16x32_bf16 v[184:187], a[28:31], a[88:91], v[184:187]
  ds_read_b64_tr_b16 a[60:61], v7 offset:4096
  ds_read_b64_tr_b16 a[62:63], v7 offset:6144
  v_mfma_f32_16x16x32_bf16 v[188:191], a[28:31], a[92:95], v[188:191]
  buffer_load_dwordx4 v22, s[36:39], s60 offen offset:2048  lds
  v_mfma_f32_16x16x32_bf16 v[172:175], a[24:27], a[92:95], v[172:175]
  v_mfma_f32_16x16x32_bf16 v[160:163], a[24:27], a[80:83], v[160:163]
  v_mfma_f32_16x16x32_bf16 v[176:179], a[28:31], a[80:83], v[176:179]
  v_mfma_f32_16x16x32_bf16 v[180:183], a[28:31], a[84:87], v[180:183]
  buffer_load_dwordx4 v23, s[36:39], s60 offen offset:3072  lds
  v_mfma_f32_16x16x32_bf16 v[164:167], a[24:27], a[84:87], v[164:167]
  s_add_u32 s60, s60, 114688
  s_waitcnt lgkmcnt(12)
  v_mfma_f32_16x16x32_bf16 v[128:131], a[32:35], a[96:99], v[128:131]
  v_mfma_f32_16x16x32_bf16 v[144:147], a[36:39], a[96:99], v[144:147]
  s_waitcnt lgkmcnt(0)
  v_mfma_f32_16x16x32_bf16 v[148:151], a[36:39], a[100:103], v[148:151]
  s_mov_b32 s60, 0
  v_mfma_f32_16x16x32_bf16 v[132:135], a[32:35], a[100:103], v[132:135]
  s_add_u32 m0, s61, 0
  v_mfma_f32_16x16x32_bf16 v[136:139], a[32:35], a[104:107], v[136:139]
  v_mfma_f32_16x16x32_bf16 v[152:155], a[36:39], a[104:107], v[152:155]
  v_mfma_f32_16x16x32_bf16 v[156:159], a[36:39], a[108:111], v[156:159]
  buffer_load_dwordx4 v24, s[24:27], s60 offen offset:0  lds
  v_mfma_f32_16x16x32_bf16 v[140:143], a[32:35], a[108:111], v[140:143]
  s_waitcnt vmcnt(9)
  v_mfma_f32_16x16x32_bf16 v[168:171], a[40:43], a[104:107], v[168:171]
  ds_read_b128 a[64:67], v2 offset:12288
  ds_read_b128 a[68:71], v2 offset:28672
  v_mfma_f32_16x16x32_bf16 v[184:187], a[44:47], a[104:107], v[184:187]
  ds_read_b64_tr_b16 a[0:1], v4 offset:32768
  ds_read_b64_tr_b16 a[2:3], v4 offset:34816
  v_mfma_f32_16x16x32_bf16 v[188:191], a[44:47], a[108:111], v[188:191]
  buffer_load_dwordx4 v25, s[24:27], s60 offen offset:1024  lds
  v_mfma_f32_16x16x32_bf16 v[172:175], a[40:43], a[108:111], v[172:175]
  ds_read_b128 a[72:75], v2 offset:45056
  ds_read_b128 a[76:79], v2 offset:61440
  v_mfma_f32_16x16x32_bf16 v[160:163], a[40:43], a[96:99], v[160:163]
  ds_read_b64_tr_b16 a[4:5], v5 offset:32768
  ds_read_b64_tr_b16 a[6:7], v5 offset:34816
  v_mfma_f32_16x16x32_bf16 v[176:179], a[44:47], a[96:99], v[176:179]
  ds_read_b64_tr_b16 a[8:9], v6 offset:32768
  ds_read_b64_tr_b16 a[10:11], v6 offset:34816
  v_mfma_f32_16x16x32_bf16 v[180:183], a[44:47], a[100:103], v[180:183]
  buffer_load_dwordx4 v26, s[24:27], s60 offen offset:2048  lds
  v_mfma_f32_16x16x32_bf16 v[164:167], a[40:43], a[100:103], v[164:167]
  ds_read_b64_tr_b16 a[12:13], v7 offset:32768
  ds_read_b64_tr_b16 a[14:15], v7 offset:34816
  v_mfma_f32_16x16x32_bf16 v[128:131], a[48:51], a[112:115], v[128:131]
  buffer_load_dwordx4 v27, s[24:27], s60 offen offset:3072  lds
  v_mfma_f32_16x16x32_bf16 v[144:147], a[52:55], a[112:115], v[144:147]
  s_add_u32 s60, s60, 16384
  v_mfma_f32_16x16x32_bf16 v[148:151], a[52:55], a[116:119], v[148:151]
  s_add_u32 m0, s61, 4096
  v_mfma_f32_16x16x32_bf16 v[132:135], a[48:51], a[116:119], v[132:135]
  ds_read_b128 a[80:83], v2 offset:13312
  ds_read_b128 a[84:87], v2 offset:29696
  v_mfma_f32_16x16x32_bf16 v[136:139], a[48:51], a[120:123], v[136:139]
  ds_read_b64_tr_b16 a[16:17], v4 offset:36864
  ds_read_b64_tr_b16 a[18:19], v4 offset:38912
  v_mfma_f32_16x16x32_bf16 v[152:155], a[52:55], a[120:123], v[152:155]
  ds_read_b128 a[88:91], v2 offset:46080
  ds_read_b128 a[92:95], v2 offset:62464
  v_mfma_f32_16x16x32_bf16 v[156:159], a[52:55], a[124:127], v[156:159]
  buffer_load_dwordx4 v24, s[24:27], s60 offen offset:0  lds
  v_mfma_f32_16x16x32_bf16 v[140:143], a[48:51], a[124:127], v[140:143]
  ds_read_b64_tr_b16 a[20:21], v5 offset:36864
  ds_read_b64_tr_b16 a[22:23], v5 offset:38912
  v_mfma_f32_16x16x32_bf16 v[168:171], a[56:59], a[120:123], v[168:171]
  ds_read_b64_tr_b16 a[24:25], v6 offset:36864
  ds_read_b64_tr_b16 a[26:27], v6 offset:38912
  v_mfma_f32_16x16x32_bf16 v[184:187], a[60:63], a[120:123], v[184:187]
  ds_read_b64_tr_b16 a[28:29], v7 offset:36864
  ds_read_b64_tr_b16 a[30:31], v7 offset:38912
  v_mfma_f32_16x16x32_bf16 v[188:191], a[60:63], a[124:127], v[188:191]
  buffer_load_dwordx4 v25, s[24:27], s60 offen offset:1024  lds
  v_mfma_f32_16x16x32_bf16 v[172:175], a[56:59], a[124:127], v[172:175]
  v_mfma_f32_16x16x32_bf16 v[160:163], a[56:59], a[112:115], v[160:163]
  v_mfma_f32_16x16x32_bf16 v[176:179], a[60:63], a[112:115], v[176:179]
  v_mfma_f32_16x16x32_bf16 v[180:183], a[60:63], a[116:119], v[180:183]
  buffer_load_dwordx4 v26, s[24:27], s60 offen offset:2048  lds
  v_mfma_f32_16x16x32_bf16 v[164:167], a[56:59], a[116:119], v[164:167]
  buffer_load_dwordx4 v27, s[24:27], s60 offen offset:3072  lds
  s_add_u32 s60, s60, 16384
  s_waitcnt lgkmcnt(12)
  v_mfma_f32_16x16x32_bf16 v[128:131], a[0:3], a[64:67], v[128:131]
  v_mfma_f32_16x16x32_bf16 v[144:147], a[4:7], a[64:67], v[144:147]
  s_waitcnt lgkmcnt(0)
  v_mfma_f32_16x16x32_bf16 v[148:151], a[4:7], a[68:71], v[148:151]
  s_add_u32 m0, s61, 32768
  v_mfma_f32_16x16x32_bf16 v[132:135], a[0:3], a[68:71], v[132:135]
  buffer_load_dwordx4 v24, s[24:27], s60 offen offset:0  lds
  v_mfma_f32_16x16x32_bf16 v[136:139], a[0:3], a[72:75], v[136:139]
  v_mfma_f32_16x16x32_bf16 v[152:155], a[4:7], a[72:75], v[152:155]
  v_mfma_f32_16x16x32_bf16 v[156:159], a[4:7], a[76:79], v[156:159]
  buffer_load_dwordx4 v25, s[24:27], s60 offen offset:1024  lds
  v_mfma_f32_16x16x32_bf16 v[140:143], a[0:3], a[76:79], v[140:143]
  s_waitcnt vmcnt(10)
  v_mfma_f32_16x16x32_bf16 v[168:171], a[8:11], a[72:75], v[168:171]
  ds_read_b128 a[96:99], v2 offset:14336
  ds_read_b128 a[100:103], v2 offset:30720
  v_mfma_f32_16x16x32_bf16 v[184:187], a[12:15], a[72:75], v[184:187]
  ds_read_b64_tr_b16 a[32:33], v12 offset:0
  ds_read_b64_tr_b16 a[34:35], v12 offset:2048
  v_mfma_f32_16x16x32_bf16 v[188:191], a[12:15], a[76:79], v[188:191]
  buffer_load_dwordx4 v26, s[24:27], s60 offen offset:2048  lds
  v_mfma_f32_16x16x32_bf16 v[172:175], a[8:11], a[76:79], v[172:175]
  ds_read_b128 a[104:107], v2 offset:47104
  ds_read_b128 a[108:111], v2 offset:63488
  v_mfma_f32_16x16x32_bf16 v[160:163], a[8:11], a[64:67], v[160:163]
  ds_read_b64_tr_b16 a[36:37], v13 offset:0
  ds_read_b64_tr_b16 a[38:39], v13 offset:2048
  v_mfma_f32_16x16x32_bf16 v[176:179], a[12:15], a[64:67], v[176:179]
  ds_read_b64_tr_b16 a[40:41], v14 offset:0
  ds_read_b64_tr_b16 a[42:43], v14 offset:2048
  v_mfma_f32_16x16x32_bf16 v[180:183], a[12:15], a[68:71], v[180:183]
  buffer_load_dwordx4 v27, s[24:27], s60 offen offset:3072  lds
  v_mfma_f32_16x16x32_bf16 v[164:167], a[8:11], a[68:71], v[164:167]
  ds_read_b64_tr_b16 a[44:45], v15 offset:0
  ds_read_b64_tr_b16 a[46:47], v15 offset:2048
  v_mfma_f32_16x16x32_bf16 v[128:131], a[16:19], a[80:83], v[128:131]
  s_add_u32 s60, s60, 16384
  v_mfma_f32_16x16x32_bf16 v[144:147], a[20:23], a[80:83], v[144:147]
  s_add_u32 m0, s61, 36864
  v_mfma_f32_16x16x32_bf16 v[148:151], a[20:23], a[84:87], v[148:151]
  buffer_load_dwordx4 v24, s[24:27], s60 offen offset:0  lds
  v_mfma_f32_16x16x32_bf16 v[132:135], a[16:19], a[84:87], v[132:135]
  ds_read_b128 a[112:115], v2 offset:15360
  ds_read_b128 a[116:119], v2 offset:31744
  v_mfma_f32_16x16x32_bf16 v[136:139], a[16:19], a[88:91], v[136:139]
  ds_read_b64_tr_b16 a[48:49], v12 offset:4096
  ds_read_b64_tr_b16 a[50:51], v12 offset:6144
  v_mfma_f32_16x16x32_bf16 v[152:155], a[20:23], a[88:91], v[152:155]
  ds_read_b128 a[120:123], v2 offset:48128
  ds_read_b128 a[124:127], v2 offset:64512
  v_mfma_f32_16x16x32_bf16 v[156:159], a[20:23], a[92:95], v[156:159]
  buffer_load_dwordx4 v25, s[24:27], s60 offen offset:1024  lds
  v_mfma_f32_16x16x32_bf16 v[140:143], a[16:19], a[92:95], v[140:143]
  ds_read_b64_tr_b16 a[52:53], v13 offset:4096
  ds_read_b64_tr_b16 a[54:55], v13 offset:6144
  v_mfma_f32_16x16x32_bf16 v[168:171], a[24:27], a[88:91], v[168:171]
  ds_read_b64_tr_b16 a[56:57], v14 offset:4096
  ds_read_b64_tr_b16 a[58:59], v14 offset:6144
  v_mfma_f32_16x16x32_bf16 v[184:187], a[28:31], a[88:91], v[184:187]
  ds_read_b64_tr_b16 a[60:61], v15 offset:4096
  ds_read_b64_tr_b16 a[62:63], v15 offset:6144
  v_mfma_f32_16x16x32_bf16 v[188:191], a[28:31], a[92:95], v[188:191]
  buffer_load_dwordx4 v26, s[24:27], s60 offen offset:2048  lds
  v_mfma_f32_16x16x32_bf16 v[172:175], a[24:27], a[92:95], v[172:175]
  v_mfma_f32_16x16x32_bf16 v[160:163], a[24:27], a[80:83], v[160:163]
  v_mfma_f32_16x16x32_bf16 v[176:179], a[28:31], a[80:83], v[176:179]
  v_mfma_f32_16x16x32_bf16 v[180:183], a[28:31], a[84:87], v[180:183]
  buffer_load_dwordx4 v27, s[24:27], s60 offen offset:3072  lds
  v_mfma_f32_16x16x32_bf16 v[164:167], a[24:27], a[84:87], v[164:167]
  s_add_u32 s60, s60, 16384
  s_waitcnt lgkmcnt(12)
  v_mfma_f32_16x16x32_bf16 v[128:131], a[32:35], a[96:99], v[128:131]
  v_mfma_f32_16x16x32_bf16 v[144:147], a[36:39], a[96:99], v[144:147]
  s_waitcnt lgkmcnt(0)
  v_mfma_f32_16x16x32_bf16 v[148:151], a[36:39], a[100:103], v[148:151]
  s_add_u32 m0, s61, 65536
  v_mfma_f32_16x16x32_bf16 v[132:135], a[32:35], a[100:103], v[132:135]
  v_mfma_f32_16x16x32_bf16 v[136:139], a[32:35], a[104:107], v[136:139]
  buffer_load_dwordx4 v24, s[24:27], s60 offen offset:0  lds
  v_mfma_f32_16x16x32_bf16 v[152:155], a[36:39], a[104:107], v[152:155]
  v_mfma_f32_16x16x32_bf16 v[156:159], a[36:39], a[108:111], v[156:159]
  buffer_load_dwordx4 v25, s[24:27], s60 offen offset:1024  lds
  v_mfma_f32_16x16x32_bf16 v[140:143], a[32:35], a[108:111], v[140:143]
  v_mfma_f32_16x16x32_bf16 v[168:171], a[40:43], a[104:107], v[168:171]
  v_mfma_f32_16x16x32_bf16 v[184:187], a[44:47], a[104:107], v[184:187]
  buffer_load_dwordx4 v26, s[24:27], s60 offen offset:2048  lds
  v_lshrrev_b32 v30, 4, v1
  v_bfe_u32 v31, v1, 2, 2
  v_mfma_f32_16x16x32_bf16 v[188:191], a[44:47], a[108:111], v[188:191]
  v_and_b32 v40, 1, v30
  v_mfma_f32_16x16x32_bf16 v[172:175], a[40:43], a[108:111], v[172:175]
  buffer_load_dwordx4 v27, s[24:27], s60 offen offset:3072  lds
  v_lshl_add_u32 v40, v40, 2, v31
  v_mfma_f32_16x16x32_bf16 v[160:163], a[40:43], a[96:99], v[160:163]
  v_lshl_add_u32 v30, v30, 2, v31
  v_mfma_f32_16x16x32_bf16 v[176:179], a[44:47], a[96:99], v[176:179]
  v_lshlrev_b32 v4, 8, v30
  v_mfma_f32_16x16x32_bf16 v[180:183], a[44:47], a[100:103], v[180:183]
  s_add_u32 s60, s60, 16384
  v_and_b32 v31, 3, v1
  v_lshl_add_u32 v4, v31, 3, v4
  v_mfma_f32_16x16x32_bf16 v[164:167], a[40:43], a[100:103], v[164:167]
  v_lshl_add_u32 v4, v40, 5, v4
  v_mfma_f32_16x16x32_bf16 v[128:131], a[48:51], a[112:115], v[128:131]
  s_add_u32 m0, s61, 69632
  v_lshlrev_b32 v46, 10, v1
  s_lshr_b32 s99, s2, 5
  s_lshl_b32 s99, s99, 2
  s_add_u32 s99, s99, s3
  s_mul_i32 s99, s99, 57344
  v_cmp_gt_u32 vcc, 56, v1
  s_nop 1
  v_cndmask_b32 v46, -1, v46, vcc
  buffer_load_dword a255, v46, s[40:43], s99 offen
  s_add_u32 s99, s99, 65536
  v_add_u32 v4, s61, v4
  v_mfma_f32_16x16x32_bf16 v[144:147], a[52:55], a[112:115], v[144:147]
  v_xor_b32 v5, 32, v4
  v_mfma_f32_16x16x32_bf16 v[148:151], a[52:55], a[116:119], v[148:151]
  buffer_load_dwordx4 v24, s[24:27], s60 offen offset:0  lds
  v_xor_b32 v6, 64, v4
  v_mfma_f32_16x16x32_bf16 v[132:135], a[48:51], a[116:119], v[132:135]
  v_xor_b32 v7, 96, v4
  v_mfma_f32_16x16x32_bf16 v[136:139], a[48:51], a[120:123], v[136:139]
  v_xor_b32 v8, 128, v4
  v_xor_b32 v9, 160, v4
  v_mfma_f32_16x16x32_bf16 v[152:155], a[52:55], a[120:123], v[152:155]
  buffer_load_dwordx4 v25, s[24:27], s60 offen offset:1024  lds
  v_xor_b32 v10, 192, v4
  v_mfma_f32_16x16x32_bf16 v[156:159], a[52:55], a[124:127], v[156:159]
  v_xor_b32 v11, 224, v4
  v_mfma_f32_16x16x32_bf16 v[140:143], a[48:51], a[124:127], v[140:143]
  buffer_load_dwordx4 v26, s[24:27], s60 offen offset:2048  lds
  v_add_u32 v12, 0x10000, v4
  v_mfma_f32_16x16x32_bf16 v[168:171], a[56:59], a[120:123], v[168:171]
  v_add_u32 v13, 0x10000, v5
  v_mfma_f32_16x16x32_bf16 v[184:187], a[60:63], a[120:123], v[184:187]
  v_add_u32 v14, 0x10000, v6
  v_mfma_f32_16x16x32_bf16 v[188:191], a[60:63], a[124:127], v[188:191]
  buffer_load_dwordx4 v27, s[24:27], s60 offen offset:3072  lds
  v_add_u32 v15, 0x10000, v7
  v_add_u32 v16, 0x10000, v8
  v_mfma_f32_16x16x32_bf16 v[172:175], a[56:59], a[124:127], v[172:175]
  v_add_u32 v17, 0x10000, v9
  v_mfma_f32_16x16x32_bf16 v[160:163], a[56:59], a[112:115], v[160:163]
  s_add_u32 s60, s60, 16384
  v_add_u32 v18, 0x10000, v10
  v_mfma_f32_16x16x32_bf16 v[176:179], a[60:63], a[112:115], v[176:179]
  v_add_u32 v19, 0x10000, v11
  v_mfma_f32_16x16x32_bf16 v[180:183], a[60:63], a[116:119], v[180:183]
  s_lshl_b32 s56, s3, 12
  v_mfma_f32_16x16x32_bf16 v[164:167], a[56:59], a[116:119], v[164:167]
  v_add_u32 v3, s56, v2
  s_barrier
  v_pk_mul_f32 v[192:193], v[128:129], v[128:129]
  ds_write_b128 v3, v[64:67] offset:0
  v_pk_mul_f32 v[194:195], v[130:131], v[130:131]
  v_pk_mul_f32 v[196:197], v[144:145], v[144:145]
  v_pk_mul_f32 v[198:199], v[146:147], v[146:147]
  v_pk_fma_f32 v[192:193], v[192:193], v[48:49], v[48:49] op_sel:[0,0,1] op_sel_hi:[1,0,1]
  v_pk_fma_f32 v[194:195], v[194:195], v[48:49], v[48:49] op_sel:[0,0,1] op_sel_hi:[1,0,1]
  v_pk_fma_f32 v[196:197], v[196:197], v[48:49], v[48:49] op_sel:[0,0,1] op_sel_hi:[1,0,1]
  ds_write_b128 v3, v[68:71] offset:16384
  v_pk_fma_f32 v[198:199], v[198:199], v[48:49], v[48:49] op_sel:[0,0,1] op_sel_hi:[1,0,1]
  v_pk_mul_f32 v[192:193], v[192:193], v[128:129]
  v_pk_mul_f32 v[194:195], v[194:195], v[130:131]
  v_pk_mul_f32 v[196:197], v[196:197], v[144:145]
  v_pk_mul_f32 v[198:199], v[198:199], v[146:147]
  v_exp_f32 v192, v192
  ds_write_b128 v3, v[72:75] offset:32768
  v_exp_f32 v193, v193
  v_exp_f32 v194, v194
  v_exp_f32 v195, v195
  v_exp_f32 v196, v196
  v_exp_f32 v197, v197
  v_exp_f32 v198, v198
  ds_write_b128 v3, v[76:79] offset:49152
  v_exp_f32 v199, v199
  v_pk_fma_f32 v[192:193], v[192:193], v[50:51], v[50:51] op_sel_hi:[1,0,0]
  v_pk_fma_f32 v[194:195], v[194:195], v[50:51], v[50:51] op_sel_hi:[1,0,0]
  v_pk_fma_f32 v[196:197], v[196:197], v[50:51], v[50:51] op_sel_hi:[1,0,0]
  v_pk_fma_f32 v[198:199], v[198:199], v[50:51], v[50:51] op_sel_hi:[1,0,0]
  v_rcp_f32 v192, v192
  ds_write_b128 v3, v[80:83] offset:1024
  v_rcp_f32 v193, v193
  v_rcp_f32 v194, v194
  v_rcp_f32 v195, v195
  v_rcp_f32 v196, v196
  v_rcp_f32 v197, v197
  v_rcp_f32 v198, v198
  ds_write_b128 v3, v[84:87] offset:17408
  v_rcp_f32 v199, v199
  v_pk_mul_f32 v[128:129], v[192:193], v[128:129]
  v_pk_mul_f32 v[130:131], v[194:195], v[130:131]
  v_pk_mul_f32 v[144:145], v[196:197], v[144:145]
  v_pk_mul_f32 v[146:147], v[198:199], v[146:147]
  v_cvt_pk_bf16_f32 v208, v128, v129
  ds_write_b128 v3, v[88:91] offset:33792
  v_cvt_pk_bf16_f32 v209, v130, v131
  v_cvt_pk_bf16_f32 v210, v144, v145
  v_cvt_pk_bf16_f32 v211, v146, v147
  buffer_store_dwordx4 v[208:211], v0, s[52:55], s81 offen offset:0 sc1
  v_pk_mul_f32 v[192:193], v[132:133], v[132:133]
  v_pk_mul_f32 v[194:195], v[134:135], v[134:135]
  ds_write_b128 v3, v[92:95] offset:50176
  v_pk_mul_f32 v[196:197], v[148:149], v[148:149]
  v_pk_mul_f32 v[198:199], v[150:151], v[150:151]
  v_pk_fma_f32 v[192:193], v[192:193], v[52:53], v[52:53] op_sel:[0,0,1] op_sel_hi:[1,0,1]
  v_pk_fma_f32 v[194:195], v[194:195], v[52:53], v[52:53] op_sel:[0,0,1] op_sel_hi:[1,0,1]
  v_pk_fma_f32 v[196:197], v[196:197], v[52:53], v[52:53] op_sel:[0,0,1] op_sel_hi:[1,0,1]
  v_pk_fma_f32 v[198:199], v[198:199], v[52:53], v[52:53] op_sel:[0,0,1] op_sel_hi:[1,0,1]
  v_pk_mul_f32 v[192:193], v[192:193], v[132:133]
  ds_write_b128 v3, v[96:99] offset:2048
  v_pk_mul_f32 v[194:195], v[194:195], v[134:135]
  v_pk_mul_f32 v[196:197], v[196:197], v[148:149]
  v_pk_mul_f32 v[198:199], v[198:199], v[150:151]
  v_exp_f32 v192, v192
  v_exp_f32 v193, v193
  v_exp_f32 v194, v194
  ds_write_b128 v3, v[100:103] offset:18432
  v_exp_f32 v195, v195
  v_exp_f32 v196, v196
  v_exp_f32 v197, v197
  v_exp_f32 v198, v198
  v_exp_f32 v199, v199
  v_pk_fma_f32 v[192:193], v[192:193], v[54:55], v[54:55] op_sel_hi:[1,0,0]
  ds_write_b128 v3, v[104:107] offset:34816
  v_pk_fma_f32 v[194:195], v[194:195], v[54:55], v[54:55] op_sel_hi:[1,0,0]
  v_pk_fma_f32 v[196:197], v[196:197], v[54:55], v[54:55] op_sel_hi:[1,0,0]
  v_pk_fma_f32 v[198:199], v[198:199], v[54:55], v[54:55] op_sel_hi:[1,0,0]
  v_rcp_f32 v192, v192
  v_rcp_f32 v193, v193
  v_rcp_f32 v194, v194
  ds_write_b128 v3, v[108:111] offset:51200
  v_rcp_f32 v195, v195
  v_rcp_f32 v196, v196
  v_rcp_f32 v197, v197
  v_rcp_f32 v198, v198
  v_rcp_f32 v199, v199
  v_pk_mul_f32 v[132:133], v[192:193], v[132:133]
  ds_write_b128 v3, v[112:115] offset:3072
  v_pk_mul_f32 v[134:135], v[194:195], v[134:135]
  v_pk_mul_f32 v[148:149], v[196:197], v[148:149]
  v_pk_mul_f32 v[150:151], v[198:199], v[150:151]
  v_cvt_pk_bf16_f32 v212, v132, v133
  v_cvt_pk_bf16_f32 v213, v134, v135
  v_cvt_pk_bf16_f32 v214, v148, v149
  ds_write_b128 v3, v[116:119] offset:19456
  v_cvt_pk_bf16_f32 v215, v150, v151
  buffer_store_dwordx4 v[212:215], v0, s[52:55], s81 offen offset:1024 sc1
  v_pk_mul_f32 v[192:193], v[136:137], v[136:137]
  v_pk_mul_f32 v[194:195], v[138:139], v[138:139]
  v_pk_mul_f32 v[196:197], v[152:153], v[152:153]
  v_pk_mul_f32 v[198:199], v[154:155], v[154:155]
  ds_write_b128 v3, v[120:123] offset:35840
  v_pk_fma_f32 v[192:193], v[192:193], v[56:57], v[56:57] op_sel:[0,0,1] op_sel_hi:[1,0,1]
  v_pk_fma_f32 v[194:195], v[194:195], v[56:57], v[56:57] op_sel:[0,0,1] op_sel_hi:[1,0,1]
  v_pk_fma_f32 v[196:197], v[196:197], v[56:57], v[56:57] op_sel:[0,0,1] op_sel_hi:[1,0,1]
  v_pk_fma_f32 v[198:199], v[198:199], v[56:57], v[56:57] op_sel:[0,0,1] op_sel_hi:[1,0,1]
  v_pk_mul_f32 v[192:193], v[192:193], v[136:137]
  v_pk_mul_f32 v[194:195], v[194:195], v[138:139]
  ds_write_b128 v3, v[124:127] offset:52224
  v_pk_mul_f32 v[196:197], v[196:197], v[152:153]
  v_pk_mul_f32 v[198:199], v[198:199], v[154:155]
  v_exp_f32 v192, v192
  v_exp_f32 v193, v193
  v_exp_f32 v194, v194
  v_exp_f32 v195, v195
  v_exp_f32 v196, v196
  s_waitcnt vmcnt(19)
  ds_read_b64_tr_b16 a[0:1], v4 offset:0
  ds_read_b64_tr_b16 a[2:3], v4 offset:4096
  v_exp_f32 v197, v197
  v_exp_f32 v198, v198
  v_exp_f32 v199, v199
  v_pk_fma_f32 v[192:193], v[192:193], v[58:59], v[58:59] op_sel_hi:[1,0,0]
  v_pk_fma_f32 v[194:195], v[194:195], v[58:59], v[58:59] op_sel_hi:[1,0,0]
  v_pk_fma_f32 v[196:197], v[196:197], v[58:59], v[58:59] op_sel_hi:[1,0,0]
  ds_read_b64_tr_b16 a[4:5], v5 offset:0
  ds_read_b64_tr_b16 a[6:7], v5 offset:4096
  v_pk_fma_f32 v[198:199], v[198:199], v[58:59], v[58:59] op_sel_hi:[1,0,0]
  v_rcp_f32 v192, v192
  v_rcp_f32 v193, v193
  v_rcp_f32 v194, v194
  v_rcp_f32 v195, v195
  v_rcp_f32 v196, v196
  ds_read_b64_tr_b16 a[8:9], v6 offset:0
  ds_read_b64_tr_b16 a[10:11], v6 offset:4096
  v_rcp_f32 v197, v197
  v_rcp_f32 v198, v198
  v_rcp_f32 v199, v199
  v_pk_mul_f32 v[136:137], v[192:193], v[136:137]
  v_pk_mul_f32 v[138:139], v[194:195], v[138:139]
  v_pk_mul_f32 v[152:153], v[196:197], v[152:153]
  ds_read_b64_tr_b16 a[12:13], v7 offset:0
  ds_read_b64_tr_b16 a[14:15], v7 offset:4096
  v_pk_mul_f32 v[154:155], v[198:199], v[154:155]
  v_cvt_pk_bf16_f32 v216, v136, v137
  v_cvt_pk_bf16_f32 v217, v138, v139
  v_cvt_pk_bf16_f32 v218, v152, v153
  v_cvt_pk_bf16_f32 v219, v154, v155
  buffer_store_dwordx4 v[216:219], v0, s[52:55], s81 offen offset:2048 sc1
  ds_read_b64_tr_b16 a[16:17], v8 offset:0
  ds_read_b64_tr_b16 a[18:19], v8 offset:4096
  v_pk_mul_f32 v[192:193], v[140:141], v[140:141]
  v_pk_mul_f32 v[194:195], v[142:143], v[142:143]
  v_pk_mul_f32 v[196:197], v[156:157], v[156:157]
  v_pk_mul_f32 v[198:199], v[158:159], v[158:159]
  v_pk_fma_f32 v[192:193], v[192:193], v[60:61], v[60:61] op_sel:[0,0,1] op_sel_hi:[1,0,1]
  v_pk_fma_f32 v[194:195], v[194:195], v[60:61], v[60:61] op_sel:[0,0,1] op_sel_hi:[1,0,1]
  ds_read_b64_tr_b16 a[20:21], v9 offset:0
  ds_read_b64_tr_b16 a[22:23], v9 offset:4096
  v_pk_fma_f32 v[196:197], v[196:197], v[60:61], v[60:61] op_sel:[0,0,1] op_sel_hi:[1,0,1]
  v_pk_fma_f32 v[198:199], v[198:199], v[60:61], v[60:61] op_sel:[0,0,1] op_sel_hi:[1,0,1]
  v_pk_mul_f32 v[192:193], v[192:193], v[140:141]
  v_pk_mul_f32 v[194:195], v[194:195], v[142:143]
  v_pk_mul_f32 v[196:197], v[196:197], v[156:157]
  v_pk_mul_f32 v[198:199], v[198:199], v[158:159]
  ds_read_b64_tr_b16 a[24:25], v10 offset:0
  ds_read_b64_tr_b16 a[26:27], v10 offset:4096
  v_exp_f32 v192, v192
  v_exp_f32 v193, v193
  v_exp_f32 v194, v194
  v_exp_f32 v195, v195
  v_exp_f32 v196, v196
  v_exp_f32 v197, v197
  ds_read_b64_tr_b16 a[28:29], v11 offset:0
  ds_read_b64_tr_b16 a[30:31], v11 offset:4096
  v_exp_f32 v198, v198
  v_exp_f32 v199, v199
  v_pk_fma_f32 v[192:193], v[192:193], v[62:63], v[62:63] op_sel_hi:[1,0,0]
  v_pk_fma_f32 v[194:195], v[194:195], v[62:63], v[62:63] op_sel_hi:[1,0,0]
  v_pk_fma_f32 v[196:197], v[196:197], v[62:63], v[62:63] op_sel_hi:[1,0,0]
  v_pk_fma_f32 v[198:199], v[198:199], v[62:63], v[62:63] op_sel_hi:[1,0,0]
  v_rcp_f32 v192, v192
  v_rcp_f32 v193, v193
  v_rcp_f32 v194, v194
  v_rcp_f32 v195, v195
  v_rcp_f32 v196, v196
  v_rcp_f32 v197, v197
  v_rcp_f32 v198, v198
  v_rcp_f32 v199, v199
  v_pk_mul_f32 v[140:141], v[192:193], v[140:141]
  v_pk_mul_f32 v[142:143], v[194:195], v[142:143]
  v_pk_mul_f32 v[156:157], v[196:197], v[156:157]
  v_pk_mul_f32 v[158:159], v[198:199], v[158:159]
  v_cvt_pk_bf16_f32 v220, v140, v141
  v_cvt_pk_bf16_f32 v221, v142, v143
  v_cvt_pk_bf16_f32 v222, v156, v157
  v_cvt_pk_bf16_f32 v223, v158, v159
  buffer_store_dwordx4 v[220:223], v0, s[52:55], s81 offen offset:3072 sc1
  s_waitcnt lgkmcnt(0)
  s_barrier
  ds_read_b128 a[64:67], v2 offset:0
  ds_read_b128 a[68:71], v2 offset:16384
  ds_read_b128 a[72:75], v2 offset:32768
  ds_read_b128 a[76:79], v2 offset:49152
  s_cmp_eq_u32 s3, 3
  s_cbranch_scc1 L_w3skip_13
  s_add_u32 s81, s81, 4096
  v_pk_mul_f32 v[192:193], v[160:161], v[160:161]
  v_pk_mul_f32 v[194:195], v[162:163], v[162:163]
  v_pk_mul_f32 v[196:197], v[176:177], v[176:177]
  v_pk_mul_f32 v[198:199], v[178:179], v[178:179]
  v_pk_fma_f32 v[192:193], v[192:193], v[48:49], v[48:49] op_sel:[0,0,1] op_sel_hi:[1,0,1]
  v_pk_fma_f32 v[194:195], v[194:195], v[48:49], v[48:49] op_sel:[0,0,1] op_sel_hi:[1,0,1]
  v_pk_fma_f32 v[196:197], v[196:197], v[48:49], v[48:49] op_sel:[0,0,1] op_sel_hi:[1,0,1]
  v_pk_fma_f32 v[198:199], v[198:199], v[48:49], v[48:49] op_sel:[0,0,1] op_sel_hi:[1,0,1]
  v_pk_mul_f32 v[192:193], v[192:193], v[160:161]
  v_pk_mul_f32 v[194:195], v[194:195], v[162:163]
  v_pk_mul_f32 v[196:197], v[196:197], v[176:177]
  v_pk_mul_f32 v[198:199], v[198:199], v[178:179]
  v_exp_f32 v192, v192
  v_exp_f32 v193, v193
  v_exp_f32 v194, v194
  v_exp_f32 v195, v195
  v_exp_f32 v196, v196
  v_exp_f32 v197, v197
  v_exp_f32 v198, v198
  v_exp_f32 v199, v199
  v_pk_fma_f32 v[192:193], v[192:193], v[50:51], v[50:51] op_sel_hi:[1,0,0]
  v_pk_fma_f32 v[194:195], v[194:195], v[50:51], v[50:51] op_sel_hi:[1,0,0]
  v_pk_fma_f32 v[196:197], v[196:197], v[50:51], v[50:51] op_sel_hi:[1,0,0]
  v_pk_fma_f32 v[198:199], v[198:199], v[50:51], v[50:51] op_sel_hi:[1,0,0]
  v_rcp_f32 v192, v192
  v_rcp_f32 v193, v193
  v_rcp_f32 v194, v194
  v_rcp_f32 v195, v195
  v_rcp_f32 v196, v196
  v_rcp_f32 v197, v197
  v_rcp_f32 v198, v198
  v_rcp_f32 v199, v199
  v_pk_mul_f32 v[160:161], v[192:193], v[160:161]
  v_pk_mul_f32 v[162:163], v[194:195], v[162:163]
  v_pk_mul_f32 v[176:177], v[196:197], v[176:177]
  v_pk_mul_f32 v[178:179], v[198:199], v[178:179]
  v_cvt_pk_bf16_f32 v64, v160, v161
  v_cvt_pk_bf16_f32 v65, v162, v163
  v_cvt_pk_bf16_f32 v66, v176, v177
  v_cvt_pk_bf16_f32 v67, v178, v179
  buffer_store_dwordx4 v[64:67], v0, s[52:55], s81 offen offset:0 sc1
  v_pk_mul_f32 v[192:193], v[164:165], v[164:165]
  v_pk_mul_f32 v[194:195], v[166:167], v[166:167]
  v_pk_mul_f32 v[196:197], v[180:181], v[180:181]
  v_pk_mul_f32 v[198:199], v[182:183], v[182:183]
  v_pk_fma_f32 v[192:193], v[192:193], v[52:53], v[52:53] op_sel:[0,0,1] op_sel_hi:[1,0,1]
  v_pk_fma_f32 v[194:195], v[194:195], v[52:53], v[52:53] op_sel:[0,0,1] op_sel_hi:[1,0,1]
  v_pk_fma_f32 v[196:197], v[196:197], v[52:53], v[52:53] op_sel:[0,0,1] op_sel_hi:[1,0,1]
  v_pk_fma_f32 v[198:199], v[198:199], v[52:53], v[52:53] op_sel:[0,0,1] op_sel_hi:[1,0,1]
  v_pk_mul_f32 v[192:193], v[192:193], v[164:165]
  v_pk_mul_f32 v[194:195], v[194:195], v[166:167]
  v_pk_mul_f32 v[196:197], v[196:197], v[180:181]
  v_pk_mul_f32 v[198:199], v[198:199], v[182:183]
  v_exp_f32 v192, v192
  v_exp_f32 v193, v193
  v_exp_f32 v194, v194
  v_exp_f32 v195, v195
  v_exp_f32 v196, v196
  v_exp_f32 v197, v197
  v_exp_f32 v198, v198
  v_exp_f32 v199, v199
  v_pk_fma_f32 v[192:193], v[192:193], v[54:55], v[54:55] op_sel_hi:[1,0,0]
  v_pk_fma_f32 v[194:195], v[194:195], v[54:55], v[54:55] op_sel_hi:[1,0,0]
  v_pk_fma_f32 v[196:197], v[196:197], v[54:55], v[54:55] op_sel_hi:[1,0,0]
  v_pk_fma_f32 v[198:199], v[198:199], v[54:55], v[54:55] op_sel_hi:[1,0,0]
  v_rcp_f32 v192, v192
  v_rcp_f32 v193, v193
  v_rcp_f32 v194, v194
  v_rcp_f32 v195, v195
  v_rcp_f32 v196, v196
  v_rcp_f32 v197, v197
  v_rcp_f32 v198, v198
  v_rcp_f32 v199, v199
  v_pk_mul_f32 v[164:165], v[192:193], v[164:165]
  v_pk_mul_f32 v[166:167], v[194:195], v[166:167]
  v_pk_mul_f32 v[180:181], v[196:197], v[180:181]
  v_pk_mul_f32 v[182:183], v[198:199], v[182:183]
  v_cvt_pk_bf16_f32 v68, v164, v165
  v_cvt_pk_bf16_f32 v69, v166, v167
  v_cvt_pk_bf16_f32 v70, v180, v181
  v_cvt_pk_bf16_f32 v71, v182, v183
  buffer_store_dwordx4 v[68:71], v0, s[52:55], s81 offen offset:1024 sc1
  v_pk_mul_f32 v[192:193], v[168:169], v[168:169]
  v_pk_mul_f32 v[194:195], v[170:171], v[170:171]
  v_pk_mul_f32 v[196:197], v[184:185], v[184:185]
  v_pk_mul_f32 v[198:199], v[186:187], v[186:187]
  v_pk_fma_f32 v[192:193], v[192:193], v[56:57], v[56:57] op_sel:[0,0,1] op_sel_hi:[1,0,1]
  v_pk_fma_f32 v[194:195], v[194:195], v[56:57], v[56:57] op_sel:[0,0,1] op_sel_hi:[1,0,1]
  v_pk_fma_f32 v[196:197], v[196:197], v[56:57], v[56:57] op_sel:[0,0,1] op_sel_hi:[1,0,1]
  v_pk_fma_f32 v[198:199], v[198:199], v[56:57], v[56:57] op_sel:[0,0,1] op_sel_hi:[1,0,1]
  v_pk_mul_f32 v[192:193], v[192:193], v[168:169]
  v_pk_mul_f32 v[194:195], v[194:195], v[170:171]
  v_pk_mul_f32 v[196:197], v[196:197], v[184:185]
  v_pk_mul_f32 v[198:199], v[198:199], v[186:187]
  v_exp_f32 v192, v192
  v_exp_f32 v193, v193
  v_exp_f32 v194, v194
  v_exp_f32 v195, v195
  v_exp_f32 v196, v196
  v_exp_f32 v197, v197
  v_exp_f32 v198, v198
  v_exp_f32 v199, v199
  v_pk_fma_f32 v[192:193], v[192:193], v[58:59], v[58:59] op_sel_hi:[1,0,0]
  v_pk_fma_f32 v[194:195], v[194:195], v[58:59], v[58:59] op_sel_hi:[1,0,0]
  v_pk_fma_f32 v[196:197], v[196:197], v[58:59], v[58:59] op_sel_hi:[1,0,0]
  v_pk_fma_f32 v[198:199], v[198:199], v[58:59], v[58:59] op_sel_hi:[1,0,0]
  v_rcp_f32 v192, v192
  v_rcp_f32 v193, v193
  v_rcp_f32 v194, v194
  v_rcp_f32 v195, v195
  v_rcp_f32 v196, v196
  v_rcp_f32 v197, v197
  v_rcp_f32 v198, v198
  v_rcp_f32 v199, v199
  v_pk_mul_f32 v[168:169], v[192:193], v[168:169]
  v_pk_mul_f32 v[170:171], v[194:195], v[170:171]
  v_pk_mul_f32 v[184:185], v[196:197], v[184:185]
  v_pk_mul_f32 v[186:187], v[198:199], v[186:187]
  v_cvt_pk_bf16_f32 v72, v168, v169
  v_cvt_pk_bf16_f32 v73, v170, v171
  v_cvt_pk_bf16_f32 v74, v184, v185
  v_cvt_pk_bf16_f32 v75, v186, v187
  buffer_store_dwordx4 v[72:75], v0, s[52:55], s81 offen offset:2048 sc1
  v_pk_mul_f32 v[192:193], v[172:173], v[172:173]
  v_pk_mul_f32 v[194:195], v[174:175], v[174:175]
  v_pk_mul_f32 v[196:197], v[188:189], v[188:189]
  v_pk_mul_f32 v[198:199], v[190:191], v[190:191]
  v_pk_fma_f32 v[192:193], v[192:193], v[60:61], v[60:61] op_sel:[0,0,1] op_sel_hi:[1,0,1]
  v_pk_fma_f32 v[194:195], v[194:195], v[60:61], v[60:61] op_sel:[0,0,1] op_sel_hi:[1,0,1]
  v_pk_fma_f32 v[196:197], v[196:197], v[60:61], v[60:61] op_sel:[0,0,1] op_sel_hi:[1,0,1]
  v_pk_fma_f32 v[198:199], v[198:199], v[60:61], v[60:61] op_sel:[0,0,1] op_sel_hi:[1,0,1]
  v_pk_mul_f32 v[192:193], v[192:193], v[172:173]
  v_pk_mul_f32 v[194:195], v[194:195], v[174:175]
  v_pk_mul_f32 v[196:197], v[196:197], v[188:189]
  v_pk_mul_f32 v[198:199], v[198:199], v[190:191]
  v_exp_f32 v192, v192
  v_exp_f32 v193, v193
  v_exp_f32 v194, v194
  v_exp_f32 v195, v195
  v_exp_f32 v196, v196
  v_exp_f32 v197, v197
  v_exp_f32 v198, v198
  v_exp_f32 v199, v199
  v_pk_fma_f32 v[192:193], v[192:193], v[62:63], v[62:63] op_sel_hi:[1,0,0]
  v_pk_fma_f32 v[194:195], v[194:195], v[62:63], v[62:63] op_sel_hi:[1,0,0]
  v_pk_fma_f32 v[196:197], v[196:197], v[62:63], v[62:63] op_sel_hi:[1,0,0]
  v_pk_fma_f32 v[198:199], v[198:199], v[62:63], v[62:63] op_sel_hi:[1,0,0]
  v_rcp_f32 v192, v192
  v_rcp_f32 v193, v193
  v_rcp_f32 v194, v194
  v_rcp_f32 v195, v195
  v_rcp_f32 v196, v196
  v_rcp_f32 v197, v197
  v_rcp_f32 v198, v198
  v_rcp_f32 v199, v199
  v_pk_mul_f32 v[172:173], v[192:193], v[172:173]
  v_pk_mul_f32 v[174:175], v[194:195], v[174:175]
  v_pk_mul_f32 v[188:189], v[196:197], v[188:189]
  v_pk_mul_f32 v[190:191], v[198:199], v[190:191]
  v_cvt_pk_bf16_f32 v76, v172, v173
  v_cvt_pk_bf16_f32 v77, v174, v175
  v_cvt_pk_bf16_f32 v78, v188, v189
  v_cvt_pk_bf16_f32 v79, v190, v191
  buffer_store_dwordx4 v[76:79], v0, s[52:55], s81 offen offset:3072 sc1
L_w3skip_13:
  s_waitcnt lgkmcnt(0)
  v_mfma_f32_16x16x32_bf16 v[128:131], a[0:3], a[64:67], 0
  v_accvgpr_write_b32 a96, v208
  v_accvgpr_write_b32 a97, v209
  v_mfma_f32_16x16x32_bf16 v[144:147], a[4:7], a[64:67], 0
  s_waitcnt lgkmcnt(0)
  v_accvgpr_write_b32 a98, v210
  v_mfma_f32_16x16x32_bf16 v[148:151], a[4:7], a[68:71], 0
  s_add_u32 m0, s61, 0
  v_accvgpr_write_b32 a99, v211
  v_mfma_f32_16x16x32_bf16 v[132:135], a[0:3], a[68:71], 0
  buffer_load_dwordx4 v24, s[24:27], s60 offen offset:0  lds
  v_accvgpr_write_b32 a100, v212
  v_mfma_f32_16x16x32_bf16 v[136:139], a[0:3], a[72:75], 0
  v_accvgpr_write_b32 a101, v213
  v_mfma_f32_16x16x32_bf16 v[152:155], a[4:7], a[72:75], 0
  v_accvgpr_write_b32 a102, v214
  v_mfma_f32_16x16x32_bf16 v[156:159], a[4:7], a[76:79], 0
  buffer_load_dwordx4 v25, s[24:27], s60 offen offset:1024  lds
  v_accvgpr_write_b32 a103, v215
  v_mfma_f32_16x16x32_bf16 v[140:143], a[0:3], a[76:79], 0
  v_accvgpr_write_b32 a104, v216
  v_mfma_f32_16x16x32_bf16 v[168:171], a[8:11], a[72:75], 0
  s_waitcnt vmcnt(15)
  v_accvgpr_write_b32 a105, v217
  v_mfma_f32_16x16x32_bf16 v[184:187], a[12:15], a[72:75], 0
  ds_read_b128 a[80:83], v2 offset:1024
  ds_read_b128 a[84:87], v2 offset:17408
  v_accvgpr_write_b32 a106, v218
  v_mfma_f32_16x16x32_bf16 v[188:191], a[12:15], a[76:79], 0
  buffer_load_dwordx4 v26, s[24:27], s60 offen offset:2048  lds
  v_accvgpr_write_b32 a107, v219
  v_mfma_f32_16x16x32_bf16 v[172:175], a[8:11], a[76:79], 0
  ds_read_b64_tr_b16 a[32:33], v4 offset:32768
  ds_read_b64_tr_b16 a[34:35], v4 offset:36864
  v_accvgpr_write_b32 a108, v220
  v_mfma_f32_16x16x32_bf16 v[160:163], a[8:11], a[64:67], 0
  v_accvgpr_write_b32 a109, v221
  v_mfma_f32_16x16x32_bf16 v[176:179], a[12:15], a[64:67], 0
  ds_read_b128 a[88:91], v2 offset:33792
  ds_read_b128 a[92:95], v2 offset:50176
  v_accvgpr_write_b32 a110, v222
  v_mfma_f32_16x16x32_bf16 v[180:183], a[12:15], a[68:71], 0
  buffer_load_dwordx4 v27, s[24:27], s60 offen offset:3072  lds
  v_accvgpr_write_b32 a111, v223
  v_mfma_f32_16x16x32_bf16 v[164:167], a[8:11], a[68:71], 0
  ds_read_b64_tr_b16 a[36:37], v5 offset:32768
  ds_read_b64_tr_b16 a[38:39], v5 offset:36864
  v_mfma_f32_16x16x32_bf16 v[192:195], a[16:19], a[64:67], 0
  s_add_u32 s60, s60, 16384
  v_mfma_f32_16x16x32_bf16 v[208:211], a[20:23], a[64:67], 0
  s_add_u32 m0, s61, 4096
  v_mfma_f32_16x16x32_bf16 v[212:215], a[20:23], a[68:71], 0
  buffer_load_dwordx4 v24, s[24:27], s60 offen offset:0  lds
  v_mfma_f32_16x16x32_bf16 v[196:199], a[16:19], a[68:71], 0
  ds_read_b64_tr_b16 a[40:41], v6 offset:32768
  ds_read_b64_tr_b16 a[42:43], v6 offset:36864
  v_mfma_f32_16x16x32_bf16 v[200:203], a[16:19], a[72:75], 0
  v_mfma_f32_16x16x32_bf16 v[216:219], a[20:23], a[72:75], 0
  ds_read_b64_tr_b16 a[44:45], v7 offset:32768
  ds_read_b64_tr_b16 a[46:47], v7 offset:36864
  v_mfma_f32_16x16x32_bf16 v[220:223], a[20:23], a[76:79], 0
  buffer_load_dwordx4 v25, s[24:27], s60 offen offset:1024  lds
  v_mfma_f32_16x16x32_bf16 v[204:207], a[16:19], a[76:79], 0
  ds_read_b64_tr_b16 a[48:49], v8 offset:32768
  ds_read_b64_tr_b16 a[50:51], v8 offset:36864
  v_mfma_f32_16x16x32_bf16 v[232:235], a[24:27], a[72:75], 0
  ds_read_b64_tr_b16 a[52:53], v9 offset:32768
  ds_read_b64_tr_b16 a[54:55], v9 offset:36864
  v_mfma_f32_16x16x32_bf16 v[248:251], a[28:31], a[72:75], 0
  ds_read_b64_tr_b16 a[56:57], v10 offset:32768
  ds_read_b64_tr_b16 a[58:59], v10 offset:36864
  v_mfma_f32_16x16x32_bf16 v[252:255], a[28:31], a[76:79], 0
  buffer_load_dwordx4 v26, s[24:27], s60 offen offset:2048  lds
  v_mfma_f32_16x16x32_bf16 v[236:239], a[24:27], a[76:79], 0
  ds_read_b64_tr_b16 a[60:61], v11 offset:32768
  ds_read_b64_tr_b16 a[62:63], v11 offset:36864
  v_mfma_f32_16x16x32_bf16 v[224:227], a[24:27], a[64:67], 0
  v_mfma_f32_16x16x32_bf16 v[240:243], a[28:31], a[64:67], 0
  v_mfma_f32_16x16x32_bf16 v[244:247], a[28:31], a[68:71], 0
  buffer_load_dwordx4 v27, s[24:27], s60 offen offset:3072  lds
  v_mfma_f32_16x16x32_bf16 v[228:231], a[24:27], a[68:71], 0
  s_add_u32 s60, s60, 16384
  s_waitcnt lgkmcnt(8)
  v_mfma_f32_16x16x32_bf16 v[128:131], a[32:35], a[80:83], v[128:131]
  v_mfma_f32_16x16x32_bf16 v[144:147], a[36:39], a[80:83], v[144:147]
  s_waitcnt lgkmcnt(0)
  v_mfma_f32_16x16x32_bf16 v[148:151], a[36:39], a[84:87], v[148:151]
  s_add_u32 m0, s61, 32768
  v_accvgpr_write_b32 a112, v64
  v_mfma_f32_16x16x32_bf16 v[132:135], a[32:35], a[84:87], v[132:135]
  buffer_load_dwordx4 v24, s[24:27], s60 offen offset:0  lds
  v_accvgpr_write_b32 a113, v65
  v_mfma_f32_16x16x32_bf16 v[136:139], a[32:35], a[88:91], v[136:139]
  v_mfma_f32_16x16x32_bf16 v[152:155], a[36:39], a[88:91], v[152:155]
  v_accvgpr_write_b32 a114, v66
  v_mfma_f32_16x16x32_bf16 v[156:159], a[36:39], a[92:95], v[156:159]
  buffer_load_dwordx4 v25, s[24:27], s60 offen offset:1024  lds
  v_mfma_f32_16x16x32_bf16 v[140:143], a[32:35], a[92:95], v[140:143]
  v_accvgpr_write_b32 a115, v67
  v_mfma_f32_16x16x32_bf16 v[168:171], a[40:43], a[88:91], v[168:171]
  s_waitcnt vmcnt(14)
  v_mfma_f32_16x16x32_bf16 v[184:187], a[44:47], a[88:91], v[184:187]
  ds_read_b128 a[64:67], v2 offset:2048
  ds_read_b128 a[68:71], v2 offset:18432
  v_accvgpr_write_b32 a116, v68
  v_mfma_f32_16x16x32_bf16 v[188:191], a[44:47], a[92:95], v[188:191]
  buffer_load_dwordx4 v26, s[24:27], s60 offen offset:2048  lds
  v_accvgpr_write_b32 a117, v69
  v_mfma_f32_16x16x32_bf16 v[172:175], a[40:43], a[92:95], v[172:175]
  ds_read_b64_tr_b16 a[0:1], v12 offset:0
  ds_read_b64_tr_b16 a[2:3], v12 offset:4096
  v_mfma_f32_16x16x32_bf16 v[160:163], a[40:43], a[80:83], v[160:163]
  v_accvgpr_write_b32 a118, v70
  v_mfma_f32_16x16x32_bf16 v[176:179], a[44:47], a[80:83], v[176:179]
  ds_read_b128 a[72:75], v2 offset:34816
  ds_read_b128 a[76:79], v2 offset:51200
  v_mfma_f32_16x16x32_bf16 v[180:183], a[44:47], a[84:87], v[180:183]
  buffer_load_dwordx4 v27, s[24:27], s60 offen offset:3072  lds
  v_accvgpr_write_b32 a119, v71
  v_mfma_f32_16x16x32_bf16 v[164:167], a[40:43], a[84:87], v[164:167]
  ds_read_b64_tr_b16 a[4:5], v13 offset:0
  ds_read_b64_tr_b16 a[6:7], v13 offset:4096
  v_mfma_f32_16x16x32_bf16 v[192:195], a[48:51], a[80:83], v[192:195]
  s_add_u32 s60, s60, 16384
  v_accvgpr_write_b32 a120, v72
  v_mfma_f32_16x16x32_bf16 v[208:211], a[52:55], a[80:83], v[208:211]
  s_add_u32 m0, s61, 36864
  v_accvgpr_write_b32 a121, v73
  v_mfma_f32_16x16x32_bf16 v[212:215], a[52:55], a[84:87], v[212:215]
  buffer_load_dwordx4 v24, s[24:27], s60 offen offset:0  lds
  v_mfma_f32_16x16x32_bf16 v[196:199], a[48:51], a[84:87], v[196:199]
  ds_read_b64_tr_b16 a[8:9], v14 offset:0
  ds_read_b64_tr_b16 a[10:11], v14 offset:4096
  v_accvgpr_write_b32 a122, v74
  v_mfma_f32_16x16x32_bf16 v[200:203], a[48:51], a[88:91], v[200:203]
  v_mfma_f32_16x16x32_bf16 v[216:219], a[52:55], a[88:91], v[216:219]
  ds_read_b64_tr_b16 a[12:13], v15 offset:0
  ds_read_b64_tr_b16 a[14:15], v15 offset:4096
  v_accvgpr_write_b32 a123, v75
  v_mfma_f32_16x16x32_bf16 v[220:223], a[52:55], a[92:95], v[220:223]
  buffer_load_dwordx4 v25, s[24:27], s60 offen offset:1024  lds
  v_mfma_f32_16x16x32_bf16 v[204:207], a[48:51], a[92:95], v[204:207]
  ds_read_b64_tr_b16 a[16:17], v16 offset:0
  ds_read_b64_tr_b16 a[18:19], v16 offset:4096
  v_accvgpr_write_b32 a124, v76
  v_mfma_f32_16x16x32_bf16 v[232:235], a[56:59], a[88:91], v[232:235]
  ds_read_b64_tr_b16 a[20:21], v17 offset:0
  ds_read_b64_tr_b16 a[22:23], v17 offset:4096
  v_accvgpr_write_b32 a125, v77
  v_mfma_f32_16x16x32_bf16 v[248:251], a[60:63], a[88:91], v[248:251]
  ds_read_b64_tr_b16 a[24:25], v18 offset:0
  ds_read_b64_tr_b16 a[26:27], v18 offset:4096
  v_mfma_f32_16x16x32_bf16 v[252:255], a[60:63], a[92:95], v[252:255]
  buffer_load_dwordx4 v26, s[24:27], s60 offen offset:2048  lds
  v_accvgpr_write_b32 a126, v78
  v_mfma_f32_16x16x32_bf16 v[236:239], a[56:59], a[92:95], v[236:239]
  ds_read_b64_tr_b16 a[28:29], v19 offset:0
  ds_read_b64_tr_b16 a[30:31], v19 offset:4096
  v_mfma_f32_16x16x32_bf16 v[224:227], a[56:59], a[80:83], v[224:227]
  v_accvgpr_write_b32 a127, v79
  v_mfma_f32_16x16x32_bf16 v[240:243], a[60:63], a[80:83], v[240:243]
  v_mfma_f32_16x16x32_bf16 v[244:247], a[60:63], a[84:87], v[244:247]
  buffer_load_dwordx4 v27, s[24:27], s60 offen offset:3072  lds
  s_mul_i32 s97, s95, 7
  s_and_b32 s58, s95, 1
  s_lshl_b32 s96, s3, 1
  s_add_u32 s96, s96, s58
  s_cmp_eq_u32 s96, 7
  s_cselect_b32 s96, 0, s96
  s_add_u32 s96, s96, s97
  v_mfma_f32_16x16x32_bf16 v[228:231], a[56:59], a[84:87], v[228:231]
  s_add_u32 s60, s60, 16384
  s_waitcnt lgkmcnt(8)
  v_mfma_f32_16x16x32_bf16 v[128:131], a[0:3], a[64:67], v[128:131]
  v_mfma_f32_16x16x32_bf16 v[144:147], a[4:7], a[64:67], v[144:147]
  s_waitcnt lgkmcnt(0)
  v_mfma_f32_16x16x32_bf16 v[148:151], a[4:7], a[68:71], v[148:151]
  s_add_u32 m0, s61, 65536
  v_mfma_f32_16x16x32_bf16 v[132:135], a[0:3], a[68:71], v[132:135]
  buffer_load_dwordx4 v24, s[24:27], s60 offen offset:0  lds
  v_mfma_f32_16x16x32_bf16 v[136:139], a[0:3], a[72:75], v[136:139]
  v_mfma_f32_16x16x32_bf16 v[152:155], a[4:7], a[72:75], v[152:155]
  v_mfma_f32_16x16x32_bf16 v[156:159], a[4:7], a[76:79], v[156:159]
  buffer_load_dwordx4 v25, s[24:27], s60 offen offset:1024  lds
  v_mfma_f32_16x16x32_bf16 v[140:143], a[0:3], a[76:79], v[140:143]
  v_mfma_f32_16x16x32_bf16 v[168:171], a[8:11], a[72:75], v[168:171]
  s_waitcnt vmcnt(10)
  s_barrier
  s_mov_b32 s56, s3
  s_cmp_lg_u32 s56, 0
  s_cbranch_scc1 L_sig_14
  v_mov_b32 v30, s89
  v_mov_b32 v31, 1
  s_mov_b64 exec, 1
  buffer_store_dword v31, v30, s[52:55], 0 offen offset:0 sc1
  s_mov_b64 exec, -1
L_sig_14:
  v_mfma_f32_16x16x32_bf16 v[184:187], a[12:15], a[72:75], v[184:187]
  ds_read_b128 a[80:83], v2 offset:3072
  ds_read_b128 a[84:87], v2 offset:19456
  v_mfma_f32_16x16x32_bf16 v[188:191], a[12:15], a[76:79], v[188:191]
  buffer_load_dwordx4 v26, s[24:27], s60 offen offset:2048  lds
  v_mfma_f32_16x16x32_bf16 v[172:175], a[8:11], a[76:79], v[172:175]
  ds_read_b64_tr_b16 a[32:33], v4 offset:0
  ds_read_b64_tr_b16 a[34:35], v4 offset:4096
  v_mfma_f32_16x16x32_bf16 v[160:163], a[8:11], a[64:67], v[160:163]
  v_mfma_f32_16x16x32_bf16 v[176:179], a[12:15], a[64:67], v[176:179]
  ds_read_b128 a[88:91], v2 offset:35840
  ds_read_b128 a[92:95], v2 offset:52224
  v_mfma_f32_16x16x32_bf16 v[180:183], a[12:15], a[68:71], v[180:183]
  buffer_load_dwordx4 v27, s[24:27], s60 offen offset:3072  lds
  v_mfma_f32_16x16x32_bf16 v[164:167], a[8:11], a[68:71], v[164:167]
  ds_read_b64_tr_b16 a[36:37], v5 offset:0
  ds_read_b64_tr_b16 a[38:39], v5 offset:4096
  v_mfma_f32_16x16x32_bf16 v[192:195], a[16:19], a[64:67], v[192:195]
  s_add_u32 s60, s60, 16384
  v_mfma_f32_16x16x32_bf16 v[208:211], a[20:23], a[64:67], v[208:211]
  s_add_u32 m0, s61, 69632
  v_mfma_f32_16x16x32_bf16 v[212:215], a[20:23], a[68:71], v[212:215]
  buffer_load_dwordx4 v24, s[24:27], s60 offen offset:0  lds
  v_mfma_f32_16x16x32_bf16 v[196:199], a[16:19], a[68:71], v[196:199]
  ds_read_b64_tr_b16 a[40:41], v6 offset:0
  ds_read_b64_tr_b16 a[42:43], v6 offset:4096
  v_mfma_f32_16x16x32_bf16 v[200:203], a[16:19], a[72:75], v[200:203]
  v_mfma_f32_16x16x32_bf16 v[216:219], a[20:23], a[72:75], v[216:219]
  ds_read_b64_tr_b16 a[44:45], v7 offset:0
  ds_read_b64_tr_b16 a[46:47], v7 offset:4096
  v_mfma_f32_16x16x32_bf16 v[220:223], a[20:23], a[76:79], v[220:223]
  buffer_load_dwordx4 v25, s[24:27], s60 offen offset:1024  lds
  v_mfma_f32_16x16x32_bf16 v[204:207], a[16:19], a[76:79], v[204:207]
  ds_read_b64_tr_b16 a[48:49], v8 offset:0
  ds_read_b64_tr_b16 a[50:51], v8 offset:4096
  v_mfma_f32_16x16x32_bf16 v[232:235], a[24:27], a[72:75], v[232:235]
  ds_read_b64_tr_b16 a[52:53], v9 offset:0
  ds_read_b64_tr_b16 a[54:55], v9 offset:4096
  v_mfma_f32_16x16x32_bf16 v[248:251], a[28:31], a[72:75], v[248:251]
  ds_read_b64_tr_b16 a[56:57], v10 offset:0
  ds_read_b64_tr_b16 a[58:59], v10 offset:4096
  v_mfma_f32_16x16x32_bf16 v[252:255], a[28:31], a[76:79], v[252:255]
  buffer_load_dwordx4 v26, s[24:27], s60 offen offset:2048  lds
  v_mfma_f32_16x16x32_bf16 v[236:239], a[24:27], a[76:79], v[236:239]
  ds_read_b64_tr_b16 a[60:61], v11 offset:0
  ds_read_b64_tr_b16 a[62:63], v11 offset:4096
  v_mfma_f32_16x16x32_bf16 v[224:227], a[24:27], a[64:67], v[224:227]
  v_mfma_f32_16x16x32_bf16 v[240:243], a[28:31], a[64:67], v[240:243]
  v_mfma_f32_16x16x32_bf16 v[244:247], a[28:31], a[68:71], v[244:247]
  buffer_load_dwordx4 v27, s[24:27], s60 offen offset:3072  lds
  v_mfma_f32_16x16x32_bf16 v[228:231], a[24:27], a[68:71], v[228:231]
  s_add_u32 s60, s60, 16384
  s_waitcnt lgkmcnt(8)
  v_mfma_f32_16x16x32_bf16 v[128:131], a[32:35], a[80:83], v[128:131]
  v_mfma_f32_16x16x32_bf16 v[144:147], a[36:39], a[80:83], v[144:147]
  s_waitcnt lgkmcnt(0)
  v_mfma_f32_16x16x32_bf16 v[148:151], a[36:39], a[84:87], v[148:151]
  s_add_u32 m0, s61, 0
  v_mfma_f32_16x16x32_bf16 v[132:135], a[32:35], a[84:87], v[132:135]
  buffer_load_dwordx4 v24, s[24:27], s60 offen offset:0  lds
  v_mfma_f32_16x16x32_bf16 v[136:139], a[32:35], a[88:91], v[136:139]
  v_mfma_f32_16x16x32_bf16 v[152:155], a[36:39], a[88:91], v[152:155]
  v_mfma_f32_16x16x32_bf16 v[156:159], a[36:39], a[92:95], v[156:159]
  buffer_load_dwordx4 v25, s[24:27], s60 offen offset:1024  lds
  v_mfma_f32_16x16x32_bf16 v[140:143], a[32:35], a[92:95], v[140:143]
  v_mfma_f32_16x16x32_bf16 v[168:171], a[40:43], a[88:91], v[168:171]
  s_waitcnt vmcnt(10)
  v_mfma_f32_16x16x32_bf16 v[184:187], a[44:47], a[88:91], v[184:187]
  ds_read_b128 a[64:67], v2 offset:4096
  ds_read_b128 a[68:71], v2 offset:20480
  v_mfma_f32_16x16x32_bf16 v[188:191], a[44:47], a[92:95], v[188:191]
  buffer_load_dwordx4 v26, s[24:27], s60 offen offset:2048  lds
  v_mfma_f32_16x16x32_bf16 v[172:175], a[40:43], a[92:95], v[172:175]
  ds_read_b64_tr_b16 a[0:1], v4 offset:32768
  ds_read_b64_tr_b16 a[2:3], v4 offset:36864
  v_mfma_f32_16x16x32_bf16 v[160:163], a[40:43], a[80:83], v[160:163]
  v_mfma_f32_16x16x32_bf16 v[176:179], a[44:47], a[80:83], v[176:179]
  ds_read_b128 a[72:75], v2 offset:36864
  ds_read_b128 a[76:79], v2 offset:53248
  v_mfma_f32_16x16x32_bf16 v[180:183], a[44:47], a[84:87], v[180:183]
  buffer_load_dwordx4 v27, s[24:27], s60 offen offset:3072  lds
  v_mfma_f32_16x16x32_bf16 v[164:167], a[40:43], a[84:87], v[164:167]
  ds_read_b64_tr_b16 a[4:5], v5 offset:32768
  ds_read_b64_tr_b16 a[6:7], v5 offset:36864
  v_mfma_f32_16x16x32_bf16 v[192:195], a[48:51], a[80:83], v[192:195]
  s_add_u32 s60, s60, 16384
  v_mfma_f32_16x16x32_bf16 v[208:211], a[52:55], a[80:83], v[208:211]
  s_add_u32 m0, s61, 4096
  v_mfma_f32_16x16x32_bf16 v[212:215], a[52:55], a[84:87], v[212:215]
  buffer_load_dwordx4 v24, s[24:27], s60 offen offset:0  lds
  v_mfma_f32_16x16x32_bf16 v[196:199], a[48:51], a[84:87], v[196:199]
  ds_read_b64_tr_b16 a[8:9], v6 offset:32768
  ds_read_b64_tr_b16 a[10:11], v6 offset:36864
  v_mfma_f32_16x16x32_bf16 v[200:203], a[48:51], a[88:91], v[200:203]
  v_mfma_f32_16x16x32_bf16 v[216:219], a[52:55], a[88:91], v[216:219]
  ds_read_b64_tr_b16 a[12:13], v7 offset:32768
  ds_read_b64_tr_b16 a[14:15], v7 offset:36864
  v_mfma_f32_16x16x32_bf16 v[220:223], a[52:55], a[92:95], v[220:223]
  buffer_load_dwordx4 v25, s[24:27], s60 offen offset:1024  lds
  v_mfma_f32_16x16x32_bf16 v[204:207], a[48:51], a[92:95], v[204:207]
  ds_read_b64_tr_b16 a[16:17], v8 offset:32768
  ds_read_b64_tr_b16 a[18:19], v8 offset:36864
  v_mfma_f32_16x16x32_bf16 v[232:235], a[56:59], a[88:91], v[232:235]
  ds_read_b64_tr_b16 a[20:21], v9 offset:32768
  ds_read_b64_tr_b16 a[22:23], v9 offset:36864
  v_mfma_f32_16x16x32_bf16 v[248:251], a[60:63], a[88:91], v[248:251]
  ds_read_b64_tr_b16 a[24:25], v10 offset:32768
  ds_read_b64_tr_b16 a[26:27], v10 offset:36864
  v_mfma_f32_16x16x32_bf16 v[252:255], a[60:63], a[92:95], v[252:255]
  buffer_load_dwordx4 v26, s[24:27], s60 offen offset:2048  lds
  v_mfma_f32_16x16x32_bf16 v[236:239], a[56:59], a[92:95], v[236:239]
  ds_read_b64_tr_b16 a[28:29], v11 offset:32768
  ds_read_b64_tr_b16 a[30:31], v11 offset:36864
  v_mfma_f32_16x16x32_bf16 v[224:227], a[56:59], a[80:83], v[224:227]
  v_mfma_f32_16x16x32_bf16 v[240:243], a[60:63], a[80:83], v[240:243]
  v_mfma_f32_16x16x32_bf16 v[244:247], a[60:63], a[84:87], v[244:247]
  buffer_load_dwordx4 v27, s[24:27], s60 offen offset:3072  lds
  v_mfma_f32_16x16x32_bf16 v[228:231], a[56:59], a[84:87], v[228:231]
  s_add_u32 s60, s60, 16384
  s_waitcnt lgkmcnt(8)
  v_mfma_f32_16x16x32_bf16 v[128:131], a[0:3], a[64:67], v[128:131]
  v_mfma_f32_16x16x32_bf16 v[144:147], a[4:7], a[64:67], v[144:147]
  s_waitcnt lgkmcnt(0)
  v_mfma_f32_16x16x32_bf16 v[148:151], a[4:7], a[68:71], v[148:151]
  s_add_u32 m0, s61, 32768
  v_mfma_f32_16x16x32_bf16 v[132:135], a[0:3], a[68:71], v[132:135]
  buffer_load_dwordx4 v24, s[24:27], s60 offen offset:0  lds
  v_mfma_f32_16x16x32_bf16 v[136:139], a[0:3], a[72:75], v[136:139]
  v_mfma_f32_16x16x32_bf16 v[152:155], a[4:7], a[72:75], v[152:155]
  v_mfma_f32_16x16x32_bf16 v[156:159], a[4:7], a[76:79], v[156:159]
  buffer_load_dwordx4 v25, s[24:27], s60 offen offset:1024  lds
  v_mfma_f32_16x16x32_bf16 v[140:143], a[0:3], a[76:79], v[140:143]
  v_mfma_f32_16x16x32_bf16 v[168:171], a[8:11], a[72:75], v[168:171]
  s_waitcnt vmcnt(10)
  v_mfma_f32_16x16x32_bf16 v[184:187], a[12:15], a[72:75], v[184:187]
  ds_read_b128 a[80:83], v2 offset:5120
  ds_read_b128 a[84:87], v2 offset:21504
  v_mfma_f32_16x16x32_bf16 v[188:191], a[12:15], a[76:79], v[188:191]
  buffer_load_dwordx4 v26, s[24:27], s60 offen offset:2048  lds
  v_mfma_f32_16x16x32_bf16 v[172:175], a[8:11], a[76:79], v[172:175]
  ds_read_b64_tr_b16 a[32:33], v12 offset:0
  ds_read_b64_tr_b16 a[34:35], v12 offset:4096
  v_mfma_f32_16x16x32_bf16 v[160:163], a[8:11], a[64:67], v[160:163]
  v_mfma_f32_16x16x32_bf16 v[176:179], a[12:15], a[64:67], v[176:179]
  ds_read_b128 a[88:91], v2 offset:37888
  ds_read_b128 a[92:95], v2 offset:54272
  v_mfma_f32_16x16x32_bf16 v[180:183], a[12:15], a[68:71], v[180:183]
  buffer_load_dwordx4 v27, s[24:27], s60 offen offset:3072  lds
  v_mfma_f32_16x16x32_bf16 v[164:167], a[8:11], a[68:71], v[164:167]
  ds_read_b64_tr_b16 a[36:37], v13 offset:0
  ds_read_b64_tr_b16 a[38:39], v13 offset:4096
  v_mfma_f32_16x16x32_bf16 v[192:195], a[16:19], a[64:67], v[192:195]
  s_add_u32 s60, s60, 16384
  v_mfma_f32_16x16x32_bf16 v[208:211], a[20:23], a[64:67], v[208:211]
  s_add_u32 m0, s61, 36864
  v_mfma_f32_16x16x32_bf16 v[212:215], a[20:23], a[68:71], v[212:215]
  buffer_load_dwordx4 v24, s[24:27], s60 offen offset:0  lds
  v_mfma_f32_16x16x32_bf16 v[196:199], a[16:19], a[68:71], v[196:199]
  ds_read_b64_tr_b16 a[40:41], v14 offset:0
  ds_read_b64_tr_b16 a[42:43], v14 offset:4096
  v_mfma_f32_16x16x32_bf16 v[200:203], a[16:19], a[72:75], v[200:203]
  v_mfma_f32_16x16x32_bf16 v[216:219], a[20:23], a[72:75], v[216:219]
  ds_read_b64_tr_b16 a[44:45], v15 offset:0
  ds_read_b64_tr_b16 a[46:47], v15 offset:4096
  v_mfma_f32_16x16x32_bf16 v[220:223], a[20:23], a[76:79], v[220:223]
  buffer_load_dwordx4 v25, s[24:27], s60 offen offset:1024  lds
  v_mfma_f32_16x16x32_bf16 v[204:207], a[16:19], a[76:79], v[204:207]
  ds_read_b64_tr_b16 a[48:49], v16 offset:0
  ds_read_b64_tr_b16 a[50:51], v16 offset:4096
  v_mfma_f32_16x16x32_bf16 v[232:235], a[24:27], a[72:75], v[232:235]
  ds_read_b64_tr_b16 a[52:53], v17 offset:0
  ds_read_b64_tr_b16 a[54:55], v17 offset:4096
  v_mfma_f32_16x16x32_bf16 v[248:251], a[28:31], a[72:75], v[248:251]
  ds_read_b64_tr_b16 a[56:57], v18 offset:0
  ds_read_b64_tr_b16 a[58:59], v18 offset:4096
  v_mfma_f32_16x16x32_bf16 v[252:255], a[28:31], a[76:79], v[252:255]
  buffer_load_dwordx4 v26, s[24:27], s60 offen offset:2048  lds
  v_mfma_f32_16x16x32_bf16 v[236:239], a[24:27], a[76:79], v[236:239]
  ds_read_b64_tr_b16 a[60:61], v19 offset:0
  ds_read_b64_tr_b16 a[62:63], v19 offset:4096
  v_mfma_f32_16x16x32_bf16 v[224:227], a[24:27], a[64:67], v[224:227]
  v_mfma_f32_16x16x32_bf16 v[240:243], a[28:31], a[64:67], v[240:243]
  v_mfma_f32_16x16x32_bf16 v[244:247], a[28:31], a[68:71], v[244:247]
  buffer_load_dwordx4 v27, s[24:27], s60 offen offset:3072  lds
  v_mfma_f32_16x16x32_bf16 v[228:231], a[24:27], a[68:71], v[228:231]
  s_add_u32 s60, s60, 16384
  s_waitcnt lgkmcnt(8)
  v_mfma_f32_16x16x32_bf16 v[128:131], a[32:35], a[80:83], v[128:131]
  v_mfma_f32_16x16x32_bf16 v[144:147], a[36:39], a[80:83], v[144:147]
  s_waitcnt lgkmcnt(0)
  v_mfma_f32_16x16x32_bf16 v[148:151], a[36:39], a[84:87], v[148:151]
  s_add_u32 m0, s61, 65536
  v_mfma_f32_16x16x32_bf16 v[132:135], a[32:35], a[84:87], v[132:135]
  buffer_load_dwordx4 v24, s[24:27], s60 offen offset:0  lds
  v_mfma_f32_16x16x32_bf16 v[136:139], a[32:35], a[88:91], v[136:139]
  v_mfma_f32_16x16x32_bf16 v[152:155], a[36:39], a[88:91], v[152:155]
  v_mfma_f32_16x16x32_bf16 v[156:159], a[36:39], a[92:95], v[156:159]
  buffer_load_dwordx4 v25, s[24:27], s60 offen offset:1024  lds
  v_mfma_f32_16x16x32_bf16 v[140:143], a[32:35], a[92:95], v[140:143]
  v_mfma_f32_16x16x32_bf16 v[168:171], a[40:43], a[88:91], v[168:171]
  s_waitcnt vmcnt(10)
  v_mfma_f32_16x16x32_bf16 v[184:187], a[44:47], a[88:91], v[184:187]
  ds_read_b128 a[64:67], v2 offset:6144
  ds_read_b128 a[68:71], v2 offset:22528
  v_mfma_f32_16x16x32_bf16 v[188:191], a[44:47], a[92:95], v[188:191]
  buffer_load_dwordx4 v26, s[24:27], s60 offen offset:2048  lds
  v_mfma_f32_16x16x32_bf16 v[172:175], a[40:43], a[92:95], v[172:175]
  ds_read_b64_tr_b16 a[0:1], v4 offset:0
  ds_read_b64_tr_b16 a[2:3], v4 offset:4096
  v_mfma_f32_16x16x32_bf16 v[160:163], a[40:43], a[80:83], v[160:163]
  v_mfma_f32_16x16x32_bf16 v[176:179], a[44:47], a[80:83], v[176:179]
  ds_read_b128 a[72:75], v2 offset:38912
  ds_read_b128 a[76:79], v2 offset:55296
  v_mfma_f32_16x16x32_bf16 v[180:183], a[44:47], a[84:87], v[180:183]
  buffer_load_dwordx4 v27, s[24:27], s60 offen offset:3072  lds
  v_mfma_f32_16x16x32_bf16 v[164:167], a[40:43], a[84:87], v[164:167]
  ds_read_b64_tr_b16 a[4:5], v5 offset:0
  ds_read_b64_tr_b16 a[6:7], v5 offset:4096
  v_mfma_f32_16x16x32_bf16 v[192:195], a[48:51], a[80:83], v[192:195]
  s_add_u32 s60, s60, 16384
  v_mfma_f32_16x16x32_bf16 v[208:211], a[52:55], a[80:83], v[208:211]
  s_add_u32 m0, s61, 69632
  v_mfma_f32_16x16x32_bf16 v[212:215], a[52:55], a[84:87], v[212:215]
  buffer_load_dwordx4 v24, s[24:27], s60 offen offset:0  lds
  v_mfma_f32_16x16x32_bf16 v[196:199], a[48:51], a[84:87], v[196:199]
  ds_read_b64_tr_b16 a[8:9], v6 offset:0
  ds_read_b64_tr_b16 a[10:11], v6 offset:4096
  v_mfma_f32_16x16x32_bf16 v[200:203], a[48:51], a[88:91], v[200:203]
  v_mfma_f32_16x16x32_bf16 v[216:219], a[52:55], a[88:91], v[216:219]
  ds_read_b64_tr_b16 a[12:13], v7 offset:0
  ds_read_b64_tr_b16 a[14:15], v7 offset:4096
  v_mfma_f32_16x16x32_bf16 v[220:223], a[52:55], a[92:95], v[220:223]
  buffer_load_dwordx4 v25, s[24:27], s60 offen offset:1024  lds
  v_mfma_f32_16x16x32_bf16 v[204:207], a[48:51], a[92:95], v[204:207]
  ds_read_b64_tr_b16 a[16:17], v8 offset:0
  ds_read_b64_tr_b16 a[18:19], v8 offset:4096
  v_mfma_f32_16x16x32_bf16 v[232:235], a[56:59], a[88:91], v[232:235]
  ds_read_b64_tr_b16 a[20:21], v9 offset:0
  ds_read_b64_tr_b16 a[22:23], v9 offset:4096
  v_mfma_f32_16x16x32_bf16 v[248:251], a[60:63], a[88:91], v[248:251]
  ds_read_b64_tr_b16 a[24:25], v10 offset:0
  ds_read_b64_tr_b16 a[26:27], v10 offset:4096
  v_mfma_f32_16x16x32_bf16 v[252:255], a[60:63], a[92:95], v[252:255]
  buffer_load_dwordx4 v26, s[24:27], s60 offen offset:2048  lds
  v_mfma_f32_16x16x32_bf16 v[236:239], a[56:59], a[92:95], v[236:239]
  ds_read_b64_tr_b16 a[28:29], v11 offset:0
  ds_read_b64_tr_b16 a[30:31], v11 offset:4096
  v_mfma_f32_16x16x32_bf16 v[224:227], a[56:59], a[80:83], v[224:227]
  v_mfma_f32_16x16x32_bf16 v[240:243], a[60:63], a[80:83], v[240:243]
  v_mfma_f32_16x16x32_bf16 v[244:247], a[60:63], a[84:87], v[244:247]
  buffer_load_dwordx4 v27, s[24:27], s60 offen offset:3072  lds
  v_mfma_f32_16x16x32_bf16 v[228:231], a[56:59], a[84:87], v[228:231]
  s_add_u32 s60, s60, 16384
  s_waitcnt lgkmcnt(8)
  v_mfma_f32_16x16x32_bf16 v[128:131], a[0:3], a[64:67], v[128:131]
  v_mfma_f32_16x16x32_bf16 v[144:147], a[4:7], a[64:67], v[144:147]
  s_waitcnt lgkmcnt(0)
  v_mfma_f32_16x16x32_bf16 v[148:151], a[4:7], a[68:71], v[148:151]
  s_add_u32 m0, s61, 0
  v_mfma_f32_16x16x32_bf16 v[132:135], a[0:3], a[68:71], v[132:135]
  buffer_load_dwordx4 v24, s[24:27], s60 offen offset:0  lds
  v_mfma_f32_16x16x32_bf16 v[136:139], a[0:3], a[72:75], v[136:139]
  v_mfma_f32_16x16x32_bf16 v[152:155], a[4:7], a[72:75], v[152:155]
  v_mfma_f32_16x16x32_bf16 v[156:159], a[4:7], a[76:79], v[156:159]
  buffer_load_dwordx4 v25, s[24:27], s60 offen offset:1024  lds
  v_mfma_f32_16x16x32_bf16 v[140:143], a[0:3], a[76:79], v[140:143]
  v_mfma_f32_16x16x32_bf16 v[168:171], a[8:11], a[72:75], v[168:171]
  s_waitcnt vmcnt(10)
  v_mfma_f32_16x16x32_bf16 v[184:187], a[12:15], a[72:75], v[184:187]
  ds_read_b128 a[80:83], v2 offset:7168
  ds_read_b128 a[84:87], v2 offset:23552
  v_mfma_f32_16x16x32_bf16 v[188:191], a[12:15], a[76:79], v[188:191]
  buffer_load_dwordx4 v26, s[24:27], s60 offen offset:2048  lds
  v_mfma_f32_16x16x32_bf16 v[172:175], a[8:11], a[76:79], v[172:175]
  ds_read_b64_tr_b16 a[32:33], v4 offset:32768
  ds_read_b64_tr_b16 a[34:35], v4 offset:36864
  v_mfma_f32_16x16x32_bf16 v[160:163], a[8:11], a[64:67], v[160:163]
  v_mfma_f32_16x16x32_bf16 v[176:179], a[12:15], a[64:67], v[176:179]
  ds_read_b128 a[88:91], v2 offset:39936
  ds_read_b128 a[92:95], v2 offset:56320
  v_mfma_f32_16x16x32_bf16 v[180:183], a[12:15], a[68:71], v[180:183]
  buffer_load_dwordx4 v27, s[24:27], s60 offen offset:3072  lds
  v_mfma_f32_16x16x32_bf16 v[164:167], a[8:11], a[68:71], v[164:167]
  ds_read_b64_tr_b16 a[36:37], v5 offset:32768
  ds_read_b64_tr_b16 a[38:39], v5 offset:36864
  v_mfma_f32_16x16x32_bf16 v[192:195], a[16:19], a[64:67], v[192:195]
  s_add_u32 s60, s60, 16384
  v_mfma_f32_16x16x32_bf16 v[208:211], a[20:23], a[64:67], v[208:211]
  s_add_u32 m0, s61, 4096
  v_mfma_f32_16x16x32_bf16 v[212:215], a[20:23], a[68:71], v[212:215]
  buffer_load_dwordx4 v24, s[24:27], s60 offen offset:0  lds
  v_mfma_f32_16x16x32_bf16 v[196:199], a[16:19], a[68:71], v[196:199]
  ds_read_b64_tr_b16 a[40:41], v6 offset:32768
  ds_read_b64_tr_b16 a[42:43], v6 offset:36864
  v_mfma_f32_16x16x32_bf16 v[200:203], a[16:19], a[72:75], v[200:203]
  v_mfma_f32_16x16x32_bf16 v[216:219], a[20:23], a[72:75], v[216:219]
  ds_read_b64_tr_b16 a[44:45], v7 offset:32768
  ds_read_b64_tr_b16 a[46:47], v7 offset:36864
  v_mfma_f32_16x16x32_bf16 v[220:223], a[20:23], a[76:79], v[220:223]
  buffer_load_dwordx4 v25, s[24:27], s60 offen offset:1024  lds
  v_mfma_f32_16x16x32_bf16 v[204:207], a[16:19], a[76:79], v[204:207]
  ds_read_b64_tr_b16 a[48:49], v8 offset:32768
  ds_read_b64_tr_b16 a[50:51], v8 offset:36864
  v_mfma_f32_16x16x32_bf16 v[232:235], a[24:27], a[72:75], v[232:235]
  ds_read_b64_tr_b16 a[52:53], v9 offset:32768
  ds_read_b64_tr_b16 a[54:55], v9 offset:36864
  v_mfma_f32_16x16x32_bf16 v[248:251], a[28:31], a[72:75], v[248:251]
  ds_read_b64_tr_b16 a[56:57], v10 offset:32768
  ds_read_b64_tr_b16 a[58:59], v10 offset:36864
  v_mfma_f32_16x16x32_bf16 v[252:255], a[28:31], a[76:79], v[252:255]
  buffer_load_dwordx4 v26, s[24:27], s60 offen offset:2048  lds
  v_mfma_f32_16x16x32_bf16 v[236:239], a[24:27], a[76:79], v[236:239]
  ds_read_b64_tr_b16 a[60:61], v11 offset:32768
  ds_read_b64_tr_b16 a[62:63], v11 offset:36864
  v_mfma_f32_16x16x32_bf16 v[224:227], a[24:27], a[64:67], v[224:227]
  v_mfma_f32_16x16x32_bf16 v[240:243], a[28:31], a[64:67], v[240:243]
  v_mfma_f32_16x16x32_bf16 v[244:247], a[28:31], a[68:71], v[244:247]
  buffer_load_dwordx4 v27, s[24:27], s60 offen offset:3072  lds
  v_mfma_f32_16x16x32_bf16 v[228:231], a[24:27], a[68:71], v[228:231]
  s_add_u32 s60, s60, 16384
  s_waitcnt lgkmcnt(8)
  v_mfma_f32_16x16x32_bf16 v[128:131], a[32:35], a[80:83], v[128:131]
  v_mfma_f32_16x16x32_bf16 v[144:147], a[36:39], a[80:83], v[144:147]
  s_waitcnt lgkmcnt(0)
  v_mfma_f32_16x16x32_bf16 v[148:151], a[36:39], a[84:87], v[148:151]
  s_add_u32 m0, s61, 32768
  v_mfma_f32_16x16x32_bf16 v[132:135], a[32:35], a[84:87], v[132:135]
  buffer_load_dwordx4 v24, s[24:27], s60 offen offset:0  lds
  v_mfma_f32_16x16x32_bf16 v[136:139], a[32:35], a[88:91], v[136:139]
  v_mfma_f32_16x16x32_bf16 v[152:155], a[36:39], a[88:91], v[152:155]
  v_mfma_f32_16x16x32_bf16 v[156:159], a[36:39], a[92:95], v[156:159]
  buffer_load_dwordx4 v25, s[24:27], s60 offen offset:1024  lds
  v_mfma_f32_16x16x32_bf16 v[140:143], a[32:35], a[92:95], v[140:143]
  v_mfma_f32_16x16x32_bf16 v[168:171], a[40:43], a[88:91], v[168:171]
  s_waitcnt vmcnt(10)
  v_mfma_f32_16x16x32_bf16 v[184:187], a[44:47], a[88:91], v[184:187]
  ds_read_b128 a[64:67], v2 offset:8192
  ds_read_b128 a[68:71], v2 offset:24576
  v_mfma_f32_16x16x32_bf16 v[188:191], a[44:47], a[92:95], v[188:191]
  buffer_load_dwordx4 v26, s[24:27], s60 offen offset:2048  lds
  v_mfma_f32_16x16x32_bf16 v[172:175], a[40:43], a[92:95], v[172:175]
  ds_read_b64_tr_b16 a[0:1], v12 offset:0
  ds_read_b64_tr_b16 a[2:3], v12 offset:4096
  v_mfma_f32_16x16x32_bf16 v[160:163], a[40:43], a[80:83], v[160:163]
  v_mfma_f32_16x16x32_bf16 v[176:179], a[44:47], a[80:83], v[176:179]
  ds_read_b128 a[72:75], v2 offset:40960
  ds_read_b128 a[76:79], v2 offset:57344
  v_mfma_f32_16x16x32_bf16 v[180:183], a[44:47], a[84:87], v[180:183]
  buffer_load_dwordx4 v27, s[24:27], s60 offen offset:3072  lds
  v_mfma_f32_16x16x32_bf16 v[164:167], a[40:43], a[84:87], v[164:167]
  ds_read_b64_tr_b16 a[4:5], v13 offset:0
  ds_read_b64_tr_b16 a[6:7], v13 offset:4096
  v_mfma_f32_16x16x32_bf16 v[192:195], a[48:51], a[80:83], v[192:195]
  s_add_u32 s60, s60, 16384
  v_mfma_f32_16x16x32_bf16 v[208:211], a[52:55], a[80:83], v[208:211]
  s_add_u32 m0, s61, 36864
  v_mfma_f32_16x16x32_bf16 v[212:215], a[52:55], a[84:87], v[212:215]
  buffer_load_dwordx4 v24, s[24:27], s60 offen offset:0  lds
  v_mfma_f32_16x16x32_bf16 v[196:199], a[48:51], a[84:87], v[196:199]
  ds_read_b64_tr_b16 a[8:9], v14 offset:0
  ds_read_b64_tr_b16 a[10:11], v14 offset:4096
  v_mfma_f32_16x16x32_bf16 v[200:203], a[48:51], a[88:91], v[200:203]
  v_mfma_f32_16x16x32_bf16 v[216:219], a[52:55], a[88:91], v[216:219]
  ds_read_b64_tr_b16 a[12:13], v15 offset:0
  ds_read_b64_tr_b16 a[14:15], v15 offset:4096
  v_mfma_f32_16x16x32_bf16 v[220:223], a[52:55], a[92:95], v[220:223]
  buffer_load_dwordx4 v25, s[24:27], s60 offen offset:1024  lds
  v_mfma_f32_16x16x32_bf16 v[204:207], a[48:51], a[92:95], v[204:207]
  ds_read_b64_tr_b16 a[16:17], v16 offset:0
  ds_read_b64_tr_b16 a[18:19], v16 offset:4096
  v_mfma_f32_16x16x32_bf16 v[232:235], a[56:59], a[88:91], v[232:235]
  ds_read_b64_tr_b16 a[20:21], v17 offset:0
  ds_read_b64_tr_b16 a[22:23], v17 offset:4096
  v_mfma_f32_16x16x32_bf16 v[248:251], a[60:63], a[88:91], v[248:251]
  ds_read_b64_tr_b16 a[24:25], v18 offset:0
  ds_read_b64_tr_b16 a[26:27], v18 offset:4096
  v_mfma_f32_16x16x32_bf16 v[252:255], a[60:63], a[92:95], v[252:255]
  buffer_load_dwordx4 v26, s[24:27], s60 offen offset:2048  lds
  v_mfma_f32_16x16x32_bf16 v[236:239], a[56:59], a[92:95], v[236:239]
  ds_read_b64_tr_b16 a[28:29], v19 offset:0
  ds_read_b64_tr_b16 a[30:31], v19 offset:4096
  v_mfma_f32_16x16x32_bf16 v[224:227], a[56:59], a[80:83], v[224:227]
  v_mfma_f32_16x16x32_bf16 v[240:243], a[60:63], a[80:83], v[240:243]
  v_mfma_f32_16x16x32_bf16 v[244:247], a[60:63], a[84:87], v[244:247]
  buffer_load_dwordx4 v27, s[24:27], s60 offen offset:3072  lds
  v_mfma_f32_16x16x32_bf16 v[228:231], a[56:59], a[84:87], v[228:231]
  s_add_u32 s60, s60, 16384
  s_waitcnt lgkmcnt(8)
  v_mfma_f32_16x16x32_bf16 v[128:131], a[0:3], a[64:67], v[128:131]
  v_mfma_f32_16x16x32_bf16 v[144:147], a[4:7], a[64:67], v[144:147]
  s_waitcnt lgkmcnt(0)
  v_mfma_f32_16x16x32_bf16 v[148:151], a[4:7], a[68:71], v[148:151]
  s_add_u32 m0, s61, 65536
  v_mfma_f32_16x16x32_bf16 v[132:135], a[0:3], a[68:71], v[132:135]
  buffer_load_dwordx4 v24, s[24:27], s60 offen offset:0  lds
  v_mfma_f32_16x16x32_bf16 v[136:139], a[0:3], a[72:75], v[136:139]
  v_mfma_f32_16x16x32_bf16 v[152:155], a[4:7], a[72:75], v[152:155]
  v_mfma_f32_16x16x32_bf16 v[156:159], a[4:7], a[76:79], v[156:159]
  buffer_load_dwordx4 v25, s[24:27], s60 offen offset:1024  lds
  v_mfma_f32_16x16x32_bf16 v[140:143], a[0:3], a[76:79], v[140:143]
  v_mfma_f32_16x16x32_bf16 v[168:171], a[8:11], a[72:75], v[168:171]
  s_waitcnt vmcnt(10)
  v_mfma_f32_16x16x32_bf16 v[184:187], a[12:15], a[72:75], v[184:187]
  ds_read_b128 a[80:83], v2 offset:9216
  ds_read_b128 a[84:87], v2 offset:25600
  v_mfma_f32_16x16x32_bf16 v[188:191], a[12:15], a[76:79], v[188:191]
  buffer_load_dwordx4 v26, s[24:27], s60 offen offset:2048  lds
  v_mfma_f32_16x16x32_bf16 v[172:175], a[8:11], a[76:79], v[172:175]
  ds_read_b64_tr_b16 a[32:33], v4 offset:0
  ds_read_b64_tr_b16 a[34:35], v4 offset:4096
  v_mfma_f32_16x16x32_bf16 v[160:163], a[8:11], a[64:67], v[160:163]
  v_mfma_f32_16x16x32_bf16 v[176:179], a[12:15], a[64:67], v[176:179]
  ds_read_b128 a[88:91], v2 offset:41984
  ds_read_b128 a[92:95], v2 offset:58368
  v_mfma_f32_16x16x32_bf16 v[180:183], a[12:15], a[68:71], v[180:183]
  buffer_load_dwordx4 v27, s[24:27], s60 offen offset:3072  lds
  v_mfma_f32_16x16x32_bf16 v[164:167], a[8:11], a[68:71], v[164:167]
  ds_read_b64_tr_b16 a[36:37], v5 offset:0
  ds_read_b64_tr_b16 a[38:39], v5 offset:4096
  v_mfma_f32_16x16x32_bf16 v[192:195], a[16:19], a[64:67], v[192:195]
  s_add_u32 s60, s60, 16384
  v_mfma_f32_16x16x32_bf16 v[208:211], a[20:23], a[64:67], v[208:211]
  s_add_u32 m0, s61, 69632
  v_mfma_f32_16x16x32_bf16 v[212:215], a[20:23], a[68:71], v[212:215]
  buffer_load_dwordx4 v24, s[24:27], s60 offen offset:0  lds
  v_mfma_f32_16x16x32_bf16 v[196:199], a[16:19], a[68:71], v[196:199]
  ds_read_b64_tr_b16 a[40:41], v6 offset:0
  ds_read_b64_tr_b16 a[42:43], v6 offset:4096
  v_mfma_f32_16x16x32_bf16 v[200:203], a[16:19], a[72:75], v[200:203]
  v_mfma_f32_16x16x32_bf16 v[216:219], a[20:23], a[72:75], v[216:219]
  ds_read_b64_tr_b16 a[44:45], v7 offset:0
  ds_read_b64_tr_b16 a[46:47], v7 offset:4096
  v_mfma_f32_16x16x32_bf16 v[220:223], a[20:23], a[76:79], v[220:223]
  buffer_load_dwordx4 v25, s[24:27], s60 offen offset:1024  lds
  v_mfma_f32_16x16x32_bf16 v[204:207], a[16:19], a[76:79], v[204:207]
  ds_read_b64_tr_b16 a[48:49], v8 offset:0
  ds_read_b64_tr_b16 a[50:51], v8 offset:4096
  v_mfma_f32_16x16x32_bf16 v[232:235], a[24:27], a[72:75], v[232:235]
  ds_read_b64_tr_b16 a[52:53], v9 offset:0
  ds_read_b64_tr_b16 a[54:55], v9 offset:4096
  v_mfma_f32_16x16x32_bf16 v[248:251], a[28:31], a[72:75], v[248:251]
  ds_read_b64_tr_b16 a[56:57], v10 offset:0
  ds_read_b64_tr_b16 a[58:59], v10 offset:4096
  v_mfma_f32_16x16x32_bf16 v[252:255], a[28:31], a[76:79], v[252:255]
  buffer_load_dwordx4 v26, s[24:27], s60 offen offset:2048  lds
  v_mfma_f32_16x16x32_bf16 v[236:239], a[24:27], a[76:79], v[236:239]
  ds_read_b64_tr_b16 a[60:61], v11 offset:0
  ds_read_b64_tr_b16 a[62:63], v11 offset:4096
  v_mfma_f32_16x16x32_bf16 v[224:227], a[24:27], a[64:67], v[224:227]
  v_mfma_f32_16x16x32_bf16 v[240:243], a[28:31], a[64:67], v[240:243]
  v_mfma_f32_16x16x32_bf16 v[244:247], a[28:31], a[68:71], v[244:247]
  buffer_load_dwordx4 v27, s[24:27], s60 offen offset:3072  lds
  v_mfma_f32_16x16x32_bf16 v[228:231], a[24:27], a[68:71], v[228:231]
  s_add_u32 s60, s60, 16384
  s_waitcnt lgkmcnt(8)
  v_mfma_f32_16x16x32_bf16 v[128:131], a[32:35], a[80:83], v[128:131]
  v_mfma_f32_16x16x32_bf16 v[144:147], a[36:39], a[80:83], v[144:147]
  s_waitcnt lgkmcnt(0)
  v_mfma_f32_16x16x32_bf16 v[148:151], a[36:39], a[84:87], v[148:151]
  s_add_u32 m0, s61, 0
  v_mfma_f32_16x16x32_bf16 v[132:135], a[32:35], a[84:87], v[132:135]
  buffer_load_dwordx4 v24, s[24:27], s60 offen offset:0  lds
  v_mfma_f32_16x16x32_bf16 v[136:139], a[32:35], a[88:91], v[136:139]
  v_mfma_f32_16x16x32_bf16 v[152:155], a[36:39], a[88:91], v[152:155]
  v_mfma_f32_16x16x32_bf16 v[156:159], a[36:39], a[92:95], v[156:159]
  buffer_load_dwordx4 v25, s[24:27], s60 offen offset:1024  lds
  v_mfma_f32_16x16x32_bf16 v[140:143], a[32:35], a[92:95], v[140:143]
  v_mfma_f32_16x16x32_bf16 v[168:171], a[40:43], a[88:91], v[168:171]
  s_waitcnt vmcnt(10)
  v_mfma_f32_16x16x32_bf16 v[184:187], a[44:47], a[88:91], v[184:187]
  ds_read_b128 a[64:67], v2 offset:10240
  ds_read_b128 a[68:71], v2 offset:26624
  v_mfma_f32_16x16x32_bf16 v[188:191], a[44:47], a[92:95], v[188:191]
  buffer_load_dwordx4 v26, s[24:27], s60 offen offset:2048  lds
  v_mfma_f32_16x16x32_bf16 v[172:175], a[40:43], a[92:95], v[172:175]
  ds_read_b64_tr_b16 a[0:1], v4 offset:32768
  ds_read_b64_tr_b16 a[2:3], v4 offset:36864
  v_mfma_f32_16x16x32_bf16 v[160:163], a[40:43], a[80:83], v[160:163]
  v_mfma_f32_16x16x32_bf16 v[176:179], a[44:47], a[80:83], v[176:179]
  ds_read_b128 a[72:75], v2 offset:43008
  ds_read_b128 a[76:79], v2 offset:59392
  v_mfma_f32_16x16x32_bf16 v[180:183], a[44:47], a[84:87], v[180:183]
  buffer_load_dwordx4 v27, s[24:27], s60 offen offset:3072  lds
  v_mfma_f32_16x16x32_bf16 v[164:167], a[40:43], a[84:87], v[164:167]
  ds_read_b64_tr_b16 a[4:5], v5 offset:32768
  ds_read_b64_tr_b16 a[6:7], v5 offset:36864
  v_mfma_f32_16x16x32_bf16 v[192:195], a[48:51], a[80:83], v[192:195]
  s_add_u32 s60, s60, 16384
  v_mfma_f32_16x16x32_bf16 v[208:211], a[52:55], a[80:83], v[208:211]
  s_add_u32 m0, s61, 4096
  v_mfma_f32_16x16x32_bf16 v[212:215], a[52:55], a[84:87], v[212:215]
  buffer_load_dwordx4 v24, s[24:27], s60 offen offset:0  lds
  v_mfma_f32_16x16x32_bf16 v[196:199], a[48:51], a[84:87], v[196:199]
  ds_read_b64_tr_b16 a[8:9], v6 offset:32768
  ds_read_b64_tr_b16 a[10:11], v6 offset:36864
  v_mfma_f32_16x16x32_bf16 v[200:203], a[48:51], a[88:91], v[200:203]
  v_mfma_f32_16x16x32_bf16 v[216:219], a[52:55], a[88:91], v[216:219]
  ds_read_b64_tr_b16 a[12:13], v7 offset:32768
  ds_read_b64_tr_b16 a[14:15], v7 offset:36864
  v_mfma_f32_16x16x32_bf16 v[220:223], a[52:55], a[92:95], v[220:223]
  buffer_load_dwordx4 v25, s[24:27], s60 offen offset:1024  lds
  v_mfma_f32_16x16x32_bf16 v[204:207], a[48:51], a[92:95], v[204:207]
  ds_read_b64_tr_b16 a[16:17], v8 offset:32768
  ds_read_b64_tr_b16 a[18:19], v8 offset:36864
  v_mfma_f32_16x16x32_bf16 v[232:235], a[56:59], a[88:91], v[232:235]
  ds_read_b64_tr_b16 a[20:21], v9 offset:32768
  ds_read_b64_tr_b16 a[22:23], v9 offset:36864
  v_mfma_f32_16x16x32_bf16 v[248:251], a[60:63], a[88:91], v[248:251]
  ds_read_b64_tr_b16 a[24:25], v10 offset:32768
  ds_read_b64_tr_b16 a[26:27], v10 offset:36864
  v_mfma_f32_16x16x32_bf16 v[252:255], a[60:63], a[92:95], v[252:255]
  buffer_load_dwordx4 v26, s[24:27], s60 offen offset:2048  lds
  v_mfma_f32_16x16x32_bf16 v[236:239], a[56:59], a[92:95], v[236:239]
  ds_read_b64_tr_b16 a[28:29], v11 offset:32768
  ds_read_b64_tr_b16 a[30:31], v11 offset:36864
  v_mfma_f32_16x16x32_bf16 v[224:227], a[56:59], a[80:83], v[224:227]
  v_mfma_f32_16x16x32_bf16 v[240:243], a[60:63], a[80:83], v[240:243]
  v_mfma_f32_16x16x32_bf16 v[244:247], a[60:63], a[84:87], v[244:247]
  buffer_load_dwordx4 v27, s[24:27], s60 offen offset:3072  lds
  v_mfma_f32_16x16x32_bf16 v[228:231], a[56:59], a[84:87], v[228:231]
  s_add_u32 s60, s60, 16384
  s_waitcnt lgkmcnt(8)
  v_mfma_f32_16x16x32_bf16 v[128:131], a[0:3], a[64:67], v[128:131]
  v_mfma_f32_16x16x32_bf16 v[144:147], a[4:7], a[64:67], v[144:147]
  s_waitcnt lgkmcnt(0)
  v_mfma_f32_16x16x32_bf16 v[148:151], a[4:7], a[68:71], v[148:151]
  s_add_u32 m0, s61, 32768
  v_mfma_f32_16x16x32_bf16 v[132:135], a[0:3], a[68:71], v[132:135]
  buffer_load_dwordx4 v24, s[24:27], s60 offen offset:0  lds
  v_mfma_f32_16x16x32_bf16 v[136:139], a[0:3], a[72:75], v[136:139]
  v_mfma_f32_16x16x32_bf16 v[152:155], a[4:7], a[72:75], v[152:155]
  v_mfma_f32_16x16x32_bf16 v[156:159], a[4:7], a[76:79], v[156:159]
  buffer_load_dwordx4 v25, s[24:27], s60 offen offset:1024  lds
  v_mfma_f32_16x16x32_bf16 v[140:143], a[0:3], a[76:79], v[140:143]
  v_mfma_f32_16x16x32_bf16 v[168:171], a[8:11], a[72:75], v[168:171]
  s_waitcnt vmcnt(10)
  v_mfma_f32_16x16x32_bf16 v[184:187], a[12:15], a[72:75], v[184:187]
  ds_read_b128 a[80:83], v2 offset:11264
  ds_read_b128 a[84:87], v2 offset:27648
  v_mfma_f32_16x16x32_bf16 v[188:191], a[12:15], a[76:79], v[188:191]
  buffer_load_dwordx4 v26, s[24:27], s60 offen offset:2048  lds
  v_mfma_f32_16x16x32_bf16 v[172:175], a[8:11], a[76:79], v[172:175]
  ds_read_b64_tr_b16 a[32:33], v12 offset:0
  ds_read_b64_tr_b16 a[34:35], v12 offset:4096
  v_mfma_f32_16x16x32_bf16 v[160:163], a[8:11], a[64:67], v[160:163]
  v_mfma_f32_16x16x32_bf16 v[176:179], a[12:15], a[64:67], v[176:179]
  ds_read_b128 a[88:91], v2 offset:44032
  ds_read_b128 a[92:95], v2 offset:60416
  v_mfma_f32_16x16x32_bf16 v[180:183], a[12:15], a[68:71], v[180:183]
  buffer_load_dwordx4 v27, s[24:27], s60 offen offset:3072  lds
  v_mfma_f32_16x16x32_bf16 v[164:167], a[8:11], a[68:71], v[164:167]
  ds_read_b64_tr_b16 a[36:37], v13 offset:0
  ds_read_b64_tr_b16 a[38:39], v13 offset:4096
  v_mfma_f32_16x16x32_bf16 v[192:195], a[16:19], a[64:67], v[192:195]
  s_add_u32 s60, s60, 16384
  v_mfma_f32_16x16x32_bf16 v[208:211], a[20:23], a[64:67], v[208:211]
  s_add_u32 m0, s61, 36864
  v_mfma_f32_16x16x32_bf16 v[212:215], a[20:23], a[68:71], v[212:215]
  buffer_load_dwordx4 v24, s[24:27], s60 offen offset:0  lds
  v_mfma_f32_16x16x32_bf16 v[196:199], a[16:19], a[68:71], v[196:199]
  ds_read_b64_tr_b16 a[40:41], v14 offset:0
  ds_read_b64_tr_b16 a[42:43], v14 offset:4096
  v_mfma_f32_16x16x32_bf16 v[200:203], a[16:19], a[72:75], v[200:203]
  v_mfma_f32_16x16x32_bf16 v[216:219], a[20:23], a[72:75], v[216:219]
  ds_read_b64_tr_b16 a[44:45], v15 offset:0
  ds_read_b64_tr_b16 a[46:47], v15 offset:4096
  v_mfma_f32_16x16x32_bf16 v[220:223], a[20:23], a[76:79], v[220:223]
  buffer_load_dwordx4 v25, s[24:27], s60 offen offset:1024  lds
  v_mfma_f32_16x16x32_bf16 v[204:207], a[16:19], a[76:79], v[204:207]
  ds_read_b64_tr_b16 a[48:49], v16 offset:0
  ds_read_b64_tr_b16 a[50:51], v16 offset:4096
  v_mfma_f32_16x16x32_bf16 v[232:235], a[24:27], a[72:75], v[232:235]
  ds_read_b64_tr_b16 a[52:53], v17 offset:0
  ds_read_b64_tr_b16 a[54:55], v17 offset:4096
  v_mfma_f32_16x16x32_bf16 v[248:251], a[28:31], a[72:75], v[248:251]
  ds_read_b64_tr_b16 a[56:57], v18 offset:0
  ds_read_b64_tr_b16 a[58:59], v18 offset:4096
  v_mfma_f32_16x16x32_bf16 v[252:255], a[28:31], a[76:79], v[252:255]
  buffer_load_dwordx4 v26, s[24:27], s60 offen offset:2048  lds
  v_mfma_f32_16x16x32_bf16 v[236:239], a[24:27], a[76:79], v[236:239]
  ds_read_b64_tr_b16 a[60:61], v19 offset:0
  ds_read_b64_tr_b16 a[62:63], v19 offset:4096
  v_mfma_f32_16x16x32_bf16 v[224:227], a[24:27], a[64:67], v[224:227]
  v_mfma_f32_16x16x32_bf16 v[240:243], a[28:31], a[64:67], v[240:243]
  v_mfma_f32_16x16x32_bf16 v[244:247], a[28:31], a[68:71], v[244:247]
  buffer_load_dwordx4 v27, s[24:27], s60 offen offset:3072  lds
  v_mfma_f32_16x16x32_bf16 v[228:231], a[24:27], a[68:71], v[228:231]
  s_add_u32 s60, s60, 16384
  s_waitcnt lgkmcnt(8)
  v_mfma_f32_16x16x32_bf16 v[128:131], a[32:35], a[80:83], v[128:131]
  v_mfma_f32_16x16x32_bf16 v[144:147], a[36:39], a[80:83], v[144:147]
  s_waitcnt lgkmcnt(0)
  v_mfma_f32_16x16x32_bf16 v[148:151], a[36:39], a[84:87], v[148:151]
  s_add_u32 m0, s61, 65536
  v_mfma_f32_16x16x32_bf16 v[132:135], a[32:35], a[84:87], v[132:135]
  buffer_load_dwordx4 v24, s[24:27], s60 offen offset:0  lds
  v_mfma_f32_16x16x32_bf16 v[136:139], a[32:35], a[88:91], v[136:139]
  v_mfma_f32_16x16x32_bf16 v[152:155], a[36:39], a[88:91], v[152:155]
  v_mfma_f32_16x16x32_bf16 v[156:159], a[36:39], a[92:95], v[156:159]
  buffer_load_dwordx4 v25, s[24:27], s60 offen offset:1024  lds
  v_mfma_f32_16x16x32_bf16 v[140:143], a[32:35], a[92:95], v[140:143]
  v_mfma_f32_16x16x32_bf16 v[168:171], a[40:43], a[88:91], v[168:171]
  s_waitcnt vmcnt(10)
  v_mfma_f32_16x16x32_bf16 v[184:187], a[44:47], a[88:91], v[184:187]
  ds_read_b128 a[64:67], v2 offset:12288
  ds_read_b128 a[68:71], v2 offset:28672
  v_mfma_f32_16x16x32_bf16 v[188:191], a[44:47], a[92:95], v[188:191]
  buffer_load_dwordx4 v26, s[24:27], s60 offen offset:2048  lds
  v_mfma_f32_16x16x32_bf16 v[172:175], a[40:43], a[92:95], v[172:175]
  ds_read_b64_tr_b16 a[0:1], v4 offset:0
  ds_read_b64_tr_b16 a[2:3], v4 offset:4096
  v_mfma_f32_16x16x32_bf16 v[160:163], a[40:43], a[80:83], v[160:163]
  v_and_b32 v46, 7, v1
  v_lshl_add_u32 v46, v46, 2, s74
  buffer_load_dword v47, v46, s[52:55], 0 offen offset:0 sc1
  v_mfma_f32_16x16x32_bf16 v[176:179], a[44:47], a[80:83], v[176:179]
  ds_read_b128 a[72:75], v2 offset:45056
  ds_read_b128 a[76:79], v2 offset:61440
  v_mfma_f32_16x16x32_bf16 v[180:183], a[44:47], a[84:87], v[180:183]
  buffer_load_dwordx4 v27, s[24:27], s60 offen offset:3072  lds
  v_mfma_f32_16x16x32_bf16 v[164:167], a[40:43], a[84:87], v[164:167]
  ds_read_b64_tr_b16 a[4:5], v5 offset:0
  ds_read_b64_tr_b16 a[6:7], v5 offset:4096
  v_mfma_f32_16x16x32_bf16 v[192:195], a[48:51], a[80:83], v[192:195]
  s_add_u32 s60, s60, 16384
  v_mfma_f32_16x16x32_bf16 v[208:211], a[52:55], a[80:83], v[208:211]
  s_add_u32 m0, s61, 69632
  v_mfma_f32_16x16x32_bf16 v[212:215], a[52:55], a[84:87], v[212:215]
  buffer_load_dwordx4 v24, s[24:27], s60 offen offset:0  lds
  v_mfma_f32_16x16x32_bf16 v[196:199], a[48:51], a[84:87], v[196:199]
  ds_read_b64_tr_b16 a[8:9], v6 offset:0
  ds_read_b64_tr_b16 a[10:11], v6 offset:4096
  v_mfma_f32_16x16x32_bf16 v[200:203], a[48:51], a[88:91], v[200:203]
  v_mfma_f32_16x16x32_bf16 v[216:219], a[52:55], a[88:91], v[216:219]
  ds_read_b64_tr_b16 a[12:13], v7 offset:0
  ds_read_b64_tr_b16 a[14:15], v7 offset:4096
  v_mfma_f32_16x16x32_bf16 v[220:223], a[52:55], a[92:95], v[220:223]
  buffer_load_dwordx4 v25, s[24:27], s60 offen offset:1024  lds
  v_mfma_f32_16x16x32_bf16 v[204:207], a[48:51], a[92:95], v[204:207]
  ds_read_b64_tr_b16 a[16:17], v8 offset:0
  ds_read_b64_tr_b16 a[18:19], v8 offset:4096
  v_mfma_f32_16x16x32_bf16 v[232:235], a[56:59], a[88:91], v[232:235]
  ds_read_b64_tr_b16 a[20:21], v9 offset:0
  ds_read_b64_tr_b16 a[22:23], v9 offset:4096
  v_mfma_f32_16x16x32_bf16 v[248:251], a[60:63], a[88:91], v[248:251]
  ds_read_b64_tr_b16 a[24:25], v10 offset:0
  ds_read_b64_tr_b16 a[26:27], v10 offset:4096
  v_mfma_f32_16x16x32_bf16 v[252:255], a[60:63], a[92:95], v[252:255]
  buffer_load_dwordx4 v26, s[24:27], s60 offen offset:2048  lds
  v_mfma_f32_16x16x32_bf16 v[236:239], a[56:59], a[92:95], v[236:239]
  ds_read_b64_tr_b16 a[28:29], v11 offset:0
  ds_read_b64_tr_b16 a[30:31], v11 offset:4096
  v_mfma_f32_16x16x32_bf16 v[224:227], a[56:59], a[80:83], v[224:227]
  v_mfma_f32_16x16x32_bf16 v[240:243], a[60:63], a[80:83], v[240:243]
  v_mfma_f32_16x16x32_bf16 v[244:247], a[60:63], a[84:87], v[244:247]
  buffer_load_dwordx4 v27, s[24:27], s60 offen offset:3072  lds
  v_mfma_f32_16x16x32_bf16 v[228:231], a[56:59], a[84:87], v[228:231]
  s_add_u32 s60, s60, 16384
  s_waitcnt lgkmcnt(8)
  v_mfma_f32_16x16x32_bf16 v[128:131], a[0:3], a[64:67], v[128:131]
  v_mfma_f32_16x16x32_bf16 v[144:147], a[4:7], a[64:67], v[144:147]
  s_waitcnt lgkmcnt(0)
  v_mfma_f32_16x16x32_bf16 v[148:151], a[4:7], a[68:71], v[148:151]
  s_add_u32 m0, s61, 0
  v_mfma_f32_16x16x32_bf16 v[132:135], a[0:3], a[68:71], v[132:135]
  buffer_load_dwordx4 v24, s[24:27], s60 offen offset:0  lds
  v_mfma_f32_16x16x32_bf16 v[136:139], a[0:3], a[72:75], v[136:139]
  v_mfma_f32_16x16x32_bf16 v[152:155], a[4:7], a[72:75], v[152:155]
  v_mfma_f32_16x16x32_bf16 v[156:159], a[4:7], a[76:79], v[156:159]
  buffer_load_dwordx4 v25, s[24:27], s60 offen offset:1024  lds
  v_mfma_f32_16x16x32_bf16 v[140:143], a[0:3], a[76:79], v[140:143]
  v_mfma_f32_16x16x32_bf16 v[168:171], a[8:11], a[72:75], v[168:171]
  s_waitcnt vmcnt(11)
  v_mfma_f32_16x16x32_bf16 v[184:187], a[12:15], a[72:75], v[184:187]
  ds_read_b128 a[80:83], v2 offset:13312
  ds_read_b128 a[84:87], v2 offset:29696
  v_mfma_f32_16x16x32_bf16 v[188:191], a[12:15], a[76:79], v[188:191]
  buffer_load_dwordx4 v26, s[24:27], s60 offen offset:2048  lds
  v_mfma_f32_16x16x32_bf16 v[172:175], a[8:11], a[76:79], v[172:175]
  ds_read_b64_tr_b16 a[32:33], v4 offset:32768
  ds_read_b64_tr_b16 a[34:35], v4 offset:36864
  v_mfma_f32_16x16x32_bf16 v[160:163], a[8:11], a[64:67], v[160:163]
  v_mfma_f32_16x16x32_bf16 v[176:179], a[12:15], a[64:67], v[176:179]
  ds_read_b128 a[88:91], v2 offset:46080
  ds_read_b128 a[92:95], v2 offset:62464
  v_mfma_f32_16x16x32_bf16 v[180:183], a[12:15], a[68:71], v[180:183]
  buffer_load_dwordx4 v27, s[24:27], s60 offen offset:3072  lds
  v_mfma_f32_16x16x32_bf16 v[164:167], a[8:11], a[68:71], v[164:167]
  ds_read_b64_tr_b16 a[36:37], v5 offset:32768
  ds_read_b64_tr_b16 a[38:39], v5 offset:36864
  v_mfma_f32_16x16x32_bf16 v[192:195], a[16:19], a[64:67], v[192:195]
  s_add_u32 s60, s60, 16384
  v_mfma_f32_16x16x32_bf16 v[208:211], a[20:23], a[64:67], v[208:211]
  s_add_u32 m0, s61, 4096
  v_mfma_f32_16x16x32_bf16 v[212:215], a[20:23], a[68:71], v[212:215]
  buffer_load_dwordx4 v24, s[24:27], s60 offen offset:0  lds
  v_mfma_f32_16x16x32_bf16 v[196:199], a[16:19], a[68:71], v[196:199]
  ds_read_b64_tr_b16 a[40:41], v6 offset:32768
  ds_read_b64_tr_b16 a[42:43], v6 offset:36864
  v_mfma_f32_16x16x32_bf16 v[200:203], a[16:19], a[72:75], v[200:203]
  v_mfma_f32_16x16x32_bf16 v[216:219], a[20:23], a[72:75], v[216:219]
  ds_read_b64_tr_b16 a[44:45], v7 offset:32768
  ds_read_b64_tr_b16 a[46:47], v7 offset:36864
  v_mfma_f32_16x16x32_bf16 v[220:223], a[20:23], a[76:79], v[220:223]
  buffer_load_dwordx4 v25, s[24:27], s60 offen offset:1024  lds
  v_mfma_f32_16x16x32_bf16 v[204:207], a[16:19], a[76:79], v[204:207]
  ds_read_b64_tr_b16 a[48:49], v8 offset:32768
  ds_read_b64_tr_b16 a[50:51], v8 offset:36864
  v_mfma_f32_16x16x32_bf16 v[232:235], a[24:27], a[72:75], v[232:235]
  ds_read_b64_tr_b16 a[52:53], v9 offset:32768
  ds_read_b64_tr_b16 a[54:55], v9 offset:36864
  v_mfma_f32_16x16x32_bf16 v[248:251], a[28:31], a[72:75], v[248:251]
  ds_read_b64_tr_b16 a[56:57], v10 offset:32768
  ds_read_b64_tr_b16 a[58:59], v10 offset:36864
  v_mfma_f32_16x16x32_bf16 v[252:255], a[28:31], a[76:79], v[252:255]
  buffer_load_dwordx4 v26, s[24:27], s60 offen offset:2048  lds
  v_mfma_f32_16x16x32_bf16 v[236:239], a[24:27], a[76:79], v[236:239]
  ds_read_b64_tr_b16 a[60:61], v11 offset:32768
  ds_read_b64_tr_b16 a[62:63], v11 offset:36864
  v_mfma_f32_16x16x32_bf16 v[224:227], a[24:27], a[64:67], v[224:227]
  v_mfma_f32_16x16x32_bf16 v[240:243], a[28:31], a[64:67], v[240:243]
  v_mfma_f32_16x16x32_bf16 v[244:247], a[28:31], a[68:71], v[244:247]
  buffer_load_dwordx4 v27, s[24:27], s60 offen offset:3072  lds
  v_mfma_f32_16x16x32_bf16 v[228:231], a[24:27], a[68:71], v[228:231]
  s_add_u32 s60, s60, 16384
  s_waitcnt lgkmcnt(8)
  v_mfma_f32_16x16x32_bf16 v[128:131], a[32:35], a[80:83], v[128:131]
  v_mfma_f32_16x16x32_bf16 v[144:147], a[36:39], a[80:83], v[144:147]
  s_waitcnt lgkmcnt(0)
  s_waitcnt vmcnt(13)
  v_cmp_ne_u32 vcc, 1, v47
  s_cbranch_vccz L_rdy_16
  s_mov_b32 s101, 0
L_spin_17:
  buffer_load_dword v47, v46, s[52:55], 0 offen offset:0 sc1
  s_waitcnt vmcnt(0)
  s_add_u32 s101, s101, 1
  s_cmp_gt_u32 s101, 0x40000
  s_cbranch_scc1 L_ok_18
  v_cmp_ne_u32 vcc, 1, v47
  s_cbranch_vccnz L_spin_17
L_ok_18:
L_rdy_16:
  v_mfma_f32_16x16x32_bf16 v[148:151], a[36:39], a[84:87], v[148:151]
  s_mov_b32 s58, s96
  v_mfma_f32_16x16x32_bf16 v[132:135], a[32:35], a[84:87], v[132:135]
  s_lshl_b32 s98, s58, 15
  v_mfma_f32_16x16x32_bf16 v[136:139], a[32:35], a[88:91], v[136:139]
  v_mfma_f32_16x16x32_bf16 v[152:155], a[36:39], a[88:91], v[152:155]
  s_lshl_b32 s99, s3, 13
  v_mfma_f32_16x16x32_bf16 v[156:159], a[36:39], a[92:95], v[156:159]
  s_add_u32 m0, s99, 98304
  v_mfma_f32_16x16x32_bf16 v[140:143], a[32:35], a[92:95], v[140:143]
  v_mfma_f32_16x16x32_bf16 v[168:171], a[40:43], a[88:91], v[168:171]
  buffer_load_dwordx4 v42, s[40:43], s98 offen offset:0  lds
  s_waitcnt vmcnt(9)
  v_mfma_f32_16x16x32_bf16 v[184:187], a[44:47], a[88:91], v[184:187]
  buffer_load_dwordx4 v43, s[40:43], s98 offen offset:1024  lds
  ds_read_b128 a[64:67], v2 offset:14336
  ds_read_b128 a[68:71], v2 offset:30720
  v_mfma_f32_16x16x32_bf16 v[188:191], a[44:47], a[92:95], v[188:191]
  v_mfma_f32_16x16x32_bf16 v[172:175], a[40:43], a[92:95], v[172:175]
  buffer_load_dwordx4 v44, s[40:43], s98 offen offset:2048  lds
  ds_read_b64_tr_b16 a[0:1], v12 offset:0
  ds_read_b64_tr_b16 a[2:3], v12 offset:4096
  v_mfma_f32_16x16x32_bf16 v[160:163], a[40:43], a[80:83], v[160:163]
  buffer_load_dwordx4 v45, s[40:43], s98 offen offset:3072  lds
  v_mfma_f32_16x16x32_bf16 v[176:179], a[44:47], a[80:83], v[176:179]
  ds_read_b128 a[72:75], v2 offset:47104
  ds_read_b128 a[76:79], v2 offset:63488
  v_mfma_f32_16x16x32_bf16 v[180:183], a[44:47], a[84:87], v[180:183]
  s_mov_b32 s58, 48
  s_cmp_ge_u32 s58, s97
  s_cselect_b32 s98, 7, 0
  s_add_u32 s58, s58, s98
  s_add_u32 s98, s96, 1
  s_cmp_eq_u32 s3, 3
  s_cselect_b32 s58, s58, s98
  v_mfma_f32_16x16x32_bf16 v[164:167], a[40:43], a[84:87], v[164:167]
  s_lshl_b32 s98, s58, 15
  ds_read_b64_tr_b16 a[4:5], v13 offset:0
  ds_read_b64_tr_b16 a[6:7], v13 offset:4096
  v_mfma_f32_16x16x32_bf16 v[192:195], a[48:51], a[80:83], v[192:195]
  v_mfma_f32_16x16x32_bf16 v[208:211], a[52:55], a[80:83], v[208:211]
  s_lshl_b32 s99, s3, 13
  v_mfma_f32_16x16x32_bf16 v[212:215], a[52:55], a[84:87], v[212:215]
  s_add_u32 m0, s99, 102400
  v_mfma_f32_16x16x32_bf16 v[196:199], a[48:51], a[84:87], v[196:199]
  ds_read_b64_tr_b16 a[8:9], v14 offset:0
  ds_read_b64_tr_b16 a[10:11], v14 offset:4096
  v_mfma_f32_16x16x32_bf16 v[200:203], a[48:51], a[88:91], v[200:203]
  buffer_load_dwordx4 v42, s[40:43], s98 offen offset:0  lds
  v_mfma_f32_16x16x32_bf16 v[216:219], a[52:55], a[88:91], v[216:219]
  buffer_load_dwordx4 v43, s[40:43], s98 offen offset:1024  lds
  ds_read_b64_tr_b16 a[12:13], v15 offset:0
  ds_read_b64_tr_b16 a[14:15], v15 offset:4096
  v_mfma_f32_16x16x32_bf16 v[220:223], a[52:55], a[92:95], v[220:223]
  v_mfma_f32_16x16x32_bf16 v[204:207], a[48:51], a[92:95], v[204:207]
  buffer_load_dwordx4 v44, s[40:43], s98 offen offset:2048  lds
  ds_read_b64_tr_b16 a[16:17], v16 offset:0
  ds_read_b64_tr_b16 a[18:19], v16 offset:4096
  v_mfma_f32_16x16x32_bf16 v[232:235], a[56:59], a[88:91], v[232:235]
  buffer_load_dwordx4 v45, s[40:43], s98 offen offset:3072  lds
  ds_read_b64_tr_b16 a[20:21], v17 offset:0
  ds_read_b64_tr_b16 a[22:23], v17 offset:4096
  v_mfma_f32_16x16x32_bf16 v[248:251], a[60:63], a[88:91], v[248:251]
  ds_read_b64_tr_b16 a[24:25], v18 offset:0
  ds_read_b64_tr_b16 a[26:27], v18 offset:4096
  v_mfma_f32_16x16x32_bf16 v[252:255], a[60:63], a[92:95], v[252:255]
  s_lshl_b32 s98, s58, 12
  v_mfma_f32_16x16x32_bf16 v[236:239], a[56:59], a[92:95], v[236:239]
  s_add_u32 s98, s98, s82
  ds_read_b64_tr_b16 a[28:29], v19 offset:0
  ds_read_b64_tr_b16 a[30:31], v19 offset:4096
  v_mfma_f32_16x16x32_bf16 v[224:227], a[56:59], a[80:83], v[224:227]
  v_mfma_f32_16x16x32_bf16 v[240:243], a[60:63], a[80:83], v[240:243]
  s_cmp_lg_u32 s3, 3
  s_cbranch_scc1 L_own_15
  buffer_load_dwordx4 a[112:115], v0, s[52:55], s98 offen offset:0 sc1
  buffer_load_dwordx4 a[116:119], v0, s[52:55], s98 offen offset:1024 sc1
  buffer_load_dwordx4 a[120:123], v0, s[52:55], s98 offen offset:2048 sc1
  buffer_load_dwordx4 a[124:127], v0, s[52:55], s98 offen offset:3072 sc1
L_own_15:
  v_mfma_f32_16x16x32_bf16 v[244:247], a[60:63], a[84:87], v[244:247]
  v_mfma_f32_16x16x32_bf16 v[228:231], a[56:59], a[84:87], v[228:231]
  s_waitcnt lgkmcnt(8)
  v_mfma_f32_16x16x32_bf16 v[128:131], a[0:3], a[64:67], v[128:131]
  v_mfma_f32_16x16x32_bf16 v[144:147], a[4:7], a[64:67], v[144:147]
  s_waitcnt lgkmcnt(0)
  v_mfma_f32_16x16x32_bf16 v[148:151], a[4:7], a[68:71], v[148:151]
  s_add_u32 s58, s3, 0
  s_cmp_ge_u32 s58, s97
  s_cselect_b32 s98, 7, 0
  s_add_u32 s58, s58, s98
  v_mfma_f32_16x16x32_bf16 v[132:135], a[0:3], a[68:71], v[132:135]
  s_lshl_b32 s98, s58, 15
  s_lshl_b32 s99, s3, 13
  s_add_u32 m0, s99, 131072
  v_mfma_f32_16x16x32_bf16 v[136:139], a[0:3], a[72:75], v[136:139]
  v_mfma_f32_16x16x32_bf16 v[152:155], a[4:7], a[72:75], v[152:155]
  v_mfma_f32_16x16x32_bf16 v[156:159], a[4:7], a[76:79], v[156:159]
  buffer_load_dwordx4 v42, s[40:43], s98 offen offset:0  lds
  v_mfma_f32_16x16x32_bf16 v[140:143], a[0:3], a[76:79], v[140:143]
  v_mfma_f32_16x16x32_bf16 v[168:171], a[8:11], a[72:75], v[168:171]
  s_waitcnt vmcnt(9)
  v_mfma_f32_16x16x32_bf16 v[184:187], a[12:15], a[72:75], v[184:187]
  ds_read_b128 a[80:83], v2 offset:15360
  ds_read_b128 a[84:87], v2 offset:31744
  v_mfma_f32_16x16x32_bf16 v[188:191], a[12:15], a[76:79], v[188:191]
  buffer_load_dwordx4 v43, s[40:43], s98 offen offset:1024  lds
  v_mfma_f32_16x16x32_bf16 v[172:175], a[8:11], a[76:79], v[172:175]
  ds_read_b64_tr_b16 a[32:33], v4 offset:0
  ds_read_b64_tr_b16 a[34:35], v4 offset:4096
  v_mfma_f32_16x16x32_bf16 v[160:163], a[8:11], a[64:67], v[160:163]
  v_mfma_f32_16x16x32_bf16 v[176:179], a[12:15], a[64:67], v[176:179]
  ds_read_b128 a[88:91], v2 offset:48128
  ds_read_b128 a[92:95], v2 offset:64512
  v_mfma_f32_16x16x32_bf16 v[180:183], a[12:15], a[68:71], v[180:183]
  buffer_load_dwordx4 v44, s[40:43], s98 offen offset:2048  lds
  v_mfma_f32_16x16x32_bf16 v[164:167], a[8:11], a[68:71], v[164:167]
  ds_read_b64_tr_b16 a[36:37], v5 offset:0
  ds_read_b64_tr_b16 a[38:39], v5 offset:4096
  v_mfma_f32_16x16x32_bf16 v[192:195], a[16:19], a[64:67], v[192:195]
  buffer_load_dwordx4 v45, s[40:43], s98 offen offset:3072  lds
  v_mfma_f32_16x16x32_bf16 v[208:211], a[20:23], a[64:67], v[208:211]
  s_lshl_b32 s98, s58, 12
  v_mfma_f32_16x16x32_bf16 v[212:215], a[20:23], a[68:71], v[212:215]
  s_add_u32 s98, s98, s82
  v_mfma_f32_16x16x32_bf16 v[196:199], a[16:19], a[68:71], v[196:199]
  ds_read_b64_tr_b16 a[40:41], v6 offset:0
  ds_read_b64_tr_b16 a[42:43], v6 offset:4096
  v_mfma_f32_16x16x32_bf16 v[200:203], a[16:19], a[72:75], v[200:203]
  v_mfma_f32_16x16x32_bf16 v[216:219], a[20:23], a[72:75], v[216:219]
  ds_read_b64_tr_b16 a[44:45], v7 offset:0
  ds_read_b64_tr_b16 a[46:47], v7 offset:4096
  v_mfma_f32_16x16x32_bf16 v[220:223], a[20:23], a[76:79], v[220:223]
  buffer_load_dwordx4 a[128:131], v0, s[52:55], s98 offen offset:0 sc1
  v_mfma_f32_16x16x32_bf16 v[204:207], a[16:19], a[76:79], v[204:207]
  ds_read_b64_tr_b16 a[48:49], v8 offset:0
  ds_read_b64_tr_b16 a[50:51], v8 offset:4096
  v_mfma_f32_16x16x32_bf16 v[232:235], a[24:27], a[72:75], v[232:235]
  ds_read_b64_tr_b16 a[52:53], v9 offset:0
  ds_read_b64_tr_b16 a[54:55], v9 offset:4096
  v_mfma_f32_16x16x32_bf16 v[248:251], a[28:31], a[72:75], v[248:251]
  ds_read_b64_tr_b16 a[56:57], v10 offset:0
  ds_read_b64_tr_b16 a[58:59], v10 offset:4096
  v_mfma_f32_16x16x32_bf16 v[252:255], a[28:31], a[76:79], v[252:255]
  buffer_load_dwordx4 a[132:135], v0, s[52:55], s98 offen offset:1024 sc1
  v_mfma_f32_16x16x32_bf16 v[236:239], a[24:27], a[76:79], v[236:239]
  ds_read_b64_tr_b16 a[60:61], v11 offset:0
  ds_read_b64_tr_b16 a[62:63], v11 offset:4096
  v_mfma_f32_16x16x32_bf16 v[224:227], a[24:27], a[64:67], v[224:227]
  v_mfma_f32_16x16x32_bf16 v[240:243], a[28:31], a[64:67], v[240:243]
  v_mfma_f32_16x16x32_bf16 v[244:247], a[28:31], a[68:71], v[244:247]
  buffer_load_dwordx4 a[136:139], v0, s[52:55], s98 offen offset:2048 sc1
  v_mfma_f32_16x16x32_bf16 v[228:231], a[24:27], a[68:71], v[228:231]
  buffer_load_dwordx4 a[140:143], v0, s[52:55], s98 offen offset:3072 sc1
  s_waitcnt lgkmcnt(8)
  v_mfma_f32_16x16x32_bf16 v[128:131], a[32:35], a[80:83], v[128:131]
  v_mfma_f32_16x16x32_bf16 v[144:147], a[36:39], a[80:83], v[144:147]
  s_waitcnt lgkmcnt(0)
  v_mfma_f32_16x16x32_bf16 v[148:151], a[36:39], a[84:87], v[148:151]
  s_add_u32 s58, s3, 4
  s_cmp_ge_u32 s58, s97
  s_cselect_b32 s98, 7, 0
  s_add_u32 s58, s58, s98
  s_lshl_b32 s57, s3, 13
  v_lshrrev_b32 v30, 4, v1
  v_mfma_f32_16x16x32_bf16 v[132:135], a[32:35], a[84:87], v[132:135]
  v_bfe_u32 v31, v1, 2, 2
  v_mfma_f32_16x16x32_bf16 v[136:139], a[32:35], a[88:91], v[136:139]
  s_lshl_b32 s98, s58, 15
  v_lshl_add_u32 v40, v30, 2, v31
  v_lshlrev_b32 v4, 7, v40
  v_mfma_f32_16x16x32_bf16 v[152:155], a[36:39], a[88:91], v[152:155]
  v_bfe_u32 v40, v40, 1, 2
  v_mfma_f32_16x16x32_bf16 v[156:159], a[36:39], a[92:95], v[156:159]
  s_lshl_b32 s99, s3, 13
  v_lshl_add_u32 v4, v40, 5, v4
  v_and_b32 v31, 3, v1
  v_mfma_f32_16x16x32_bf16 v[140:143], a[32:35], a[92:95], v[140:143]
  v_lshl_add_u32 v4, v31, 3, v4
  v_mfma_f32_16x16x32_bf16 v[168:171], a[40:43], a[88:91], v[168:171]
  s_add_u32 m0, s99, 135168
  v_add_u32 v4, s57, v4
  v_xor_b32 v5, 32, v4
  v_mfma_f32_16x16x32_bf16 v[184:187], a[44:47], a[88:91], v[184:187]
  v_xor_b32 v6, 64, v4
  v_mfma_f32_16x16x32_bf16 v[188:191], a[44:47], a[92:95], v[188:191]
  buffer_load_dwordx4 v42, s[40:43], s98 offen offset:0  lds
  v_xor_b32 v7, 96, v4
  v_mfma_f32_16x16x32_bf16 v[172:175], a[40:43], a[92:95], v[172:175]
  v_add_u32 v8, 65536, v4
  v_add_u32 v9, 65536, v5
  v_mfma_f32_16x16x32_bf16 v[160:163], a[40:43], a[80:83], v[160:163]
  buffer_load_dwordx4 v43, s[40:43], s98 offen offset:1024  lds
  v_add_u32 v10, 65536, v6
  v_mfma_f32_16x16x32_bf16 v[176:179], a[44:47], a[80:83], v[176:179]
  v_add_u32 v11, 65536, v7
  v_add_u32 v12, 131072, v4
  v_mfma_f32_16x16x32_bf16 v[180:183], a[44:47], a[84:87], v[180:183]
  buffer_load_dwordx4 v44, s[40:43], s98 offen offset:2048  lds
  v_add_u32 v13, 131072, v5
  v_mfma_f32_16x16x32_bf16 v[164:167], a[40:43], a[84:87], v[164:167]
  v_add_u32 v14, 131072, v6
  v_add_u32 v15, 131072, v7
  v_mfma_f32_16x16x32_bf16 v[192:195], a[48:51], a[80:83], v[192:195]
  buffer_load_dwordx4 v45, s[40:43], s98 offen offset:3072  lds
  v_and_b32 v30, 15, v1
  v_mfma_f32_16x16x32_bf16 v[208:211], a[52:55], a[80:83], v[208:211]
  v_lshlrev_b32 v30, 10, v30
  v_mfma_f32_16x16x32_bf16 v[212:215], a[52:55], a[84:87], v[212:215]
  s_lshl_b32 s98, s58, 12
  v_lshrrev_b32 v31, 4, v1
  v_lshl_add_u32 v20, v31, 4, v30
  v_mfma_f32_16x16x32_bf16 v[196:199], a[48:51], a[84:87], v[196:199]
  s_lshl_b32 s57, s3, 13
  v_mfma_f32_16x16x32_bf16 v[200:203], a[48:51], a[88:91], v[200:203]
  s_add_u32 s98, s98, s82
  s_add_u32 s57, s57, 98304
  v_add_u32 v21, s57, v0
  v_mfma_f32_16x16x32_bf16 v[216:219], a[52:55], a[88:91], v[216:219]
  s_lshl_b32 s57, s7, 15
  v_mfma_f32_16x16x32_bf16 v[220:223], a[52:55], a[92:95], v[220:223]
  buffer_load_dwordx4 a[144:147], v0, s[52:55], s98 offen offset:0 sc1
  s_lshl_b32 s56, s6, 12
  s_add_u32 s57, s57, s56
  v_mfma_f32_16x16x32_bf16 v[204:207], a[48:51], a[92:95], v[204:207]
  s_add_u32 s57, s57, 98304
  v_mfma_f32_16x16x32_bf16 v[232:235], a[56:59], a[88:91], v[232:235]
  buffer_load_dwordx4 a[148:151], v0, s[52:55], s98 offen offset:1024 sc1
  v_add_u32 v22, s57, v0
  v_mfma_f32_16x16x32_bf16 v[248:251], a[60:63], a[88:91], v[248:251]
  v_mfma_f32_16x16x32_bf16 v[252:255], a[60:63], a[92:95], v[252:255]
  buffer_load_dwordx4 a[152:155], v0, s[52:55], s98 offen offset:2048 sc1
  v_mfma_f32_16x16x32_bf16 v[236:239], a[56:59], a[92:95], v[236:239]
  v_mfma_f32_16x16x32_bf16 v[224:227], a[56:59], a[80:83], v[224:227]
  buffer_load_dwordx4 a[156:159], v0, s[52:55], s98 offen offset:3072 sc1
  v_mfma_f32_16x16x32_bf16 v[240:243], a[60:63], a[80:83], v[240:243]
  v_mfma_f32_16x16x32_bf16 v[244:247], a[60:63], a[84:87], v[244:247]
  s_barrier
  v_mfma_f32_16x16x32_bf16 v[228:231], a[56:59], a[84:87], v[228:231]
L_oproj_end:
  s_mov_b32 s100, 0
  s_waitcnt vmcnt(20)
  ds_read_b64_tr_b16 a[0:1], v8 offset:32768
  ds_read_b64_tr_b16 a[2:3], v8 offset:34816
  ds_read_b64_tr_b16 a[4:5], v9 offset:32768
  ds_read_b64_tr_b16 a[6:7], v9 offset:34816
  ds_read_b64_tr_b16 a[8:9], v10 offset:32768
  ds_read_b64_tr_b16 a[10:11], v10 offset:34816
  ds_read_b64_tr_b16 a[12:13], v11 offset:32768
  ds_read_b64_tr_b16 a[14:15], v11 offset:34816
  v_cvt_pk_bf16_f32 v64, v128, v129
  v_cvt_pk_bf16_f32 v65, v130, v131
  v_cvt_pk_bf16_f32 v66, v144, v145
  v_cvt_pk_bf16_f32 v67, v146, v147
  s_xor_b32 s98, s84, 0
  s_add_u32 s98, s98, s83
  buffer_store_dwordx4 v[64:67], v0, s[52:55], s98 offen sc1
  v_cvt_pk_bf16_f32 v68, v132, v133
  v_cvt_pk_bf16_f32 v69, v134, v135
  v_cvt_pk_bf16_f32 v70, v148, v149
  v_cvt_pk_bf16_f32 v71, v150, v151
  s_xor_b32 s98, s84, 8192
  s_add_u32 s98, s98, s83
  buffer_store_dwordx4 v[68:71], v0, s[52:55], s98 offen sc1
  v_cvt_pk_bf16_f32 v72, v136, v137
  v_cvt_pk_bf16_f32 v73, v138, v139
  v_cvt_pk_bf16_f32 v74, v152, v153
  v_cvt_pk_bf16_f32 v75, v154, v155
  s_xor_b32 s98, s84, 16384
  s_add_u32 s98, s98, s83
  buffer_store_dwordx4 v[72:75], v0, s[52:55], s98 offen sc1
  v_cvt_pk_bf16_f32 v76, v140, v141
  v_cvt_pk_bf16_f32 v77, v142, v143
  v_cvt_pk_bf16_f32 v78, v156, v157
  v_cvt_pk_bf16_f32 v79, v158, v159
  s_xor_b32 s98, s84, 24576
  s_add_u32 s98, s98, s83
  buffer_store_dwordx4 v[76:79], v0, s[52:55], s98 offen sc1
  v_cvt_pk_bf16_f32 v80, v160, v161
  v_cvt_pk_bf16_f32 v81, v162, v163
  v_cvt_pk_bf16_f32 v82, v176, v177
  v_cvt_pk_bf16_f32 v83, v178, v179
  s_xor_b32 s98, s84, 32768
  s_add_u32 s98, s98, s83
  buffer_store_dwordx4 v[80:83], v0, s[52:55], s98 offen sc1
  v_cvt_pk_bf16_f32 v84, v164, v165
  v_cvt_pk_bf16_f32 v85, v166, v167
  v_cvt_pk_bf16_f32 v86, v180, v181
  v_cvt_pk_bf16_f32 v87, v182, v183
  s_xor_b32 s98, s84, 40960
  s_add_u32 s98, s98, s83
  buffer_store_dwordx4 v[84:87], v0, s[52:55], s98 offen sc1
  v_cvt_pk_bf16_f32 v88, v168, v169
  v_cvt_pk_bf16_f32 v89, v170, v171
  v_cvt_pk_bf16_f32 v90, v184, v185
  v_cvt_pk_bf16_f32 v91, v186, v187
  s_xor_b32 s98, s84, 49152
  s_add_u32 s98, s98, s83
  buffer_store_dwordx4 v[88:91], v0, s[52:55], s98 offen sc1
  v_cvt_pk_bf16_f32 v92, v172, v173
  v_cvt_pk_bf16_f32 v93, v174, v175
  v_cvt_pk_bf16_f32 v94, v188, v189
  v_cvt_pk_bf16_f32 v95, v190, v191
  s_xor_b32 s98, s84, 57344
  s_add_u32 s98, s98, s83
  buffer_store_dwordx4 v[92:95], v0, s[52:55], s98 offen sc1
  v_cvt_pk_bf16_f32 v96, v192, v193
  v_cvt_pk_bf16_f32 v97, v194, v195
  v_cvt_pk_bf16_f32 v98, v208, v209
  v_cvt_pk_bf16_f32 v99, v210, v211
  s_xor_b32 s98, s84, 65536
  s_add_u32 s98, s98, s83
  buffer_store_dwordx4 v[96:99], v0, s[52:55], s98 offen sc1
  v_cvt_pk_bf16_f32 v100, v196, v197
  v_cvt_pk_bf16_f32 v101, v198, v199
  v_cvt_pk_bf16_f32 v102, v212, v213
  v_cvt_pk_bf16_f32 v103, v214, v215
  s_xor_b32 s98, s84, 73728
  s_add_u32 s98, s98, s83
  buffer_store_dwordx4 v[100:103], v0, s[52:55], s98 offen sc1
  v_cvt_pk_bf16_f32 v104, v200, v201
  v_cvt_pk_bf16_f32 v105, v202, v203
  v_cvt_pk_bf16_f32 v106, v216, v217
  v_cvt_pk_bf16_f32 v107, v218, v219
  s_xor_b32 s98, s84, 81920
  s_add_u32 s98, s98, s83
  buffer_store_dwordx4 v[104:107], v0, s[52:55], s98 offen sc1
  v_cvt_pk_bf16_f32 v108, v204, v205
  v_cvt_pk_bf16_f32 v109, v206, v207
  v_cvt_pk_bf16_f32 v110, v220, v221
  v_cvt_pk_bf16_f32 v111, v222, v223
  s_xor_b32 s98, s84, 90112
  s_add_u32 s98, s98, s83
  buffer_store_dwordx4 v[108:111], v0, s[52:55], s98 offen sc1
  v_cvt_pk_bf16_f32 v112, v224, v225
  v_cvt_pk_bf16_f32 v113, v226, v227
  v_cvt_pk_bf16_f32 v114, v240, v241
  v_cvt_pk_bf16_f32 v115, v242, v243
  s_xor_b32 s98, s84, 98304
  s_add_u32 s98, s98, s83
  buffer_store_dwordx4 v[112:115], v0, s[52:55], s98 offen sc1
  v_cvt_pk_bf16_f32 v116, v228, v229
  v_cvt_pk_bf16_f32 v117, v230, v231
  v_cvt_pk_bf16_f32 v118, v244, v245
  v_cvt_pk_bf16_f32 v119, v246, v247
  s_xor_b32 s98, s84, 106496
  s_add_u32 s98, s98, s83
  buffer_store_dwordx4 v[116:119], v0, s[52:55], s98 offen sc1
  v_cvt_pk_bf16_f32 v120, v232, v233
  v_cvt_pk_bf16_f32 v121, v234, v235
  v_cvt_pk_bf16_f32 v122, v248, v249
  v_cvt_pk_bf16_f32 v123, v250, v251
  s_xor_b32 s98, s84, 114688
  s_add_u32 s98, s98, s83
  buffer_store_dwordx4 v[120:123], v0, s[52:55], s98 offen sc1
  v_cvt_pk_bf16_f32 v124, v236, v237
  v_cvt_pk_bf16_f32 v125, v238, v239
  v_cvt_pk_bf16_f32 v126, v252, v253
  v_cvt_pk_bf16_f32 v127, v254, v255
  s_xor_b32 s98, s84, 122880
  s_add_u32 s98, s98, s83
  buffer_store_dwordx4 v[124:127], v0, s[52:55], s98 offen sc1
  s_waitcnt lgkmcnt(0)
  v_mfma_f32_16x16x32_bf16 v[128:131], a[0:3], a[96:99], 0
  s_add_u32 s58, s3, 8
  s_cmp_ge_u32 s58, s97
  s_cselect_b32 s98, 7, 0
  s_add_u32 s58, s58, s98
  s_lshl_b32 s98, s58, 15
  s_lshl_b32 s99, s3, 13
  s_add_u32 m0, s99, 65536
  s_nop 0
  buffer_load_dwordx4 v42, s[40:43], s98 offen offset:0  lds
  v_mfma_f32_16x16x32_bf16 v[144:147], a[4:7], a[96:99], 0
  buffer_load_dwordx4 v43, s[40:43], s98 offen offset:1024  lds
  buffer_load_dwordx4 v44, s[40:43], s98 offen offset:2048  lds
  buffer_load_dwordx4 v45, s[40:43], s98 offen offset:3072  lds
  s_lshl_b32 s98, s58, 12
  s_add_u32 s98, s98, s82
  v_mfma_f32_16x16x32_bf16 v[148:151], a[4:7], a[100:103], 0
  buffer_load_dwordx4 a[160:163], v0, s[52:55], s98 offen offset:0 sc1
  buffer_load_dwordx4 a[164:167], v0, s[52:55], s98 offen offset:1024 sc1
  buffer_load_dwordx4 a[168:171], v0, s[52:55], s98 offen offset:2048 sc1
  buffer_load_dwordx4 a[172:175], v0, s[52:55], s98 offen offset:3072 sc1
  v_mfma_f32_16x16x32_bf16 v[132:135], a[0:3], a[100:103], 0
  s_add_u32 s58, s3, 12
  s_cmp_ge_u32 s58, s97
  s_cselect_b32 s98, 7, 0
  s_add_u32 s58, s58, s98
  s_lshl_b32 s98, s58, 15
  s_lshl_b32 s99, s3, 13
  s_add_u32 m0, s99, 69632
  s_nop 0
  buffer_load_dwordx4 v42, s[40:43], s98 offen offset:0  lds
  v_mfma_f32_16x16x32_bf16 v[136:139], a[0:3], a[104:107], 0
  buffer_load_dwordx4 v43, s[40:43], s98 offen offset:1024  lds
  buffer_load_dwordx4 v44, s[40:43], s98 offen offset:2048  lds
  buffer_load_dwordx4 v45, s[40:43], s98 offen offset:3072  lds
  s_lshl_b32 s98, s58, 12
  s_add_u32 s98, s98, s82
  v_mfma_f32_16x16x32_bf16 v[152:155], a[4:7], a[104:107], 0
  buffer_load_dwordx4 a[176:179], v0, s[52:55], s98 offen offset:0 sc1
  buffer_load_dwordx4 a[180:183], v0, s[52:55], s98 offen offset:1024 sc1
  buffer_load_dwordx4 a[184:187], v0, s[52:55], s98 offen offset:2048 sc1
  buffer_load_dwordx4 a[188:191], v0, s[52:55], s98 offen offset:3072 sc1
  v_mfma_f32_16x16x32_bf16 v[156:159], a[4:7], a[108:111], 0
  s_add_u32 s58, s3, 16
  s_cmp_ge_u32 s58, s97
  s_cselect_b32 s98, 7, 0
  s_add_u32 s58, s58, s98
  s_lshl_b32 s98, s58, 15
  s_lshl_b32 s99, s3, 13
  s_add_u32 m0, s99, 0
  s_nop 0
  buffer_load_dwordx4 v42, s[40:43], s98 offen offset:0  lds
  v_mfma_f32_16x16x32_bf16 v[140:143], a[0:3], a[108:111], 0
  buffer_load_dwordx4 v43, s[40:43], s98 offen offset:1024  lds
  buffer_load_dwordx4 v44, s[40:43], s98 offen offset:2048  lds
  buffer_load_dwordx4 v45, s[40:43], s98 offen offset:3072  lds
  s_lshl_b32 s98, s58, 12
  s_add_u32 s98, s98, s82
  v_mfma_f32_16x16x32_bf16 v[168:171], a[8:11], a[104:107], 0
  buffer_load_dwordx4 a[192:195], v0, s[52:55], s98 offen offset:0 sc1
  buffer_load_dwordx4 a[196:199], v0, s[52:55], s98 offen offset:1024 sc1
  buffer_load_dwordx4 a[200:203], v0, s[52:55], s98 offen offset:2048 sc1
  buffer_load_dwordx4 a[204:207], v0, s[52:55], s98 offen offset:3072 sc1
  v_mfma_f32_16x16x32_bf16 v[184:187], a[12:15], a[104:107], 0
  s_waitcnt vmcnt(56)
  ds_read_b64_tr_b16 a[16:17], v8 offset:36864
  ds_read_b64_tr_b16 a[18:19], v8 offset:38912
  v_mfma_f32_16x16x32_bf16 v[188:191], a[12:15], a[108:111], 0
  ds_read_b64_tr_b16 a[20:21], v9 offset:36864
  ds_read_b64_tr_b16 a[22:23], v9 offset:38912
  v_mfma_f32_16x16x32_bf16 v[172:175], a[8:11], a[108:111], 0
  ds_read_b64_tr_b16 a[24:25], v10 offset:36864
  ds_read_b64_tr_b16 a[26:27], v10 offset:38912
  v_mfma_f32_16x16x32_bf16 v[160:163], a[8:11], a[96:99], 0
  ds_read_b64_tr_b16 a[28:29], v11 offset:36864
  ds_read_b64_tr_b16 a[30:31], v11 offset:38912
  v_mfma_f32_16x16x32_bf16 v[176:179], a[12:15], a[96:99], 0
  v_mfma_f32_16x16x32_bf16 v[180:183], a[12:15], a[100:103], 0
  v_mfma_f32_16x16x32_bf16 v[164:167], a[8:11], a[100:103], 0
  s_waitcnt vmcnt(52) lgkmcnt(0)
  v_mfma_f32_16x16x32_bf16 v[128:131], a[16:19], a[112:115], v[128:131]
  s_add_u32 s58, s3, 20
  s_cmp_ge_u32 s58, s97
  s_cselect_b32 s98, 7, 0
  s_add_u32 s58, s58, s98
  s_lshl_b32 s98, s58, 15
  v_mfma_f32_16x16x32_bf16 v[144:147], a[20:23], a[112:115], v[144:147]
  s_lshl_b32 s99, s3, 13
  s_add_u32 m0, s99, 4096
  v_mfma_f32_16x16x32_bf16 v[148:151], a[20:23], a[116:119], v[148:151]
  buffer_load_dwordx4 v42, s[40:43], s98 offen offset:0  lds
  v_mfma_f32_16x16x32_bf16 v[132:135], a[16:19], a[116:119], v[132:135]
  buffer_load_dwordx4 v43, s[40:43], s98 offen offset:1024  lds
  buffer_load_dwordx4 v44, s[40:43], s98 offen offset:2048  lds
  v_mfma_f32_16x16x32_bf16 v[136:139], a[16:19], a[120:123], v[136:139]
  buffer_load_dwordx4 v45, s[40:43], s98 offen offset:3072  lds
  v_mfma_f32_16x16x32_bf16 v[152:155], a[20:23], a[120:123], v[152:155]
  s_lshl_b32 s98, s58, 12
  s_add_u32 s98, s98, s82
  v_mfma_f32_16x16x32_bf16 v[156:159], a[20:23], a[124:127], v[156:159]
  buffer_load_dwordx4 a[96:99], v0, s[52:55], s98 offen offset:0 sc1
  v_mfma_f32_16x16x32_bf16 v[140:143], a[16:19], a[124:127], v[140:143]
  buffer_load_dwordx4 a[100:103], v0, s[52:55], s98 offen offset:1024 sc1
  buffer_load_dwordx4 a[104:107], v0, s[52:55], s98 offen offset:2048 sc1
  v_mfma_f32_16x16x32_bf16 v[168:171], a[24:27], a[120:123], v[168:171]
  buffer_load_dwordx4 a[108:111], v0, s[52:55], s98 offen offset:3072 sc1
  v_mfma_f32_16x16x32_bf16 v[184:187], a[28:31], a[120:123], v[184:187]
  s_waitcnt vmcnt(60)
  ds_read_b64_tr_b16 a[0:1], v12 offset:0
  ds_read_b64_tr_b16 a[2:3], v12 offset:2048
  v_mfma_f32_16x16x32_bf16 v[188:191], a[28:31], a[124:127], v[188:191]
  ds_read_b64_tr_b16 a[4:5], v13 offset:0
  ds_read_b64_tr_b16 a[6:7], v13 offset:2048
  v_mfma_f32_16x16x32_bf16 v[172:175], a[24:27], a[124:127], v[172:175]
  ds_read_b64_tr_b16 a[8:9], v14 offset:0
  ds_read_b64_tr_b16 a[10:11], v14 offset:2048
  v_mfma_f32_16x16x32_bf16 v[160:163], a[24:27], a[112:115], v[160:163]
  ds_read_b64_tr_b16 a[12:13], v15 offset:0
  ds_read_b64_tr_b16 a[14:15], v15 offset:2048
  v_mfma_f32_16x16x32_bf16 v[176:179], a[28:31], a[112:115], v[176:179]
  v_mfma_f32_16x16x32_bf16 v[180:183], a[28:31], a[116:119], v[180:183]
  v_mfma_f32_16x16x32_bf16 v[164:167], a[24:27], a[116:119], v[164:167]
  s_waitcnt vmcnt(32)
  s_barrier
  s_mov_b32 s56, s3
  s_cmp_lg_u32 s56, 0
  s_cbranch_scc1 L_sig_19
  v_mov_b32 v30, s88
  v_mov_b32 v31, 1
  s_mov_b64 exec, 1
  buffer_store_dword v31, v30, s[52:55], 0 offen offset:128 sc1
  s_mov_b64 exec, -1
L_sig_19:
  s_waitcnt vmcnt(56) lgkmcnt(0)
  v_mfma_f32_16x16x32_bf16 v[128:131], a[0:3], a[128:131], v[128:131]
  s_add_u32 s58, s3, 24
  s_cmp_ge_u32 s58, s97
  s_cselect_b32 s98, 7, 0
  s_add_u32 s58, s58, s98
  s_lshl_b32 s98, s58, 15
  v_mfma_f32_16x16x32_bf16 v[144:147], a[4:7], a[128:131], v[144:147]
  s_lshl_b32 s99, s3, 13
  s_add_u32 m0, s99, 32768
  v_mfma_f32_16x16x32_bf16 v[148:151], a[4:7], a[132:135], v[148:151]
  buffer_load_dwordx4 v42, s[40:43], s98 offen offset:0  lds
  v_mfma_f32_16x16x32_bf16 v[132:135], a[0:3], a[132:135], v[132:135]
  buffer_load_dwordx4 v43, s[40:43], s98 offen offset:1024  lds
  buffer_load_dwordx4 v44, s[40:43], s98 offen offset:2048  lds
  v_mfma_f32_16x16x32_bf16 v[136:139], a[0:3], a[136:139], v[136:139]
  buffer_load_dwordx4 v45, s[40:43], s98 offen offset:3072  lds
  v_mfma_f32_16x16x32_bf16 v[152:155], a[4:7], a[136:139], v[152:155]
  s_lshl_b32 s98, s58, 12
  s_add_u32 s98, s98, s82
  v_mfma_f32_16x16x32_bf16 v[156:159], a[4:7], a[140:143], v[156:159]
  buffer_load_dwordx4 a[112:115], v0, s[52:55], s98 offen offset:0 sc1
  v_mfma_f32_16x16x32_bf16 v[140:143], a[0:3], a[140:143], v[140:143]
  buffer_load_dwordx4 a[116:119], v0, s[52:55], s98 offen offset:1024 sc1
  buffer_load_dwordx4 a[120:123], v0, s[52:55], s98 offen offset:2048 sc1
  v_mfma_f32_16x16x32_bf16 v[168:171], a[8:11], a[136:139], v[168:171]
  buffer_load_dwordx4 a[124:127], v0, s[52:55], s98 offen offset:3072 sc1
  v_mfma_f32_16x16x32_bf16 v[184:187], a[12:15], a[136:139], v[184:187]
  s_waitcnt vmcnt(60)
  ds_read_b64_tr_b16 a[16:17], v12 offset:4096
  ds_read_b64_tr_b16 a[18:19], v12 offset:6144
  v_mfma_f32_16x16x32_bf16 v[188:191], a[12:15], a[140:143], v[188:191]
  ds_read_b64_tr_b16 a[20:21], v13 offset:4096
  ds_read_b64_tr_b16 a[22:23], v13 offset:6144
  v_mfma_f32_16x16x32_bf16 v[172:175], a[8:11], a[140:143], v[172:175]
  ds_read_b64_tr_b16 a[24:25], v14 offset:4096
  ds_read_b64_tr_b16 a[26:27], v14 offset:6144
  v_mfma_f32_16x16x32_bf16 v[160:163], a[8:11], a[128:131], v[160:163]
  ds_read_b64_tr_b16 a[28:29], v15 offset:4096
  ds_read_b64_tr_b16 a[30:31], v15 offset:6144
  v_mfma_f32_16x16x32_bf16 v[176:179], a[12:15], a[128:131], v[176:179]
  v_mfma_f32_16x16x32_bf16 v[180:183], a[12:15], a[132:135], v[180:183]
  v_mfma_f32_16x16x32_bf16 v[164:167], a[8:11], a[132:135], v[164:167]
  s_waitcnt vmcnt(56) lgkmcnt(0)
  v_mfma_f32_16x16x32_bf16 v[128:131], a[16:19], a[144:147], v[128:131]
  s_add_u32 s58, s3, 28
  s_cmp_ge_u32 s58, s97
  s_cselect_b32 s98, 7, 0
  s_add_u32 s58, s58, s98
  s_lshl_b32 s98, s58, 15
  v_mfma_f32_16x16x32_bf16 v[144:147], a[20:23], a[144:147], v[144:147]
  s_lshl_b32 s99, s3, 13
  s_add_u32 m0, s99, 36864
  v_mfma_f32_16x16x32_bf16 v[148:151], a[20:23], a[148:151], v[148:151]
  buffer_load_dwordx4 v42, s[40:43], s98 offen offset:0  lds
  v_mfma_f32_16x16x32_bf16 v[132:135], a[16:19], a[148:151], v[132:135]
  buffer_load_dwordx4 v43, s[40:43], s98 offen offset:1024  lds
  buffer_load_dwordx4 v44, s[40:43], s98 offen offset:2048  lds
  v_mfma_f32_16x16x32_bf16 v[136:139], a[16:19], a[152:155], v[136:139]
  buffer_load_dwordx4 v45, s[40:43], s98 offen offset:3072  lds
  v_mfma_f32_16x16x32_bf16 v[152:155], a[20:23], a[152:155], v[152:155]
  s_lshl_b32 s98, s58, 12
  s_add_u32 s98, s98, s82
  v_mfma_f32_16x16x32_bf16 v[156:159], a[20:23], a[156:159], v[156:159]
  buffer_load_dwordx4 a[128:131], v0, s[52:55], s98 offen offset:0 sc1
  v_mfma_f32_16x16x32_bf16 v[140:143], a[16:19], a[156:159], v[140:143]
  buffer_load_dwordx4 a[132:135], v0, s[52:55], s98 offen offset:1024 sc1
  buffer_load_dwordx4 a[136:139], v0, s[52:55], s98 offen offset:2048 sc1
  v_mfma_f32_16x16x32_bf16 v[168:171], a[24:27], a[152:155], v[168:171]
  buffer_load_dwordx4 a[140:143], v0, s[52:55], s98 offen offset:3072 sc1
  v_mfma_f32_16x16x32_bf16 v[184:187], a[28:31], a[152:155], v[184:187]
  s_waitcnt vmcnt(44)
  ds_read_b64_tr_b16 a[0:1], v8 offset:0
  ds_read_b64_tr_b16 a[2:3], v8 offset:2048
  v_mfma_f32_16x16x32_bf16 v[188:191], a[28:31], a[156:159], v[188:191]
  ds_read_b64_tr_b16 a[4:5], v9 offset:0
  ds_read_b64_tr_b16 a[6:7], v9 offset:2048
  v_mfma_f32_16x16x32_bf16 v[172:175], a[24:27], a[156:159], v[172:175]
  ds_read_b64_tr_b16 a[8:9], v10 offset:0
  ds_read_b64_tr_b16 a[10:11], v10 offset:2048
  v_mfma_f32_16x16x32_bf16 v[160:163], a[24:27], a[144:147], v[160:163]
  ds_read_b64_tr_b16 a[12:13], v11 offset:0
  ds_read_b64_tr_b16 a[14:15], v11 offset:2048
  v_mfma_f32_16x16x32_bf16 v[176:179], a[28:31], a[144:147], v[176:179]
  v_mfma_f32_16x16x32_bf16 v[180:183], a[28:31], a[148:151], v[180:183]
  v_mfma_f32_16x16x32_bf16 v[164:167], a[24:27], a[148:151], v[164:167]
  s_waitcnt vmcnt(40) lgkmcnt(0)
  v_mfma_f32_16x16x32_bf16 v[128:131], a[0:3], a[160:163], v[128:131]
  s_add_u32 s58, s3, 32
  s_cmp_ge_u32 s58, s97
  s_cselect_b32 s98, 7, 0
  s_add_u32 s58, s58, s98
  s_lshl_b32 s98, s58, 15
  v_mfma_f32_16x16x32_bf16 v[144:147], a[4:7], a[160:163], v[144:147]
  s_lshl_b32 s99, s3, 13
  s_add_u32 m0, s99, 98304
  v_mfma_f32_16x16x32_bf16 v[148:151], a[4:7], a[164:167], v[148:151]
  buffer_load_dwordx4 v42, s[40:43], s98 offen offset:0  lds
  v_mfma_f32_16x16x32_bf16 v[132:135], a[0:3], a[164:167], v[132:135]
  buffer_load_dwordx4 v43, s[40:43], s98 offen offset:1024  lds
  buffer_load_dwordx4 v44, s[40:43], s98 offen offset:2048  lds
  v_mfma_f32_16x16x32_bf16 v[136:139], a[0:3], a[168:171], v[136:139]
  buffer_load_dwordx4 v45, s[40:43], s98 offen offset:3072  lds
  v_mfma_f32_16x16x32_bf16 v[152:155], a[4:7], a[168:171], v[152:155]
  s_lshl_b32 s98, s58, 12
  s_add_u32 s98, s98, s82
  v_mfma_f32_16x16x32_bf16 v[156:159], a[4:7], a[172:175], v[156:159]
  buffer_load_dwordx4 a[144:147], v0, s[52:55], s98 offen offset:0 sc1
  v_mfma_f32_16x16x32_bf16 v[140:143], a[0:3], a[172:175], v[140:143]
  buffer_load_dwordx4 a[148:151], v0, s[52:55], s98 offen offset:1024 sc1
  buffer_load_dwordx4 a[152:155], v0, s[52:55], s98 offen offset:2048 sc1
  v_mfma_f32_16x16x32_bf16 v[168:171], a[8:11], a[168:171], v[168:171]
  buffer_load_dwordx4 a[156:159], v0, s[52:55], s98 offen offset:3072 sc1
  v_mfma_f32_16x16x32_bf16 v[184:187], a[12:15], a[168:171], v[184:187]
  s_waitcnt vmcnt(44)
  ds_read_b64_tr_b16 a[16:17], v8 offset:4096
  ds_read_b64_tr_b16 a[18:19], v8 offset:6144
  v_mfma_f32_16x16x32_bf16 v[188:191], a[12:15], a[172:175], v[188:191]
  ds_read_b64_tr_b16 a[20:21], v9 offset:4096
  ds_read_b64_tr_b16 a[22:23], v9 offset:6144
  v_mfma_f32_16x16x32_bf16 v[172:175], a[8:11], a[172:175], v[172:175]
  ds_read_b64_tr_b16 a[24:25], v10 offset:4096
  ds_read_b64_tr_b16 a[26:27], v10 offset:6144
  v_mfma_f32_16x16x32_bf16 v[160:163], a[8:11], a[160:163], v[160:163]
  ds_read_b64_tr_b16 a[28:29], v11 offset:4096
  ds_read_b64_tr_b16 a[30:31], v11 offset:6144
  v_mfma_f32_16x16x32_bf16 v[176:179], a[12:15], a[160:163], v[176:179]
  v_mfma_f32_16x16x32_bf16 v[180:183], a[12:15], a[164:167], v[180:183]
  v_mfma_f32_16x16x32_bf16 v[164:167], a[8:11], a[164:167], v[164:167]
  s_waitcnt vmcnt(40) lgkmcnt(0)
  v_mfma_f32_16x16x32_bf16 v[128:131], a[16:19], a[176:179], v[128:131]
  s_add_u32 s58, s3, 36
  s_cmp_ge_u32 s58, s97
  s_cselect_b32 s98, 7, 0
  s_add_u32 s58, s58, s98
  s_lshl_b32 s98, s58, 15
  v_mfma_f32_16x16x32_bf16 v[144:147], a[20:23], a[176:179], v[144:147]
  s_lshl_b32 s99, s3, 13
  s_add_u32 m0, s99, 102400
  v_mfma_f32_16x16x32_bf16 v[148:151], a[20:23], a[180:183], v[148:151]
  buffer_load_dwordx4 v42, s[40:43], s98 offen offset:0  lds
  v_mfma_f32_16x16x32_bf16 v[132:135], a[16:19], a[180:183], v[132:135]
  buffer_load_dwordx4 v43, s[40:43], s98 offen offset:1024  lds
  buffer_load_dwordx4 v44, s[40:43], s98 offen offset:2048  lds
  v_mfma_f32_16x16x32_bf16 v[136:139], a[16:19], a[184:187], v[136:139]
  buffer_load_dwordx4 v45, s[40:43], s98 offen offset:3072  lds
  v_mfma_f32_16x16x32_bf16 v[152:155], a[20:23], a[184:187], v[152:155]
  s_lshl_b32 s98, s58, 12
  s_add_u32 s98, s98, s82
  v_mfma_f32_16x16x32_bf16 v[156:159], a[20:23], a[188:191], v[156:159]
  buffer_load_dwordx4 a[160:163], v0, s[52:55], s98 offen offset:0 sc1
  v_mfma_f32_16x16x32_bf16 v[140:143], a[16:19], a[188:191], v[140:143]
  buffer_load_dwordx4 a[164:167], v0, s[52:55], s98 offen offset:1024 sc1
  buffer_load_dwordx4 a[168:171], v0, s[52:55], s98 offen offset:2048 sc1
  v_mfma_f32_16x16x32_bf16 v[168:171], a[24:27], a[184:187], v[168:171]
  buffer_load_dwordx4 a[172:175], v0, s[52:55], s98 offen offset:3072 sc1
  v_mfma_f32_16x16x32_bf16 v[184:187], a[28:31], a[184:187], v[184:187]
  s_waitcnt vmcnt(44)
  ds_read_b64_tr_b16 a[0:1], v4 offset:0
  ds_read_b64_tr_b16 a[2:3], v4 offset:2048
  v_mfma_f32_16x16x32_bf16 v[188:191], a[28:31], a[188:191], v[188:191]
  ds_read_b64_tr_b16 a[4:5], v5 offset:0
  ds_read_b64_tr_b16 a[6:7], v5 offset:2048
  v_and_b32 v46, 7, v1
  v_mfma_f32_16x16x32_bf16 v[172:175], a[24:27], a[188:191], v[172:175]
  ds_read_b64_tr_b16 a[8:9], v6 offset:0
  ds_read_b64_tr_b16 a[10:11], v6 offset:2048
  v_mfma_f32_16x16x32_bf16 v[160:163], a[24:27], a[176:179], v[160:163]
  ds_read_b64_tr_b16 a[12:13], v7 offset:0
  ds_read_b64_tr_b16 a[14:15], v7 offset:2048
  v_lshl_add_u32 v46, v46, 2, s74
  v_mfma_f32_16x16x32_bf16 v[176:179], a[28:31], a[176:179], v[176:179]
  v_mfma_f32_16x16x32_bf16 v[180:183], a[28:31], a[180:183], v[180:183]
  buffer_load_dword v47, v46, s[52:55], 0 offen offset:128 sc1
  v_mfma_f32_16x16x32_bf16 v[164:167], a[24:27], a[180:183], v[164:167]
  s_waitcnt vmcnt(41) lgkmcnt(0)
  v_mfma_f32_16x16x32_bf16 v[128:131], a[0:3], a[192:195], v[128:131]
  s_add_u32 s58, s3, 40
  s_cmp_ge_u32 s58, s97
  s_cselect_b32 s98, 7, 0
  s_add_u32 s58, s58, s98
  s_lshl_b32 s98, s58, 15
  v_mfma_f32_16x16x32_bf16 v[144:147], a[4:7], a[192:195], v[144:147]
  s_lshl_b32 s99, s3, 13
  s_add_u32 m0, s99, 131072
  v_mfma_f32_16x16x32_bf16 v[148:151], a[4:7], a[196:199], v[148:151]
  buffer_load_dwordx4 v42, s[40:43], s98 offen offset:0  lds
  v_mfma_f32_16x16x32_bf16 v[132:135], a[0:3], a[196:199], v[132:135]
  buffer_load_dwordx4 v43, s[40:43], s98 offen offset:1024  lds
  buffer_load_dwordx4 v44, s[40:43], s98 offen offset:2048  lds
  v_mfma_f32_16x16x32_bf16 v[136:139], a[0:3], a[200:203], v[136:139]
  buffer_load_dwordx4 v45, s[40:43], s98 offen offset:3072  lds
  v_mfma_f32_16x16x32_bf16 v[152:155], a[4:7], a[200:203], v[152:155]
  s_lshl_b32 s98, s58, 12
  s_add_u32 s98, s98, s82
  v_mfma_f32_16x16x32_bf16 v[156:159], a[4:7], a[204:207], v[156:159]
  buffer_load_dwordx4 a[176:179], v0, s[52:55], s98 offen offset:0 sc1
  v_mfma_f32_16x16x32_bf16 v[140:143], a[0:3], a[204:207], v[140:143]
  buffer_load_dwordx4 a[180:183], v0, s[52:55], s98 offen offset:1024 sc1
  buffer_load_dwordx4 a[184:187], v0, s[52:55], s98 offen offset:2048 sc1
  v_mfma_f32_16x16x32_bf16 v[168:171], a[8:11], a[200:203], v[168:171]
  buffer_load_dwordx4 a[188:191], v0, s[52:55], s98 offen offset:3072 sc1
  v_mfma_f32_16x16x32_bf16 v[184:187], a[12:15], a[200:203], v[184:187]
  s_waitcnt vmcnt(45)
  ds_read_b64_tr_b16 a[16:17], v4 offset:4096
  ds_read_b64_tr_b16 a[18:19], v4 offset:6144
  v_mfma_f32_16x16x32_bf16 v[188:191], a[12:15], a[204:207], v[188:191]
  ds_read_b64_tr_b16 a[20:21], v5 offset:4096
  ds_read_b64_tr_b16 a[22:23], v5 offset:6144
  v_mfma_f32_16x16x32_bf16 v[172:175], a[8:11], a[204:207], v[172:175]
  ds_read_b64_tr_b16 a[24:25], v6 offset:4096
  ds_read_b64_tr_b16 a[26:27], v6 offset:6144
  v_mfma_f32_16x16x32_bf16 v[160:163], a[8:11], a[192:195], v[160:163]
  ds_read_b64_tr_b16 a[28:29], v7 offset:4096
  ds_read_b64_tr_b16 a[30:31], v7 offset:6144
  v_mfma_f32_16x16x32_bf16 v[176:179], a[12:15], a[192:195], v[176:179]
  buffer_load_dword v47, v46, s[52:55], 0 offen offset:128 sc1
  v_mfma_f32_16x16x32_bf16 v[180:183], a[12:15], a[196:199], v[180:183]
  v_mfma_f32_16x16x32_bf16 v[164:167], a[8:11], a[196:199], v[164:167]
  s_waitcnt vmcnt(9)
  s_bitcmp1_b32 s100, 0
  s_cbranch_scc1 L_sp_20
  v_cmp_ne_u32 vcc, 1, v47
  s_mov_b64 s[58:59], 0x55
  s_and_b64 vcc, vcc, s[58:59]
  s_cbranch_vccnz L_sp_20
  s_bitset1_b32 s100, 0
  s_xor_b32 s56, s86, 0
  s_add_u32 s56, s56, s85
  s_add_u32 s56, s56, 0
  buffer_load_dwordx4 v[224:227], v0, s[52:55], s56 offen offset:0 sc1
  buffer_load_dwordx4 v[228:231], v0, s[52:55], s56 offen offset:2048 sc1
  s_xor_b32 s56, s86, 0
  s_add_u32 s56, s56, s85
  s_add_u32 s56, s56, 4096
  buffer_load_dwordx4 v[232:235], v0, s[52:55], s56 offen offset:0 sc1
  buffer_load_dwordx4 v[236:239], v0, s[52:55], s56 offen offset:2048 sc1
  s_xor_b32 s56, s86, 8192
  s_add_u32 s56, s56, s85
  s_add_u32 s56, s56, 0
  buffer_load_dwordx4 v[240:243], v0, s[52:55], s56 offen offset:0 sc1
  buffer_load_dwordx4 v[244:247], v0, s[52:55], s56 offen offset:2048 sc1
  s_xor_b32 s56, s86, 8192
  s_add_u32 s56, s56, s85
  s_add_u32 s56, s56, 4096
  buffer_load_dwordx4 v[248:251], v0, s[52:55], s56 offen offset:0 sc1
  buffer_load_dwordx4 v[252:255], v0, s[52:55], s56 offen offset:2048 sc1
L_sp_20:
  s_waitcnt vmcnt(42) lgkmcnt(0)
  v_mfma_f32_16x16x32_bf16 v[128:131], a[16:19], a[96:99], v[128:131]
  s_add_u32 s58, s3, 44
  s_cmp_ge_u32 s58, s97
  s_cselect_b32 s98, 7, 0
  s_add_u32 s58, s58, s98
  s_lshl_b32 s98, s58, 15
  v_mfma_f32_16x16x32_bf16 v[144:147], a[20:23], a[96:99], v[144:147]
  s_lshl_b32 s99, s3, 13
  s_add_u32 m0, s99, 135168
  v_mfma_f32_16x16x32_bf16 v[148:151], a[20:23], a[100:103], v[148:151]
  buffer_load_dwordx4 v42, s[40:43], s98 offen offset:0  lds
  v_mfma_f32_16x16x32_bf16 v[132:135], a[16:19], a[100:103], v[132:135]
  buffer_load_dwordx4 v43, s[40:43], s98 offen offset:1024  lds
  buffer_load_dwordx4 v44, s[40:43], s98 offen offset:2048  lds
  v_mfma_f32_16x16x32_bf16 v[136:139], a[16:19], a[104:107], v[136:139]
  buffer_load_dwordx4 v45, s[40:43], s98 offen offset:3072  lds
  v_mfma_f32_16x16x32_bf16 v[152:155], a[20:23], a[104:107], v[152:155]
  s_lshl_b32 s98, s58, 12
  s_add_u32 s98, s98, s82
  v_mfma_f32_16x16x32_bf16 v[156:159], a[20:23], a[108:111], v[156:159]
  buffer_load_dwordx4 a[192:195], v0, s[52:55], s98 offen offset:0 sc1
  v_mfma_f32_16x16x32_bf16 v[140:143], a[16:19], a[108:111], v[140:143]
  buffer_load_dwordx4 a[196:199], v0, s[52:55], s98 offen offset:1024 sc1
  buffer_load_dwordx4 a[200:203], v0, s[52:55], s98 offen offset:2048 sc1
  v_mfma_f32_16x16x32_bf16 v[168:171], a[24:27], a[104:107], v[168:171]
  buffer_load_dwordx4 a[204:207], v0, s[52:55], s98 offen offset:3072 sc1
  v_mfma_f32_16x16x32_bf16 v[184:187], a[28:31], a[104:107], v[184:187]
  s_waitcnt vmcnt(46)
  ds_read_b64_tr_b16 a[0:1], v4 offset:32768
  ds_read_b64_tr_b16 a[2:3], v4 offset:34816
  v_mfma_f32_16x16x32_bf16 v[188:191], a[28:31], a[108:111], v[188:191]
  ds_read_b64_tr_b16 a[4:5], v5 offset:32768
  ds_read_b64_tr_b16 a[6:7], v5 offset:34816
  v_mfma_f32_16x16x32_bf16 v[172:175], a[24:27], a[108:111], v[172:175]
  ds_read_b64_tr_b16 a[8:9], v6 offset:32768
  ds_read_b64_tr_b16 a[10:11], v6 offset:34816
  v_mfma_f32_16x16x32_bf16 v[160:163], a[24:27], a[96:99], v[160:163]
  ds_read_b64_tr_b16 a[12:13], v7 offset:32768
  ds_read_b64_tr_b16 a[14:15], v7 offset:34816
  s_waitcnt vmcnt(8)
  s_bitcmp1_b32 s100, 0
  s_cbranch_scc1 L_sp_21
  v_cmp_ne_u32 vcc, 1, v47
  s_cbranch_vccnz L_sp_21
  s_bitset1_b32 s100, 0
  s_xor_b32 s56, s86, 0
  s_add_u32 s56, s56, s85
  s_add_u32 s56, s56, 0
  buffer_load_dwordx4 v[224:227], v0, s[52:55], s56 offen offset:0 sc1
  buffer_load_dwordx4 v[228:231], v0, s[52:55], s56 offen offset:2048 sc1
  s_xor_b32 s56, s86, 0
  s_add_u32 s56, s56, s85
  s_add_u32 s56, s56, 4096
  buffer_load_dwordx4 v[232:235], v0, s[52:55], s56 offen offset:0 sc1
  buffer_load_dwordx4 v[236:239], v0, s[52:55], s56 offen offset:2048 sc1
  s_xor_b32 s56, s86, 8192
  s_add_u32 s56, s56, s85
  s_add_u32 s56, s56, 0
  buffer_load_dwordx4 v[240:243], v0, s[52:55], s56 offen offset:0 sc1
  buffer_load_dwordx4 v[244:247], v0, s[52:55], s56 offen offset:2048 sc1
  s_xor_b32 s56, s86, 8192
  s_add_u32 s56, s56, s85
  s_add_u32 s56, s56, 4096
  buffer_load_dwordx4 v[248:251], v0, s[52:55], s56 offen offset:0 sc1
  buffer_load_dwordx4 v[252:255], v0, s[52:55], s56 offen offset:2048 sc1
L_sp_21:
  s_bitcmp1_b32 s100, 1
  s_cbranch_scc1 L_sp_22
  v_cmp_ne_u32 vcc, 1, v47
  s_cbranch_vccnz L_sp_22
  s_bitset1_b32 s100, 1
  s_xor_b32 s56, s86, 0
  s_add_u32 s56, s56, s85
  s_add_u32 s56, s56, 0
  buffer_load_dwordx4 v[64:67], v0, s[52:55], s56 offen offset:1024 sc1
  buffer_load_dwordx4 v[68:71], v0, s[52:55], s56 offen offset:3072 sc1
  s_xor_b32 s56, s86, 0
  s_add_u32 s56, s56, s85
  s_add_u32 s56, s56, 4096
  buffer_load_dwordx4 v[72:75], v0, s[52:55], s56 offen offset:1024 sc1
  buffer_load_dwordx4 v[76:79], v0, s[52:55], s56 offen offset:3072 sc1
  s_xor_b32 s56, s86, 8192
  s_add_u32 s56, s56, s85
  s_add_u32 s56, s56, 0
  buffer_load_dwordx4 v[80:83], v0, s[52:55], s56 offen offset:1024 sc1
  buffer_load_dwordx4 v[84:87], v0, s[52:55], s56 offen offset:3072 sc1
  s_xor_b32 s56, s86, 8192
  s_add_u32 s56, s56, s85
  s_add_u32 s56, s56, 4096
  buffer_load_dwordx4 v[88:91], v0, s[52:55], s56 offen offset:1024 sc1
  buffer_load_dwordx4 v[92:95], v0, s[52:55], s56 offen offset:3072 sc1
L_sp_22:
  v_mfma_f32_16x16x32_bf16 v[176:179], a[28:31], a[96:99], v[176:179]
  v_mfma_f32_16x16x32_bf16 v[180:183], a[28:31], a[100:103], v[180:183]
  v_mfma_f32_16x16x32_bf16 v[164:167], a[24:27], a[100:103], v[164:167]
  s_waitcnt vmcnt(42) lgkmcnt(0)
  v_mfma_f32_16x16x32_bf16 v[128:131], a[0:3], a[112:115], v[128:131]
  v_mfma_f32_16x16x32_bf16 v[144:147], a[4:7], a[112:115], v[144:147]
  v_mfma_f32_16x16x32_bf16 v[148:151], a[4:7], a[116:119], v[148:151]
  v_mfma_f32_16x16x32_bf16 v[132:135], a[0:3], a[116:119], v[132:135]
  v_mfma_f32_16x16x32_bf16 v[136:139], a[0:3], a[120:123], v[136:139]
  v_mfma_f32_16x16x32_bf16 v[152:155], a[4:7], a[120:123], v[152:155]
  v_mfma_f32_16x16x32_bf16 v[156:159], a[4:7], a[124:127], v[156:159]
  v_mfma_f32_16x16x32_bf16 v[140:143], a[0:3], a[124:127], v[140:143]
  v_mfma_f32_16x16x32_bf16 v[168:171], a[8:11], a[120:123], v[168:171]
  v_mfma_f32_16x16x32_bf16 v[184:187], a[12:15], a[120:123], v[184:187]
  s_waitcnt vmcnt(38)
  ds_read_b64_tr_b16 a[16:17], v4 offset:36864
  ds_read_b64_tr_b16 a[18:19], v4 offset:38912
  v_mfma_f32_16x16x32_bf16 v[188:191], a[12:15], a[124:127], v[188:191]
  ds_read_b64_tr_b16 a[20:21], v5 offset:36864
  ds_read_b64_tr_b16 a[22:23], v5 offset:38912
  v_mfma_f32_16x16x32_bf16 v[172:175], a[8:11], a[124:127], v[172:175]
  ds_read_b64_tr_b16 a[24:25], v6 offset:36864
  ds_read_b64_tr_b16 a[26:27], v6 offset:38912
  v_mfma_f32_16x16x32_bf16 v[160:163], a[8:11], a[112:115], v[160:163]
  ds_read_b64_tr_b16 a[28:29], v7 offset:36864
  ds_read_b64_tr_b16 a[30:31], v7 offset:38912
  v_mfma_f32_16x16x32_bf16 v[176:179], a[12:15], a[112:115], v[176:179]
  v_mfma_f32_16x16x32_bf16 v[180:183], a[12:15], a[116:119], v[180:183]
  v_mfma_f32_16x16x32_bf16 v[164:167], a[8:11], a[116:119], v[164:167]
  s_waitcnt vmcnt(34) lgkmcnt(0)
  v_mfma_f32_16x16x32_bf16 v[128:131], a[16:19], a[128:131], v[128:131]
  buffer_load_dwordx4 v[192:195], v20, s[8:11], s87 offen
  v_mfma_f32_16x16x32_bf16 v[144:147], a[20:23], a[128:131], v[144:147]
  v_mfma_f32_16x16x32_bf16 v[148:151], a[20:23], a[132:135], v[148:151]
  v_mfma_f32_16x16x32_bf16 v[132:135], a[16:19], a[132:135], v[132:135]
  s_add_u32 s57, s87, 16384
  v_mfma_f32_16x16x32_bf16 v[136:139], a[16:19], a[136:139], v[136:139]
  v_mfma_f32_16x16x32_bf16 v[152:155], a[20:23], a[136:139], v[152:155]
  v_mfma_f32_16x16x32_bf16 v[156:159], a[20:23], a[140:143], v[156:159]
  buffer_load_dwordx4 v[196:199], v20, s[8:11], s57 offen
  v_mfma_f32_16x16x32_bf16 v[140:143], a[16:19], a[140:143], v[140:143]
  v_mfma_f32_16x16x32_bf16 v[168:171], a[24:27], a[136:139], v[168:171]
  v_mfma_f32_16x16x32_bf16 v[184:187], a[28:31], a[136:139], v[184:187]
  s_waitcnt vmcnt(32)
  ds_read_b64_tr_b16 a[0:1], v8 offset:32768
  ds_read_b64_tr_b16 a[2:3], v8 offset:34816
  v_mfma_f32_16x16x32_bf16 v[188:191], a[28:31], a[140:143], v[188:191]
  ds_read_b64_tr_b16 a[4:5], v9 offset:32768
  ds_read_b64_tr_b16 a[6:7], v9 offset:34816
  v_mfma_f32_16x16x32_bf16 v[172:175], a[24:27], a[140:143], v[172:175]
  ds_read_b64_tr_b16 a[8:9], v10 offset:32768
  ds_read_b64_tr_b16 a[10:11], v10 offset:34816
  v_mfma_f32_16x16x32_bf16 v[160:163], a[24:27], a[128:131], v[160:163]
  ds_read_b64_tr_b16 a[12:13], v11 offset:32768
  ds_read_b64_tr_b16 a[14:15], v11 offset:34816
  v_mfma_f32_16x16x32_bf16 v[176:179], a[28:31], a[128:131], v[176:179]
  v_mfma_f32_16x16x32_bf16 v[180:183], a[28:31], a[132:135], v[180:183]
  v_mfma_f32_16x16x32_bf16 v[164:167], a[24:27], a[132:135], v[164:167]
  s_waitcnt vmcnt(28) lgkmcnt(0)
  v_mfma_f32_16x16x32_bf16 v[128:131], a[0:3], a[144:147], v[128:131]
  v_mfma_f32_16x16x32_bf16 v[144:147], a[4:7], a[144:147], v[144:147]
  v_mfma_f32_16x16x32_bf16 v[148:151], a[4:7], a[148:151], v[148:151]
  v_mfma_f32_16x16x32_bf16 v[132:135], a[0:3], a[148:151], v[132:135]
  v_mfma_f32_16x16x32_bf16 v[136:139], a[0:3], a[152:155], v[136:139]
  v_mfma_f32_16x16x32_bf16 v[152:155], a[4:7], a[152:155], v[152:155]
  v_mfma_f32_16x16x32_bf16 v[156:159], a[4:7], a[156:159], v[156:159]
  v_mfma_f32_16x16x32_bf16 v[140:143], a[0:3], a[156:159], v[140:143]
  v_mfma_f32_16x16x32_bf16 v[168:171], a[8:11], a[152:155], v[168:171]
  v_mfma_f32_16x16x32_bf16 v[184:187], a[12:15], a[152:155], v[184:187]
  s_waitcnt vmcnt(24)
  ds_read_b64_tr_b16 a[16:17], v8 offset:36864
  ds_read_b64_tr_b16 a[18:19], v8 offset:38912
  v_mfma_f32_16x16x32_bf16 v[188:191], a[12:15], a[156:159], v[188:191]
  ds_read_b64_tr_b16 a[20:21], v9 offset:36864
  ds_read_b64_tr_b16 a[22:23], v9 offset:38912
  v_mfma_f32_16x16x32_bf16 v[172:175], a[8:11], a[156:159], v[172:175]
  ds_read_b64_tr_b16 a[24:25], v10 offset:36864
  ds_read_b64_tr_b16 a[26:27], v10 offset:38912
  v_mfma_f32_16x16x32_bf16 v[160:163], a[8:11], a[144:147], v[160:163]
  ds_read_b64_tr_b16 a[28:29], v11 offset:36864
  ds_read_b64_tr_b16 a[30:31], v11 offset:38912
  v_mfma_f32_16x16x32_bf16 v[176:179], a[12:15], a[144:147], v[176:179]
  v_mfma_f32_16x16x32_bf16 v[180:183], a[12:15], a[148:151], v[180:183]
  v_mfma_f32_16x16x32_bf16 v[164:167], a[8:11], a[148:151], v[164:167]
  s_bitcmp1_b32 s100, 0
  s_cbranch_scc1 L_sp_23
  s_mov_b32 s101, 0
L_spin_24:
  buffer_load_dword v47, v46, s[52:55], 0 offen offset:128 sc1
  s_waitcnt vmcnt(0)
  s_add_u32 s101, s101, 1
  s_cmp_gt_u32 s101, 0x40000
  s_cbranch_scc1 L_ok_25
  v_cmp_ne_u32 vcc, 1, v47
  s_cbranch_vccnz L_spin_24
L_ok_25:
  s_bitset1_b32 s100, 0
  s_xor_b32 s56, s86, 0
  s_add_u32 s56, s56, s85
  s_add_u32 s56, s56, 0
  buffer_load_dwordx4 v[224:227], v0, s[52:55], s56 offen offset:0 sc1
  buffer_load_dwordx4 v[228:231], v0, s[52:55], s56 offen offset:2048 sc1
  s_xor_b32 s56, s86, 0
  s_add_u32 s56, s56, s85
  s_add_u32 s56, s56, 4096
  buffer_load_dwordx4 v[232:235], v0, s[52:55], s56 offen offset:0 sc1
  buffer_load_dwordx4 v[236:239], v0, s[52:55], s56 offen offset:2048 sc1
  s_xor_b32 s56, s86, 8192
  s_add_u32 s56, s56, s85
  s_add_u32 s56, s56, 0
  buffer_load_dwordx4 v[240:243], v0, s[52:55], s56 offen offset:0 sc1
  buffer_load_dwordx4 v[244:247], v0, s[52:55], s56 offen offset:2048 sc1
  s_xor_b32 s56, s86, 8192
  s_add_u32 s56, s56, s85
  s_add_u32 s56, s56, 4096
  buffer_load_dwordx4 v[248:251], v0, s[52:55], s56 offen offset:0 sc1
  buffer_load_dwordx4 v[252:255], v0, s[52:55], s56 offen offset:2048 sc1
L_sp_23:
  s_bitcmp1_b32 s100, 1
  s_cbranch_scc1 L_sp_26
  s_mov_b32 s101, 0
L_spin_27:
  buffer_load_dword v47, v46, s[52:55], 0 offen offset:128 sc1
  s_waitcnt vmcnt(0)
  s_add_u32 s101, s101, 1
  s_cmp_gt_u32 s101, 0x40000
  s_cbranch_scc1 L_ok_28
  v_cmp_ne_u32 vcc, 1, v47
  s_cbranch_vccnz L_spin_27
L_ok_28:
  s_bitset1_b32 s100, 1
  s_xor_b32 s56, s86, 0
  s_add_u32 s56, s56, s85
  s_add_u32 s56, s56, 0
  buffer_load_dwordx4 v[64:67], v0, s[52:55], s56 offen offset:1024 sc1
  buffer_load_dwordx4 v[68:71], v0, s[52:55], s56 offen offset:3072 sc1
  s_xor_b32 s56, s86, 0
  s_add_u32 s56, s56, s85
  s_add_u32 s56, s56, 4096
  buffer_load_dwordx4 v[72:75], v0, s[52:55], s56 offen offset:1024 sc1
  buffer_load_dwordx4 v[76:79], v0, s[52:55], s56 offen offset:3072 sc1
  s_xor_b32 s56, s86, 8192
  s_add_u32 s56, s56, s85
  s_add_u32 s56, s56, 0
  buffer_load_dwordx4 v[80:83], v0, s[52:55], s56 offen offset:1024 sc1
  buffer_load_dwordx4 v[84:87], v0, s[52:55], s56 offen offset:3072 sc1
  s_xor_b32 s56, s86, 8192
  s_add_u32 s56, s56, s85
  s_add_u32 s56, s56, 4096
  buffer_load_dwordx4 v[88:91], v0, s[52:55], s56 offen offset:1024 sc1
  buffer_load_dwordx4 v[92:95], v0, s[52:55], s56 offen offset:3072 sc1
L_sp_26:
  s_waitcnt vmcnt(20) lgkmcnt(0)
  v_mfma_f32_16x16x32_bf16 v[128:131], a[16:19], a[160:163], v[128:131]
  v_mfma_f32_16x16x32_bf16 v[144:147], a[20:23], a[160:163], v[144:147]
  v_mfma_f32_16x16x32_bf16 v[148:151], a[20:23], a[164:167], v[148:151]
  v_mfma_f32_16x16x32_bf16 v[132:135], a[16:19], a[164:167], v[132:135]
  v_mfma_f32_16x16x32_bf16 v[136:139], a[16:19], a[168:171], v[136:139]
  v_mfma_f32_16x16x32_bf16 v[152:155], a[20:23], a[168:171], v[152:155]
  v_mfma_f32_16x16x32_bf16 v[156:159], a[20:23], a[172:175], v[156:159]
  v_mfma_f32_16x16x32_bf16 v[140:143], a[16:19], a[172:175], v[140:143]
  v_mfma_f32_16x16x32_bf16 v[168:171], a[24:27], a[168:171], v[168:171]
  v_mfma_f32_16x16x32_bf16 v[184:187], a[28:31], a[168:171], v[184:187]
  s_waitcnt vmcnt(15)
  ds_read_b64_tr_b16 a[0:1], v12 offset:0
  ds_read_b64_tr_b16 a[2:3], v12 offset:2048
  v_mfma_f32_16x16x32_bf16 v[188:191], a[28:31], a[172:175], v[188:191]
  ds_read_b64_tr_b16 a[4:5], v13 offset:0
  ds_read_b64_tr_b16 a[6:7], v13 offset:2048
  v_mfma_f32_16x16x32_bf16 v[172:175], a[24:27], a[172:175], v[172:175]
  ds_read_b64_tr_b16 a[8:9], v14 offset:0
  ds_read_b64_tr_b16 a[10:11], v14 offset:2048
  v_mfma_f32_16x16x32_bf16 v[160:163], a[24:27], a[160:163], v[160:163]
  ds_read_b64_tr_b16 a[12:13], v15 offset:0
  ds_read_b64_tr_b16 a[14:15], v15 offset:2048
  v_mfma_f32_16x16x32_bf16 v[176:179], a[28:31], a[160:163], v[176:179]
  v_mfma_f32_16x16x32_bf16 v[180:183], a[28:31], a[164:167], v[180:183]
  v_mfma_f32_16x16x32_bf16 v[164:167], a[24:27], a[164:167], v[164:167]
  s_waitcnt vmcnt(11) lgkmcnt(0)
  v_mfma_f32_16x16x32_bf16 v[128:131], a[0:3], a[176:179], v[128:131]
  v_mfma_f32_16x16x32_bf16 v[144:147], a[4:7], a[176:179], v[144:147]
  v_mfma_f32_16x16x32_bf16 v[148:151], a[4:7], a[180:183], v[148:151]
  v_mfma_f32_16x16x32_bf16 v[132:135], a[0:3], a[180:183], v[132:135]
  v_mfma_f32_16x16x32_bf16 v[136:139], a[0:3], a[184:187], v[136:139]
  v_mfma_f32_16x16x32_bf16 v[152:155], a[4:7], a[184:187], v[152:155]
  v_mfma_f32_16x16x32_bf16 v[156:159], a[4:7], a[188:191], v[156:159]
  v_mfma_f32_16x16x32_bf16 v[140:143], a[0:3], a[188:191], v[140:143]
  v_mfma_f32_16x16x32_bf16 v[168:171], a[8:11], a[184:187], v[168:171]
  v_mfma_f32_16x16x32_bf16 v[184:187], a[12:15], a[184:187], v[184:187]
  s_waitcnt vmcnt(6)
  ds_read_b64_tr_b16 a[16:17], v12 offset:4096
  ds_read_b64_tr_b16 a[18:19], v12 offset:6144
  v_mfma_f32_16x16x32_bf16 v[188:191], a[12:15], a[188:191], v[188:191]
  ds_read_b64_tr_b16 a[20:21], v13 offset:4096
  ds_read_b64_tr_b16 a[22:23], v13 offset:6144
  v_mfma_f32_16x16x32_bf16 v[172:175], a[8:11], a[188:191], v[172:175]
  ds_read_b64_tr_b16 a[24:25], v14 offset:4096
  ds_read_b64_tr_b16 a[26:27], v14 offset:6144
  v_mfma_f32_16x16x32_bf16 v[160:163], a[8:11], a[176:179], v[160:163]
  ds_read_b64_tr_b16 a[28:29], v15 offset:4096
  ds_read_b64_tr_b16 a[30:31], v15 offset:6144
  v_mfma_f32_16x16x32_bf16 v[176:179], a[12:15], a[176:179], v[176:179]
  v_mfma_f32_16x16x32_bf16 v[180:183], a[12:15], a[180:183], v[180:183]
  v_mfma_f32_16x16x32_bf16 v[164:167], a[8:11], a[180:183], v[164:167]
  s_waitcnt vmcnt(2) lgkmcnt(0)
  v_mfma_f32_16x16x32_bf16 v[128:131], a[16:19], a[192:195], v[128:131]
  v_mfma_f32_16x16x32_bf16 v[144:147], a[20:23], a[192:195], v[144:147]
  v_mfma_f32_16x16x32_bf16 v[148:151], a[20:23], a[196:199], v[148:151]
  v_mfma_f32_16x16x32_bf16 v[132:135], a[16:19], a[196:199], v[132:135]
  v_mfma_f32_16x16x32_bf16 v[136:139], a[16:19], a[200:203], v[136:139]
  v_mfma_f32_16x16x32_bf16 v[152:155], a[20:23], a[200:203], v[152:155]
  v_mfma_f32_16x16x32_bf16 v[156:159], a[20:23], a[204:207], v[156:159]
  v_mfma_f32_16x16x32_bf16 v[140:143], a[16:19], a[204:207], v[140:143]
  v_mfma_f32_16x16x32_bf16 v[168:171], a[24:27], a[200:203], v[168:171]
  v_mfma_f32_16x16x32_bf16 v[184:187], a[28:31], a[200:203], v[184:187]
  v_mfma_f32_16x16x32_bf16 v[188:191], a[28:31], a[204:207], v[188:191]
  v_mfma_f32_16x16x32_bf16 v[172:175], a[24:27], a[204:207], v[172:175]
  v_mfma_f32_16x16x32_bf16 v[160:163], a[24:27], a[192:195], v[160:163]
  v_mfma_f32_16x16x32_bf16 v[176:179], a[28:31], a[192:195], v[176:179]
  v_mfma_f32_16x16x32_bf16 v[180:183], a[28:31], a[196:199], v[180:183]
  v_mfma_f32_16x16x32_bf16 v[164:167], a[24:27], a[196:199], v[164:167]
  ds_write_b128 v21, v[128:131] offset:0
  ds_write_b128 v21, v[132:135] offset:1024
  ds_write_b128 v21, v[136:139] offset:4096
  ds_write_b128 v21, v[140:143] offset:5120
  s_waitcnt vmcnt(0)
  v_mfma_f32_16x16x32_bf16 v[208:211], a[214:217], v[224:227], 0
  ds_write_b128 v21, v[144:147] offset:2048
  v_mfma_f32_16x16x32_bf16 v[216:219], a[212:215], v[224:227], 0
  ds_write_b128 v21, v[148:151] offset:3072
  v_mfma_f32_16x16x32_bf16 v[212:215], a[214:217], v[240:243], 0
  v_mfma_f32_16x16x32_bf16 v[220:223], a[212:215], v[240:243], 0
  ds_write_b128 v21, v[152:155] offset:6144
  v_mfma_f32_16x16x32_bf16 v[208:211], a[214:217], v[64:67], v[208:211]
  v_mfma_f32_16x16x32_bf16 v[216:219], a[212:215], v[64:67], v[216:219]
  ds_write_b128 v21, v[156:159] offset:7168
  v_mfma_f32_16x16x32_bf16 v[212:215], a[214:217], v[80:83], v[212:215]
  v_mfma_f32_16x16x32_bf16 v[220:223], a[212:215], v[80:83], v[220:223]
  ds_write_b128 v21, v[160:163] offset:32768
  v_mfma_f32_16x16x32_bf16 v[208:211], a[214:217], v[228:231], v[208:211]
  v_mfma_f32_16x16x32_bf16 v[216:219], a[212:215], v[228:231], v[216:219]
  ds_write_b128 v21, v[164:167] offset:33792
  v_mfma_f32_16x16x32_bf16 v[212:215], a[214:217], v[244:247], v[212:215]
  v_mfma_f32_16x16x32_bf16 v[220:223], a[212:215], v[244:247], v[220:223]
  ds_write_b128 v21, v[168:171] offset:36864
  v_mfma_f32_16x16x32_bf16 v[208:211], a[214:217], v[68:71], v[208:211]
  v_mfma_f32_16x16x32_bf16 v[216:219], a[212:215], v[68:71], v[216:219]
  ds_write_b128 v21, v[172:175] offset:37888
  v_mfma_f32_16x16x32_bf16 v[212:215], a[214:217], v[84:87], v[212:215]
  v_mfma_f32_16x16x32_bf16 v[220:223], a[212:215], v[84:87], v[220:223]
  ds_write_b128 v21, v[176:179] offset:34816
  v_mfma_f32_16x16x32_bf16 v[208:211], a[214:217], v[232:235], v[208:211]
  v_mfma_f32_16x16x32_bf16 v[216:219], a[212:215], v[232:235], v[216:219]
  ds_write_b128 v21, v[180:183] offset:35840
  v_mfma_f32_16x16x32_bf16 v[212:215], a[214:217], v[248:251], v[212:215]
  v_mfma_f32_16x16x32_bf16 v[220:223], a[212:215], v[248:251], v[220:223]
  ds_write_b128 v21, v[184:187] offset:38912
  v_mfma_f32_16x16x32_bf16 v[208:211], a[214:217], v[72:75], v[208:211]
  v_mfma_f32_16x16x32_bf16 v[216:219], a[212:215], v[72:75], v[216:219]
  ds_write_b128 v21, v[188:191] offset:39936
  v_mfma_f32_16x16x32_bf16 v[212:215], a[214:217], v[88:91], v[212:215]
  v_mfma_f32_16x16x32_bf16 v[220:223], a[212:215], v[88:91], v[220:223]
  v_mfma_f32_16x16x32_bf16 v[208:211], a[214:217], v[236:239], v[208:211]
  v_mfma_f32_16x16x32_bf16 v[216:219], a[212:215], v[236:239], v[216:219]
  v_mfma_f32_16x16x32_bf16 v[212:215], a[214:217], v[252:255], v[212:215]
  v_mfma_f32_16x16x32_bf16 v[220:223], a[212:215], v[252:255], v[220:223]
  v_mfma_f32_16x16x32_bf16 v[208:211], a[214:217], v[76:79], v[208:211]
  v_mfma_f32_16x16x32_bf16 v[216:219], a[212:215], v[76:79], v[216:219]
  v_mfma_f32_16x16x32_bf16 v[212:215], a[214:217], v[92:95], v[212:215]
  v_mfma_f32_16x16x32_bf16 v[220:223], a[212:215], v[92:95], v[220:223]
  s_waitcnt lgkmcnt(0)
  s_barrier
  ds_read_b128 v[128:131], v22 offset:0
  ds_read_b128 v[132:135], v22 offset:1024
  ds_read_b128 v[136:139], v22 offset:2048
  ds_read_b128 v[140:143], v22 offset:3072
  ds_read_b128 v[144:147], v22 offset:8192
  ds_read_b128 v[148:151], v22 offset:9216
  ds_read_b128 v[152:155], v22 offset:10240
  ds_read_b128 v[156:159], v22 offset:11264
  ds_read_b128 v[160:163], v22 offset:16384
  ds_read_b128 v[164:167], v22 offset:17408
  ds_read_b128 v[168:171], v22 offset:18432
  ds_read_b128 v[172:175], v22 offset:19456
  ds_read_b128 v[176:179], v22 offset:24576
  ds_read_b128 v[180:183], v22 offset:25600
  ds_read_b128 v[184:187], v22 offset:26624
  ds_read_b128 v[188:191], v22 offset:27648
  s_waitcnt lgkmcnt(8)
  v_pk_add_f32 v[48:49], v[128:129], v[144:145]
  v_pk_add_f32 v[50:51], v[130:131], v[146:147]
  v_pk_add_f32 v[52:53], v[132:133], v[148:149]
  v_pk_add_f32 v[54:55], v[134:135], v[150:151]
  v_pk_add_f32 v[56:57], v[136:137], v[152:153]
  v_pk_add_f32 v[58:59], v[138:139], v[154:155]
  v_pk_add_f32 v[60:61], v[140:141], v[156:157]
  v_pk_add_f32 v[62:63], v[142:143], v[158:159]
  s_waitcnt lgkmcnt(0)
  v_pk_add_f32 v[160:161], v[160:161], v[176:177]
  v_pk_add_f32 v[162:163], v[162:163], v[178:179]
  v_pk_add_f32 v[164:165], v[164:165], v[180:181]
  v_pk_add_f32 v[166:167], v[166:167], v[182:183]
  v_pk_add_f32 v[168:169], v[168:169], v[184:185]
  v_pk_add_f32 v[170:171], v[170:171], v[186:187]
  v_pk_add_f32 v[172:173], v[172:173], v[188:189]
  v_pk_add_f32 v[174:175], v[174:175], v[190:191]
  v_pk_add_f32 v[48:49], v[48:49], v[160:161]
  v_pk_add_f32 v[50:51], v[50:51], v[162:163]
  v_pk_add_f32 v[52:53], v[52:53], v[164:165]
  v_pk_add_f32 v[54:55], v[54:55], v[166:167]
  v_pk_add_f32 v[56:57], v[56:57], v[168:169]
  v_pk_add_f32 v[58:59], v[58:59], v[170:171]
  v_pk_add_f32 v[60:61], v[60:61], v[172:173]
  v_pk_add_f32 v[62:63], v[62:63], v[174:175]
  v_mfma_f32_16x16x32_bf16 v[48:51], a[214:217], v[32:35], v[48:51]
  v_mfma_f32_16x16x32_bf16 v[52:55], a[214:217], v[36:39], v[52:55]
  v_mfma_f32_16x16x32_bf16 v[56:59], a[212:215], v[32:35], v[56:59]
  v_mfma_f32_16x16x32_bf16 v[60:63], a[212:215], v[36:39], v[60:63]
  s_nop 4
  v_pk_mul_f32 v[144:145], v[48:49], s[68:69]
  v_pk_mul_f32 v[146:147], v[50:51], s[68:69]
  v_pk_mul_f32 v[148:149], v[52:53], s[68:69]
  v_pk_mul_f32 v[150:151], v[54:55], s[68:69]
  v_pk_mul_f32 v[152:153], v[56:57], s[68:69]
  v_pk_mul_f32 v[154:155], v[58:59], s[68:69]
  v_pk_mul_f32 v[156:157], v[60:61], s[68:69]
  v_pk_mul_f32 v[158:159], v[62:63], s[68:69]
  v_exp_f32 v144, v144
  v_exp_f32 v145, v145
  v_exp_f32 v146, v146
  v_exp_f32 v147, v147
  v_exp_f32 v148, v148
  v_exp_f32 v149, v149
  v_exp_f32 v150, v150
  v_exp_f32 v151, v151
  v_exp_f32 v152, v152
  v_exp_f32 v153, v153
  v_exp_f32 v154, v154
  v_exp_f32 v155, v155
  v_exp_f32 v156, v156
  v_exp_f32 v157, v157
  v_exp_f32 v158, v158
  v_exp_f32 v159, v159
  v_pk_add_f32 v[144:145], v[144:145], 1.0 op_sel_hi:[1,0]
  v_pk_add_f32 v[146:147], v[146:147], 1.0 op_sel_hi:[1,0]
  v_pk_add_f32 v[148:149], v[148:149], 1.0 op_sel_hi:[1,0]
  v_pk_add_f32 v[150:151], v[150:151], 1.0 op_sel_hi:[1,0]
  v_pk_add_f32 v[152:153], v[152:153], 1.0 op_sel_hi:[1,0]
  v_pk_add_f32 v[154:155], v[154:155], 1.0 op_sel_hi:[1,0]
  v_pk_add_f32 v[156:157], v[156:157], 1.0 op_sel_hi:[1,0]
  v_pk_add_f32 v[158:159], v[158:159], 1.0 op_sel_hi:[1,0]
  v_rcp_f32 v144, v144
  v_rcp_f32 v145, v145
  v_rcp_f32 v146, v146
  v_rcp_f32 v147, v147
  v_rcp_f32 v148, v148
  v_rcp_f32 v149, v149
  v_rcp_f32 v150, v150
  v_rcp_f32 v151, v151
  v_rcp_f32 v152, v152
  v_rcp_f32 v153, v153
  v_rcp_f32 v154, v154
  v_rcp_f32 v155, v155
  v_rcp_f32 v156, v156
  v_rcp_f32 v157, v157
  v_rcp_f32 v158, v158
  v_rcp_f32 v159, v159
  v_pk_mul_f32 v[48:49], v[48:49], v[144:145]
  v_pk_mul_f32 v[50:51], v[50:51], v[146:147]
  v_pk_mul_f32 v[52:53], v[52:53], v[148:149]
  v_pk_mul_f32 v[54:55], v[54:55], v[150:151]
  v_pk_mul_f32 v[56:57], v[56:57], v[152:153]
  v_pk_mul_f32 v[58:59], v[58:59], v[154:155]
  v_pk_mul_f32 v[60:61], v[60:61], v[156:157]
  v_pk_mul_f32 v[62:63], v[62:63], v[158:159]
  v_pk_mul_f32 v[208:209], v[208:209], v[48:49]
  v_pk_mul_f32 v[210:211], v[210:211], v[50:51]
  v_pk_mul_f32 v[212:213], v[212:213], v[52:53]
  v_pk_mul_f32 v[214:215], v[214:215], v[54:55]
  v_pk_mul_f32 v[216:217], v[216:217], v[56:57]
  v_pk_mul_f32 v[218:219], v[218:219], v[58:59]
  v_pk_mul_f32 v[220:221], v[220:221], v[60:61]
  v_pk_mul_f32 v[222:223], v[222:223], v[62:63]
  v_permlane32_swap_b32 v208, v216
  v_permlane32_swap_b32 v209, v217
  v_permlane32_swap_b32 v210, v218
  v_permlane32_swap_b32 v211, v219
  v_permlane16_swap_b32 v208, v216
  v_permlane16_swap_b32 v209, v217
  v_permlane16_swap_b32 v210, v218
  v_permlane16_swap_b32 v211, v219
  v_dot2_f32_bf16 v208, v192, s65, v208
  v_dot2_f32_bf16 v209, v192, s66, v209
  v_dot2_f32_bf16 v210, v193, s65, v210
  v_dot2_f32_bf16 v211, v193, s66, v211
  v_dot2_f32_bf16 v216, v194, s65, v216
  v_dot2_f32_bf16 v217, v194, s66, v217
  v_dot2_f32_bf16 v218, v195, s65, v218
  v_dot2_f32_bf16 v219, v195, s66, v219
  v_cvt_pk_bf16_f32 v200, v208, v209
  v_cvt_pk_bf16_f32 v201, v210, v211
  v_cvt_pk_bf16_f32 v202, v216, v217
  v_cvt_pk_bf16_f32 v203, v218, v219
  buffer_store_dwordx4 v[200:203], v20, s[44:47], s87 offen sc1
  v_permlane32_swap_b32 v212, v220
  v_permlane32_swap_b32 v213, v221
  v_permlane32_swap_b32 v214, v222
  v_permlane32_swap_b32 v215, v223
  v_permlane16_swap_b32 v212, v220
  v_permlane16_swap_b32 v213, v221
  v_permlane16_swap_b32 v214, v222
  v_permlane16_swap_b32 v215, v223
  v_dot2_f32_bf16 v212, v196, s65, v212
  v_dot2_f32_bf16 v213, v196, s66, v213
  v_dot2_f32_bf16 v214, v197, s65, v214
  v_dot2_f32_bf16 v215, v197, s66, v215
  v_dot2_f32_bf16 v220, v198, s65, v220
  v_dot2_f32_bf16 v221, v198, s66, v221
  v_dot2_f32_bf16 v222, v199, s65, v222
  v_dot2_f32_bf16 v223, v199, s66, v223
  v_cvt_pk_bf16_f32 v204, v212, v213
  v_cvt_pk_bf16_f32 v205, v214, v215
  v_cvt_pk_bf16_f32 v206, v220, v221
  v_cvt_pk_bf16_f32 v207, v222, v223
  buffer_store_dwordx4 v[204:207], v20, s[44:47], s57 offen sc1
  s_endpgm
L_slow:
  s_waitcnt vmcnt(0) lgkmcnt(0)
  s_barrier
  v_mov_b32 v48, 0xff800000
  v_mov_b32 v49, 0xff800000
  v_mov_b32 v50, 0xff800000
  v_mov_b32 v51, 0xff800000
  v_mov_b32 v52, 0xff800000
  v_mov_b32 v53, 0xff800000
  v_mov_b32 v54, 0xff800000
  v_mov_b32 v55, 0xff800000
  v_mov_b32 v56, 0xff800000
  v_mov_b32 v57, 0xff800000
  v_mov_b32 v58, 0xff800000
  v_mov_b32 v59, 0xff800000
  v_mov_b32 v60, 0xff800000
  v_mov_b32 v61, 0xff800000
  v_mov_b32 v62, 0xff800000
  v_mov_b32 v63, 0xff800000
  s_mov_b32 s62, 0
  s_mov_b32 s100, 0
L_slow_loop:
  s_add_u32 m0, s63, 65536
  s_nop 0
  buffer_load_dwordx4 v24, s[12:15], s62 offen offset:0 lds
  buffer_load_dwordx4 v25, s[12:15], s62 offen offset:1024 lds
  s_add_u32 s62, s62, 8192
  s_waitcnt vmcnt(0)
  s_barrier
  ds_read_b128 a[144:147], v12 offset:32768
  ds_read_b128 a[148:151], v13 offset:32768
  ds_read_b128 a[152:155], v14 offset:32768
  ds_read_b128 a[156:159], v15 offset:32768
  ds_read_b128 a[160:163], v12 offset:40960
  ds_read_b128 a[164:167], v13 offset:40960
  ds_read_b128 a[168:171], v14 offset:40960
  ds_read_b128 a[172:175], v15 offset:40960
  s_waitcnt lgkmcnt(0)
  s_barrier
  v_mfma_f32_16x16x32_bf16 v[64:67], a[144:147], a[0:3], 0
  v_mfma_f32_16x16x32_bf16 v[64:67], a[148:151], a[16:19], v[64:67]
  v_mfma_f32_16x16x32_bf16 v[64:67], a[152:155], a[32:35], v[64:67]
  v_mfma_f32_16x16x32_bf16 v[64:67], a[156:159], a[48:51], v[64:67]
  v_mfma_f32_16x16x32_bf16 v[68:71], a[172:175], a[48:51], 0
  v_mfma_f32_16x16x32_bf16 v[68:71], a[168:171], a[32:35], v[68:71]
  v_mfma_f32_16x16x32_bf16 v[68:71], a[164:167], a[16:19], v[68:71]
  v_mfma_f32_16x16x32_bf16 v[68:71], a[160:163], a[0:3], v[68:71]
  v_mfma_f32_16x16x32_bf16 v[72:75], a[144:147], a[4:7], 0
  v_mfma_f32_16x16x32_bf16 v[72:75], a[148:151], a[20:23], v[72:75]
  v_mfma_f32_16x16x32_bf16 v[72:75], a[152:155], a[36:39], v[72:75]
  v_mfma_f32_16x16x32_bf16 v[72:75], a[156:159], a[52:55], v[72:75]
  v_mfma_f32_16x16x32_bf16 v[76:79], a[172:175], a[52:55], 0
  v_mfma_f32_16x16x32_bf16 v[76:79], a[168:171], a[36:39], v[76:79]
  v_mfma_f32_16x16x32_bf16 v[76:79], a[164:167], a[20:23], v[76:79]
  v_mfma_f32_16x16x32_bf16 v[76:79], a[160:163], a[4:7], v[76:79]
  v_mfma_f32_16x16x32_bf16 v[80:83], a[144:147], a[8:11], 0
  v_mfma_f32_16x16x32_bf16 v[80:83], a[148:151], a[24:27], v[80:83]
  v_mfma_f32_16x16x32_bf16 v[80:83], a[152:155], a[40:43], v[80:83]
  v_mfma_f32_16x16x32_bf16 v[80:83], a[156:159], a[56:59], v[80:83]
  v_mfma_f32_16x16x32_bf16 v[84:87], a[172:175], a[56:59], 0
  v_mfma_f32_16x16x32_bf16 v[84:87], a[168:171], a[40:43], v[84:87]
  v_mfma_f32_16x16x32_bf16 v[84:87], a[164:167], a[24:27], v[84:87]
  v_mfma_f32_16x16x32_bf16 v[84:87], a[160:163], a[8:11], v[84:87]
  v_mfma_f32_16x16x32_bf16 v[88:91], a[144:147], a[12:15], 0
  v_mfma_f32_16x16x32_bf16 v[88:91], a[148:151], a[28:31], v[88:91]
  v_mfma_f32_16x16x32_bf16 v[88:91], a[152:155], a[44:47], v[88:91]
  v_mfma_f32_16x16x32_bf16 v[88:91], a[156:159], a[60:63], v[88:91]
  v_mfma_f32_16x16x32_bf16 v[92:95], a[172:175], a[60:63], 0
  v_mfma_f32_16x16x32_bf16 v[92:95], a[168:171], a[44:47], v[92:95]
  v_mfma_f32_16x16x32_bf16 v[92:95], a[164:167], a[28:31], v[92:95]
  v_mfma_f32_16x16x32_bf16 v[92:95], a[160:163], a[12:15], v[92:95]
  v_max3_f32 v48, v48, v64, v65
  v_max3_f32 v48, v48, v66, v67
  v_max3_f32 v48, v48, v68, v69
  v_max3_f32 v48, v48, v70, v71
  v_max3_f32 v52, v52, v72, v73
  v_max3_f32 v52, v52, v74, v75
  v_max3_f32 v52, v52, v76, v77
  v_max3_f32 v52, v52, v78, v79
  v_max3_f32 v56, v56, v80, v81
  v_max3_f32 v56, v56, v82, v83
  v_max3_f32 v56, v56, v84, v85
  v_max3_f32 v56, v56, v86, v87
  v_max3_f32 v60, v60, v88, v89
  v_max3_f32 v60, v60, v90, v91
  v_max3_f32 v60, v60, v92, v93
  v_max3_f32 v60, v60, v94, v95
  s_add_u32 s100, s100, 1
  s_cmp_lt_u32 s100, 16
  s_cbranch_scc1 L_slow_loop
  v_mov_b32 v49, v48
  s_nop 1
  v_permlane32_swap_b32 v48, v49
  v_max_f32 v48, v48, v49
  v_mov_b32 v49, v48
  s_nop 1
  v_permlane16_swap_b32 v48, v49
  v_max_f32 v48, v48, v49
  v_sub_f32 v48, 0, v48
  v_mov_b32 v49, v48
  v_mov_b32 v50, v48
  v_mov_b32 v51, v48
  v_mov_b32 v53, v52
  s_nop 1
  v_permlane32_swap_b32 v52, v53
  v_max_f32 v52, v52, v53
  v_mov_b32 v53, v52
  s_nop 1
  v_permlane16_swap_b32 v52, v53
  v_max_f32 v52, v52, v53
  v_sub_f32 v52, 0, v52
  v_mov_b32 v53, v52
  v_mov_b32 v54, v52
  v_mov_b32 v55, v52
  v_mov_b32 v57, v56
  s_nop 1
  v_permlane32_swap_b32 v56, v57
  v_max_f32 v56, v56, v57
  v_mov_b32 v57, v56
  s_nop 1
  v_permlane16_swap_b32 v56, v57
  v_max_f32 v56, v56, v57
  v_sub_f32 v56, 0, v56
  v_mov_b32 v57, v56
  v_mov_b32 v58, v56
  v_mov_b32 v59, v56
  v_mov_b32 v61, v60
  s_nop 1
  v_permlane32_swap_b32 v60, v61
  v_max_f32 v60, v60, v61
  v_mov_b32 v61, v60
  s_nop 1
  v_permlane16_swap_b32 v60, v61
  v_max_f32 v60, v60, v61
  v_sub_f32 v60, 0, v60
  v_mov_b32 v61, v60
  v_mov_b32 v62, v60
  v_mov_b32 v63, v60
  s_mov_b32 s62, 0
  s_mov_b32 s60, 0
  s_add_u32 m0, s63, 65536
  s_nop 0
  buffer_load_dwordx4 v24, s[12:15], s62 offen offset:0 lds
  buffer_load_dwordx4 v25, s[12:15], s62 offen offset:1024 lds
  s_add_u32 s62, s62, 8192
  s_add_u32 m0, s63, 81920
  s_nop 0
  buffer_load_dwordx4 v24, s[12:15], s62 offen offset:0 lds
  buffer_load_dwordx4 v25, s[12:15], s62 offen offset:1024 lds
  buffer_load_dwordx4 v26, s[16:19], s62 offen offset:2048 lds
  buffer_load_dwordx4 v27, s[16:19], s62 offen offset:3072 lds
  s_add_u32 s62, s62, 8192
  s_add_u32 m0, s63, 32768
  s_nop 0
  buffer_load_dwordx4 v24, s[12:15], s62 offen offset:0 lds
  buffer_load_dwordx4 v25, s[12:15], s62 offen offset:1024 lds
  buffer_load_dwordx4 v26, s[16:19], s62 offen offset:2048 lds
  buffer_load_dwordx4 v27, s[16:19], s62 offen offset:3072 lds
  s_add_u32 s62, s62, 8192
  s_add_u32 m0, s63, 49152
  s_nop 0
  buffer_load_dwordx4 v24, s[12:15], s62 offen offset:0 lds
  buffer_load_dwordx4 v25, s[12:15], s62 offen offset:1024 lds
  buffer_load_dwordx4 v26, s[16:19], s62 offen offset:2048 lds
  buffer_load_dwordx4 v27, s[16:19], s62 offen offset:3072 lds
  s_add_u32 s62, s62, 8192
  s_waitcnt vmcnt(0)
  s_barrier
  ds_read_b128 a[144:147], v12 offset:32768
  ds_read_b128 a[148:151], v13 offset:32768
  ds_read_b128 a[152:155], v14 offset:32768
  ds_read_b128 a[156:159], v15 offset:32768
  ds_read_b128 a[160:163], v12 offset:40960
  ds_read_b128 a[164:167], v13 offset:40960
  ds_read_b128 a[168:171], v14 offset:40960
  ds_read_b128 a[172:175], v15 offset:40960
  s_waitcnt lgkmcnt(0)
  s_barrier
  s_add_u32 m0, s63, 65536
  s_nop 0
  buffer_load_dwordx4 v24, s[12:15], s62 offen offset:0 lds
  buffer_load_dwordx4 v25, s[12:15], s62 offen offset:1024 lds
  buffer_load_dwordx4 v26, s[16:19], s62 offen offset:2048 lds
  buffer_load_dwordx4 v27, s[16:19], s62 offen offset:3072 lds
  s_add_u32 s62, s62, 8192
  v_mfma_f32_16x16x32_bf16 v[64:67], a[144:147], a[0:3], v[48:51]
  v_mfma_f32_16x16x32_bf16 v[64:67], a[148:151], a[16:19], v[64:67]
  v_mfma_f32_16x16x32_bf16 v[64:67], a[152:155], a[32:35], v[64:67]
  v_mfma_f32_16x16x32_bf16 v[64:67], a[156:159], a[48:51], v[64:67]
  v_mfma_f32_16x16x32_bf16 v[68:71], a[172:175], a[48:51], v[48:51]
  v_mfma_f32_16x16x32_bf16 v[68:71], a[168:171], a[32:35], v[68:71]
  v_mfma_f32_16x16x32_bf16 v[68:71], a[164:167], a[16:19], v[68:71]
  v_mfma_f32_16x16x32_bf16 v[68:71], a[160:163], a[0:3], v[68:71]
  v_mfma_f32_16x16x32_bf16 v[72:75], a[144:147], a[4:7], v[52:55]
  v_mfma_f32_16x16x32_bf16 v[72:75], a[148:151], a[20:23], v[72:75]
  v_mfma_f32_16x16x32_bf16 v[72:75], a[152:155], a[36:39], v[72:75]
  v_mfma_f32_16x16x32_bf16 v[72:75], a[156:159], a[52:55], v[72:75]
  v_mfma_f32_16x16x32_bf16 v[76:79], a[172:175], a[52:55], v[52:55]
  v_mfma_f32_16x16x32_bf16 v[76:79], a[168:171], a[36:39], v[76:79]
  v_mfma_f32_16x16x32_bf16 v[76:79], a[164:167], a[20:23], v[76:79]
  v_mfma_f32_16x16x32_bf16 v[76:79], a[160:163], a[4:7], v[76:79]
  v_mfma_f32_16x16x32_bf16 v[80:83], a[144:147], a[8:11], v[56:59]
  v_mfma_f32_16x16x32_bf16 v[80:83], a[148:151], a[24:27], v[80:83]
  v_mfma_f32_16x16x32_bf16 v[80:83], a[152:155], a[40:43], v[80:83]
  v_mfma_f32_16x16x32_bf16 v[80:83], a[156:159], a[56:59], v[80:83]
  v_mfma_f32_16x16x32_bf16 v[84:87], a[172:175], a[56:59], v[56:59]
  v_mfma_f32_16x16x32_bf16 v[84:87], a[168:171], a[40:43], v[84:87]
  v_mfma_f32_16x16x32_bf16 v[84:87], a[164:167], a[24:27], v[84:87]
  v_mfma_f32_16x16x32_bf16 v[84:87], a[160:163], a[8:11], v[84:87]
  v_mfma_f32_16x16x32_bf16 v[88:91], a[144:147], a[12:15], v[60:63]
  v_mfma_f32_16x16x32_bf16 v[88:91], a[148:151], a[28:31], v[88:91]
  v_mfma_f32_16x16x32_bf16 v[88:91], a[152:155], a[44:47], v[88:91]
  v_mfma_f32_16x16x32_bf16 v[88:91], a[156:159], a[60:63], v[88:91]
  v_mfma_f32_16x16x32_bf16 v[92:95], a[172:175], a[60:63], v[60:63]
  v_mfma_f32_16x16x32_bf16 v[92:95], a[168:171], a[44:47], v[92:95]
  v_mfma_f32_16x16x32_bf16 v[92:95], a[164:167], a[28:31], v[92:95]
  v_mfma_f32_16x16x32_bf16 v[92:95], a[160:163], a[12:15], v[92:95]
  ds_read_b128 a[144:147], v12 offset:49152
  ds_read_b128 a[148:151], v13 offset:49152
  ds_read_b128 a[152:155], v14 offset:49152
  ds_read_b128 a[156:159], v15 offset:49152
  ds_read_b128 a[160:163], v12 offset:57344
  ds_read_b128 a[164:167], v13 offset:57344
  ds_read_b128 a[168:171], v14 offset:57344
  ds_read_b128 a[172:175], v15 offset:57344
  v_exp_f32 v64, v64
  v_exp_f32 v65, v65
  v_exp_f32 v66, v66
  v_exp_f32 v67, v67
  v_exp_f32 v68, v68
  v_exp_f32 v69, v69
  v_exp_f32 v70, v70
  v_exp_f32 v71, v71
  v_cvt_pk_bf16_f32 v96, v64, v65
  v_cvt_pk_bf16_f32 v97, v66, v67
  v_cvt_pk_bf16_f32 v98, v68, v69
  v_cvt_pk_bf16_f32 v99, v70, v71
  v_exp_f32 v72, v72
  v_exp_f32 v73, v73
  v_exp_f32 v74, v74
  v_exp_f32 v75, v75
  v_exp_f32 v76, v76
  v_exp_f32 v77, v77
  v_exp_f32 v78, v78
  v_exp_f32 v79, v79
  v_cvt_pk_bf16_f32 v100, v72, v73
  v_cvt_pk_bf16_f32 v101, v74, v75
  v_cvt_pk_bf16_f32 v102, v76, v77
  v_cvt_pk_bf16_f32 v103, v78, v79
  v_exp_f32 v80, v80
  v_exp_f32 v81, v81
  v_exp_f32 v82, v82
  v_exp_f32 v83, v83
  v_exp_f32 v84, v84
  v_exp_f32 v85, v85
  v_exp_f32 v86, v86
  v_exp_f32 v87, v87
  v_cvt_pk_bf16_f32 v104, v80, v81
  v_cvt_pk_bf16_f32 v105, v82, v83
  v_cvt_pk_bf16_f32 v106, v84, v85
  v_cvt_pk_bf16_f32 v107, v86, v87
  s_waitcnt vmcnt(0) lgkmcnt(0)
  s_branch L_attn
L_end:
  s_endpgm
.section .rodata,"a"
.p2align 6
.amdhsa_kernel recurrent_scan__sliding_block_cached__mixer_s_mlp__prompt_kernel
  .amdhsa_next_free_vgpr 512
  .amdhsa_next_free_sgpr 102
  .amdhsa_accum_offset 256
  .amdhsa_group_segment_fixed_size 0
  .amdhsa_kernarg_size 104
  .amdhsa_user_sgpr_count 2
  .amdhsa_user_sgpr_kernarg_segment_ptr 1
  .amdhsa_system_sgpr_workgroup_id_x 1
  .amdhsa_float_denorm_mode_32 3
.end_amdhsa_kernel
```
